```python
import torch

def _softmax(x, axis=-1):
    return torch.softmax(x, dim=axis)
def _gelu(x):
    return torch.nn.functional.gelu(x, approximate="tanh")
def _silu(x):
    return torch.nn.functional.silu(x)
def _sigmoid(x):
    return torch.sigmoid(x)
def _layernorm(x, axis=-1, eps=1e-5):
    m = x.mean(dim=axis, keepdim=True)
    v = x.var(dim=axis, keepdim=True, unbiased=False)
    return (x - m) / torch.sqrt(v + eps)
def _scatter_add(tgt, idx, src, axis=0):
    return tgt.clone().index_add_(axis, idx, src)
def _segment_sum(src, seg, n):
    out = torch.zeros((n,) + src.shape[1:], dtype=src.dtype)
    return out.index_add_(0, seg, src)
def _pad(x, pw):
    flat = tuple(v for pair in reversed(pw) for v in pair)
    return torch.nn.functional.pad(x, flat)

kernel_name = 'parallel_sum__linear_kernel_hedgehog__dense_activation_relu__prompt'

def setup_inputs():

    _w = (lambda a: (lambda t: t.to(torch.bfloat16) if t.is_floating_point() else t)(torch.as_tensor(a)))
    def _A_setup():
        B, S, D, H = 1, 2048, 576, 32
        Dh = D // H
        return {
            "x": _w((lambda *s: torch.randn(*s, dtype=torch.bfloat16) * 0.05)(B, S, D)),
            "wqkv": _w((lambda *s: torch.randn(*s, dtype=torch.bfloat16) * 0.8)(D, 3 * D)),
            "w_phi": _w((lambda *s: torch.randn(*s, dtype=torch.bfloat16) * 0.8)(H, Dh, Dh) * (Dh ** -0.5)),
            "wo": _w((lambda *s: torch.randn(*s, dtype=torch.bfloat16) * 0.2)(D, D)),
        }
    _A_in = _A_setup()

    def _B_setup():
        B, S, D, Dff = 1, 2048, 576, 4608
        return {
            "x": _w((lambda *s: torch.randn(*s, dtype=torch.bfloat16) * 0.05)(B, S, D)),
            "w1": _w((lambda *s: torch.randn(*s, dtype=torch.bfloat16) * 0.05)(D, Dff)),
            "w2": _w((lambda *s: torch.randn(*s, dtype=torch.bfloat16) * 0.05)(Dff, D)),
        }
    _B_in = _B_setup()

    return {
        "A_x": _A_in["x"],
        "A_wqkv": _A_in["wqkv"],
        "A_w_phi": _A_in["w_phi"],
        "A_wo": _A_in["wo"],
        "B_x": _B_in["x"],
        "B_w1": _B_in["w1"],
        "B_w2": _B_in["w2"],
    }

def reference(A_x, A_wqkv, A_w_phi, A_wo, B_x, B_w1, B_w2):
    def _A_ref(x, wqkv, w_phi, wo):
        B, S, D = x.shape
        H = 32; Dh = D // H
        qkv = (lambda x, *d: x.permute(*d))((x @ wqkv).reshape(B, S, 3, H, Dh), 2, 0, 3, 1, 4)
        q, k, v = qkv[0], qkv[1], qkv[2]
        pq = torch.einsum("bhsd,hdf->bhsf", q, w_phi)
        pk = torch.einsum("bhsd,hdf->bhsf", k, w_phi)
        phi_q = torch.concatenate([_softmax(pq, axis=-1), _softmax(-pq, axis=-1)], axis=-1)
        phi_k = torch.concatenate([_softmax(pk, axis=-1), _softmax(-pk, axis=-1)], axis=-1)
        kv = torch.einsum("bhsf,bhsd->bhfd", phi_k, v)
        z  = torch.einsum("bhsf->bhf", phi_k)
        num = torch.einsum("bhqf,bhfd->bhqd", phi_q, kv)
        den = torch.einsum("bhqf,bhf->bhq", phi_q, z)[..., None] + 1e-6
        o = num / den
        return (lambda x, *d: x.permute(*d))(o, 0, 2, 1, 3).reshape(B, S, D) @ wo

    def _B_ref(x, w1, w2):
        h = torch.einsum("bsd,df->bsf", x, w1)
        zero = torch.zeros_like(h)
        h = torch.maximum(h, zero)
        return torch.einsum("bsf,fd->bsd", h, w2)

    x = A_x
    xn = _layernorm(x, axis=-1)
    return x + _A_ref(xn, A_wqkv, A_w_phi, A_wo) + _B_ref(xn, B_w1, B_w2)
```

```asm
; @launch grid=(256,1,1) block=(256,1,1) lds=163840
.amdgcn_target "amdgcn-amd-amdhsa--gfx950"
.text
.globl parallel_sum__linear_kernel_hedgehog__dense_activation_relu__prompt_kernel
.p2align 8
.type parallel_sum__linear_kernel_hedgehog__dense_activation_relu__prompt_kernel,@function
parallel_sum__linear_kernel_hedgehog__dense_activation_relu__prompt_kernel:
    s_cmp_ge_u32 s2, 256
    s_cbranch_scc1 L_end
    s_load_dwordx16 s[4:19], s[0:1], 0
    s_load_dwordx4 s[20:23], s[0:1], 64
    s_getpc_b64 s[96:97]
L_pc:
    s_bfe_u32 s98, s2, 0x30003
    v_lshrrev_b32 v184, 2, v0
    v_lshl_add_u32 v184, s98, 6, v184
    v_lshlrev_b32 v184, 7, v184
    v_min_u32 v185, L_end-L_pc, v184
    global_load_dword v251, v185, s[96:97]
    v_and_b32 v1, 63, v0
    v_lshrrev_b32 v184, 6, v0
    s_nop 0
    v_readfirstlane_b32 s62, v184
    s_and_b32 s87, s2, 7
    s_lshr_b32 s88, s2, 3
    s_and_b32 s96, s87, 1
    s_lshl_b32 s96, s96, 3
    s_and_b32 s97, s88, 7
    s_add_u32 s60, s96, s97
    s_lshr_b32 s96, s87, 1
    s_lshl_b32 s96, s96, 2
    s_lshr_b32 s98, s88, 3
    s_add_u32 s61, s96, s98
    s_lshl_b32 s97, s97, 0
    s_lshl_b32 s98, s98, 1
    s_add_u32 s86, s97, s98
    s_mov_b32 s89, s97
    s_cmp_ge_u32 s86, 9
    s_cselect_b32 s99, 9, 0
    s_sub_u32 s86, s86, s99
    v_lshrrev_b32 v189, 3, v1
    v_and_b32 v190, 7, v1
    v_xor_b32 v191, v190, v189
    v_mul_u32_u24 v224, 1152, v189
    v_lshl_add_u32 v224, v191, 4, v224
    v_add_u32 v225, 8192, v224
    v_add_u32 v226, 16384, v224
    v_add_u32 v227, 24576, v224
    s_lshl_b32 s94, s60, 2
    s_add_u32 s94, s94, s62
    s_mul_i32 s94, s94, 36864
    s_add_u32 s90, s94, 1152
    s_lshl_b32 s93, s86, 7
    s_add_u32 s93, s93, s94
    s_lshl_b32 s84, s62, 12
    s_mul_i32 s91, s62, 20480
    s_lshl_b32 s63, s60, 4
    s_add_u32 s63, s63, s61
    s_mul_i32 s96, s61, 1296
    v_lshl_add_u32 v193, v0, 2, s96
    v_mov_b32 v196, 0
    v_mov_b32 v197, 0
    v_mov_b32 v198, 0
    v_mov_b32 v199, 0
    s_lshl_b32 s95, s63, 8
    v_lshlrev_b32 v200, 4, v0
    v_lshlrev_b32 v250, 20, v1
    ds_write_b128 v200, v[196:199]
    s_waitcnt lgkmcnt(0)
    s_mov_b32 s24, s4
    s_and_b32 s25, s5, 0xffff
    s_mov_b32 s26, 2359296
    s_mov_b32 s27, 0x20000
    s_add_u32 m0, s84, 6400
    v_min_u32 v201, 2288, v200
    buffer_load_dwordx4 v224, s[24:27], s93 offen lds
    ds_write_b128 v201, v[196:199] offset:4096
    s_mov_b32 s28, s6
    s_and_b32 s29, s7, 0xffff
    buffer_load_dwordx4 v225, s[24:27], s93 offen offset:1024 lds
    s_mov_b32 s30, 1990656
    s_mov_b32 s31, 0x20000
    s_mov_b32 s32, s14
    buffer_load_dwordx4 v226, s[24:27], s93 offen offset:2048 lds
    s_and_b32 s33, s15, 0xffff
    s_mov_b32 s34, 5308416
    s_mov_b32 s35, 0x20000
    buffer_load_dwordx4 v227, s[24:27], s93 offen offset:3072 lds
    s_mov_b32 s56, s8
    s_and_b32 s57, s9, 0xffff
    s_mov_b32 s58, 20736
    s_add_u32 m0, s84, 22784
    s_add_u32 s93, s93, 128
    s_cmp_eq_u32 s93, s90
    s_cselect_b32 s93, s94, s93
    buffer_load_dwordx4 v224, s[24:27], s93 offen lds
    s_mov_b32 s59, 0x20000
    s_mov_b32 s48, s22
    s_and_b32 s49, s23, 0xffff
    buffer_load_dwordx4 v225, s[24:27], s93 offen offset:1024 lds
    s_mov_b32 s50, 268435456
    s_mov_b32 s51, 0x20000
    s_mov_b32 s40, s10
    buffer_load_dwordx4 v226, s[24:27], s93 offen offset:2048 lds
    s_and_b32 s41, s11, 0xffff
    s_mov_b32 s42, 663552
    s_mov_b32 s43, 0x20000
    buffer_load_dwordx4 v227, s[24:27], s93 offen offset:3072 lds
    s_mov_b32 s36, s16
    s_and_b32 s37, s17, 0xffff
    s_mov_b32 s38, 5308416
    s_add_u32 m0, s84, 39168
    s_add_u32 s93, s93, 128
    s_cmp_eq_u32 s93, s90
    s_cselect_b32 s93, s94, s93
    buffer_load_dwordx4 v224, s[24:27], s93 offen lds
    s_mov_b32 s39, 0x20000
    s_mov_b32 s44, s18
    s_and_b32 s45, s19, 0xffff
    buffer_load_dwordx4 v225, s[24:27], s93 offen offset:1024 lds
    s_mov_b32 s46, 2359296
    s_mov_b32 s47, 0x20000
    s_mov_b32 s52, s20
    buffer_load_dwordx4 v226, s[24:27], s93 offen offset:2048 lds
    s_and_b32 s53, s21, 0xffff
    s_mov_b32 s54, 256
    s_mov_b32 s55, 0x20000
    buffer_load_dwordx4 v227, s[24:27], s93 offen offset:3072 lds
    s_mov_b32 s85, 0xffff0000
    s_mov_b32 s100, 0x01010101
    v_lshlrev_b32 v30, 4, v1
    v_mov_b32 v254, 1
    v_lshlrev_b32 v255, 6, s62
    v_lshrrev_b32 v203, 5, v1
    v_and_b32 v204, 31, v1
    v_bfe_u32 v205, v1, 2, 2
    v_and_b32 v206, 3, v1
    v_bfe_u32 v207, v1, 4, 1
    v_xor_b32 v208, v190, v203
    v_lshlrev_b32 v209, 7, v204
    v_lshl_add_u32 v208, v208, 4, v209
    s_add_u32 s96, s84, 6400
    s_add_u32 s97, s91, 71936
    v_add_u32 v228, s96, v208
    v_add_u32 v232, s97, v208
    v_xor_b32 v229, 32, v228
    v_xor_b32 v233, 32, v232
    v_xor_b32 v230, 64, v228
    v_xor_b32 v234, 64, v232
    v_xor_b32 v231, 96, v228
    v_xor_b32 v235, 96, v232
    v_bfe_u32 v208, v1, 2, 1
    v_mov_b32 v209, 0x3f803f80
    v_cmp_eq_u32 vcc, v208, v207
    s_nop 1
    v_cndmask_b32 v156, 0, v209, vcc
    v_cndmask_b32 v157, 0, v209, vcc
    v_cndmask_b32 v158, 0, v209, vcc
    v_cndmask_b32 v159, 0, v209, vcc
    s_mul_i32 s97, s61, 72
    s_and_b32 s97, s97, -16
    s_lshr_b32 s98, s61, 1
    s_mul_i32 s98, s98, 1152
    s_mul_i32 s64, s86, 221184
    s_add_u32 s64, s64, s97
    s_mul_i32 s73, s86, 589824
    s_add_u32 s73, s73, s98
    s_add_u32 s86, s86, 1
    s_cmp_eq_u32 s86, 9
    s_cselect_b32 s86, 0, s86
    s_mul_i32 s65, s86, 221184
    s_add_u32 s65, s65, s97
    s_mul_i32 s74, s86, 589824
    s_add_u32 s74, s74, s98
    s_add_u32 s86, s86, 1
    s_cmp_eq_u32 s86, 9
    s_cselect_b32 s86, 0, s86
    s_mul_i32 s66, s86, 221184
    s_add_u32 s66, s66, s97
    s_mul_i32 s75, s86, 589824
    s_add_u32 s75, s75, s98
    s_add_u32 s86, s86, 1
    s_cmp_eq_u32 s86, 9
    s_cselect_b32 s86, 0, s86
    s_mul_i32 s67, s86, 221184
    s_add_u32 s67, s67, s97
    s_mul_i32 s76, s86, 589824
    s_add_u32 s76, s76, s98
    s_add_u32 s86, s86, 1
    s_cmp_eq_u32 s86, 9
    s_cselect_b32 s86, 0, s86
    s_mul_i32 s68, s86, 221184
    s_add_u32 s68, s68, s97
    s_mul_i32 s77, s86, 589824
    s_add_u32 s77, s77, s98
    s_add_u32 s86, s86, 1
    s_cmp_eq_u32 s86, 9
    s_cselect_b32 s86, 0, s86
    s_mul_i32 s69, s86, 221184
    s_add_u32 s69, s69, s97
    s_mul_i32 s78, s86, 589824
    s_add_u32 s78, s78, s98
    s_add_u32 s86, s86, 1
    s_cmp_eq_u32 s86, 9
    s_cselect_b32 s86, 0, s86
    s_mul_i32 s70, s86, 221184
    s_add_u32 s70, s70, s97
    s_mul_i32 s79, s86, 589824
    s_add_u32 s79, s79, s98
    s_add_u32 s86, s86, 1
    s_cmp_eq_u32 s86, 9
    s_cselect_b32 s86, 0, s86
    s_mul_i32 s71, s86, 221184
    s_add_u32 s71, s71, s97
    s_mul_i32 s80, s86, 589824
    s_add_u32 s80, s80, s98
    s_add_u32 s86, s86, 1
    s_cmp_eq_u32 s86, 9
    s_cselect_b32 s86, 0, s86
    s_mul_i32 s72, s86, 221184
    s_add_u32 s72, s72, s97
    s_mul_i32 s81, s86, 589824
    s_add_u32 s81, s81, s98
    s_and_b32 s87, s89, 0
    s_lshr_b32 s88, s89, 1
    s_and_b32 s88, s88, 3
    s_and_b32 s89, s61, 1
    s_mov_b32 s86, 0x3fb8aa3b
    s_lshl_b32 s82, s62, 10
    s_lshl_b32 s83, s62, 11
    s_lshl_b32 s96, s62, 2
    v_subrev_u32 v208, s96, v1
    v_and_b32 v208, 15, v208
    v_min_u32 v208, 14, v208
    v_mul_u32_u24 v209, 13, v208
    v_lshrrev_b32 v209, 6, v209
    s_mov_b32 s96, 0x24310
    s_cmp_eq_u32 s89, 0
    s_cselect_b32 s96, 0x43102, s96
    v_mul_u32_u24 v210, 20, v209
    v_lshlrev_b32 v208, 2, v208
    v_sub_u32 v208, v208, v210
    v_lshrrev_b32 v208, v208, s96
    v_and_b32 v208, 7, v208
    v_mul_u32_u24 v210, 1152, v209
    v_lshl_add_u32 v208, v208, 4, v210
    v_lshrrev_b32 v209, 4, v1
    v_mul_u32_u24 v209, 13824, v209
    s_mul_i32 s96, s62, 3456
    v_add3_u32 v14, v208, v209, s96
    v_add_u32 v15, 54272, v14
    v_add_u32 v16, 108544, v14
    v_add_u32 v17, 162816, v14
    v_xor_b32 v208, s89, v207
    v_lshlrev_b32 v208, 2, v208
    v_xor_b32 v208, v208, v190
    v_mul_u32_u24 v209, 9216, v189
    v_lshl_add_u32 v208, v208, 4, v209
    s_mul_i32 s101, s89, 640
    s_lshr_b32 s96, s62, 1
    s_lshl_b32 s96, s96, 7
    s_add_u32 s96, s96, s101
    s_and_b32 s99, s62, 1
    s_mul_i32 s99, s99, 294912
    s_add_u32 s96, s96, s99
    v_add_u32 v18, s96, v208
    v_add_u32 v19, 72704, v18
    v_add_u32 v20, 145408, v18
    v_add_u32 v21, 218112, v18
    s_mul_i32 s97, s62, 147456
    s_add_u32 s97, s97, s101
    s_add_u32 s97, s97, 256
    s_add_u32 s98, s101, 384
    s_cmp_lt_u32 s62, 2
    s_cselect_b32 s98, s98, 512
    s_add_u32 s98, s98, s99
    s_sub_u32 s98, s98, s97
    s_sub_u32 s97, s97, s96
    s_xor_b32 s101, s95, 256
    v_lshlrev_b32 v208, 5, v207
    v_lshl_add_u32 v208, v205, 7, v208
    v_lshl_add_u32 v208, v206, 3, v208
    v_bfe_u32 v209, v1, 3, 1
    v_lshl_add_u32 v208, v209, 6, v208
    v_lshl_add_u32 v2, v203, 10, v208
    v_xor_b32 v4, 64, v2
    v_add_u32 v3, 64512, v2
    v_add_u32 v5, 64512, v4
    v_lshrrev_b32 v208, 1, v206
    v_lshl_add_u32 v211, v207, 1, v208
    v_and_b32 v212, 1, v206
    s_mov_b32 s92, 0x76548321
    s_cmp_eq_u32 s89, 0
    s_cselect_b32 s92, 0x87615432, s92
    v_lshl_add_u32 v213, v212, 2, v211
    v_lshlrev_b32 v213, 2, v213
    v_lshrrev_b32 v213, v213, s92
    v_and_b32 v213, 15, v213
    s_mul_i32 s92, s89, 9
    v_lshlrev_b32 v209, 12, v205
    v_lshl_add_u32 v209, v203, 9, v209
    v_lshl_add_u32 v208, v205, 3, v213
    v_add_u32 v208, 0, v208
    v_and_b32 v208, 31, v208
    v_lshl_add_u32 v6, v208, 3, v209
    v_add_u32 v7, 64512, v6
    v_lshl_add_u32 v208, v205, 3, v213
    v_add_u32 v208, 10, v208
    v_and_b32 v208, 31, v208
    v_lshl_add_u32 v8, v208, 3, v209
    v_add_u32 v9, 64512, v8
    v_lshl_add_u32 v208, v205, 3, v213
    v_add_u32 v208, 20, v208
    v_and_b32 v208, 31, v208
    v_lshl_add_u32 v10, v208, 3, v209
    v_add_u32 v11, 64512, v10
    v_min_u32 v208, 2, v211
    v_mul_u32_u24 v208, 10, v208
    v_lshl_add_u32 v208, v205, 3, v208
    v_add_u32 v208, s92, v208
    v_and_b32 v208, 31, v208
    v_lshl_add_u32 v12, v208, 3, v209
    v_add_u32 v13, 64512, v12
    v_mul_u32_u24 v208, 40, v205
    v_mov_b32 v210, 4800
    v_mul_u32_u24 v209, 800, v203
    v_add_u32 v209, v209, v208
    v_lshl_add_u32 v22, v211, 3, v209
    v_add_u32 v23, 32, v209
    v_cmp_eq_u32 vcc, v203, v212
    s_nop 1
    v_cndmask_b32 v22, v210, v22, vcc
    v_cndmask_b32 v23, v210, v23, vcc
    v_cmp_eq_u32 vcc, 0, v211
    s_nop 1
    v_cndmask_b32 v23, v210, v23, vcc
    v_mul_u32_u24 v209, 1600, v203
    v_add_u32 v209, v209, v208
    v_add_u32 v209, 1600, v209
    v_lshl_add_u32 v24, v211, 3, v209
    v_add_u32 v25, 32, v209
    v_cmp_eq_u32 vcc, v203, v212
    s_nop 1
    v_cndmask_b32 v24, v210, v24, vcc
    v_cndmask_b32 v25, v210, v25, vcc
    v_cmp_eq_u32 vcc, 0, v211
    s_add_u32 m0, s84, 55552
    s_add_u32 s93, s93, 128
    s_cmp_eq_u32 s93, s90
    s_cselect_b32 s93, s94, s93
    buffer_load_dwordx4 v224, s[24:27], s93 offen lds
    v_cndmask_b32 v25, v210, v25, vcc
    s_mul_i32 s96, s62, 8640
    s_add_u32 s96, s96, 129280
    buffer_load_dwordx4 v225, s[24:27], s93 offen offset:1024 lds
    v_and_b32 v208, 1, v1
    v_mul_u32_u24 v208, 576, v208
    v_bfe_u32 v209, v1, 1, 1
    buffer_load_dwordx4 v226, s[24:27], s93 offen offset:2048 lds
    v_lshl_add_u32 v208, v209, 7, v208
    v_lshl_add_u32 v208, v203, 8, v208
    v_lshrrev_b32 v209, 2, v204
    buffer_load_dwordx4 v227, s[24:27], s93 offen offset:3072 lds
    v_mul_u32_u24 v209, 1080, v209
    v_add3_u32 v26, v208, v209, s96
    v_and_b32 v208, 1, v205
    buffer_load_dword v251, v250, s[28:31], 0 offen
    buffer_load_dword v251, v250, s[32:35], 0 offen
    s_waitcnt vmcnt(14)
    ds_read_b128 a[0:3], v228
    ds_read_b128 a[4:7], v229
    ds_read_b128 a[8:11], v230
    ds_read_b128 a[12:15], v231
    s_add_u32 m0, s91, 71936
    s_add_u32 s93, s93, 128
    s_cmp_eq_u32 s93, s90
    s_cselect_b32 s93, s94, s93
    buffer_load_dwordx4 v224, s[24:27], s93 offen lds
    buffer_load_dwordx4 v225, s[24:27], s93 offen offset:1024 lds
    s_waitcnt lgkmcnt(3)
    v_mfma_f32_32x32x16_bf16 v[136:151], a[0:3], a[0:3], 0
    v_mul_u32_u24 v208, 576, v208
    v_lshrrev_b32 v209, 1, v205
    v_lshl_add_u32 v208, v209, 7, v208
    v_mul_u32_u24 v209, 2160, v203
    v_mfma_f32_16x16x32_bf16 v[152:155], v[156:159], a[0:3], 0
    v_add_u32 v208, v208, v209
    v_lshlrev_b32 v209, 3, v206
    buffer_load_dwordx4 v226, s[24:27], s93 offen offset:2048 lds
    s_waitcnt lgkmcnt(2)
    v_mfma_f32_32x32x16_bf16 v[136:151], a[4:7], a[4:7], v[136:151]
    v_lshl_add_u32 v209, v207, 5, v209
    s_lshr_b32 s96, s62, 1
    s_lshl_b32 s96, s96, 8
    s_add_u32 s96, s96, 129280
    v_mfma_f32_16x16x32_bf16 v[152:155], v[156:159], a[4:7], v[152:155]
    s_and_b32 s92, s62, 1
    s_mul_i32 s92, s92, 40
    buffer_load_dwordx4 v227, s[24:27], s93 offen offset:3072 lds
    s_waitcnt lgkmcnt(1)
    v_mfma_f32_32x32x16_bf16 v[136:151], a[8:11], a[8:11], v[136:151]
    s_add_u32 s92, s92, s96
    v_add3_u32 v28, v208, v209, s92
    v_min_u32 v209, 32, v209
    s_add_u32 s92, s96, 80
    v_mfma_f32_16x16x32_bf16 v[152:155], v[156:159], a[8:11], v[152:155]
    v_add3_u32 v27, v208, v209, s92
    s_mul_i32 s96, s62, 147456
    buffer_load_dword v194, v193, s[56:59], 0 offen
    s_cmp_lg_u32 s61, 0
    s_cbranch_scc1 L_noclr
    buffer_store_dwordx4 v[196:199], v200, s[48:51], s95 offen sc1
L_noclr:
    buffer_load_dword v195, v193, s[56:59], 0 offen offset:1024
    s_waitcnt vmcnt(16)
    ds_read_b128 a[16:19], v228 offset:16384
    ds_read_b128 a[20:23], v229 offset:16384
    ds_read_b128 a[24:27], v230 offset:16384
    ds_read_b128 a[28:31], v231 offset:16384
    s_add_u32 m0, s91, 76032
    s_add_u32 s93, s93, 128
    s_cmp_eq_u32 s93, s90
    s_cselect_b32 s93, s94, s93
    buffer_load_dwordx4 v224, s[24:27], s93 offen lds
    s_waitcnt lgkmcnt(4)
    v_mfma_f32_32x32x16_bf16 v[136:151], a[12:15], a[12:15], v[136:151]
    v_mul_u32_u24 v208, 73728, v207
    v_and_b32 v209, 15, v1
    v_lshl_add_u32 v208, v209, 4, v208
    v_lshl_add_u32 v208, v203, 8, v208
    v_mfma_f32_16x16x32_bf16 v[152:155], v[156:159], a[12:15], v[152:155]
    v_add_u32 v29, s96, v208
    v_bfe_u32 v208, v1, 2, 1
    buffer_load_dwordx4 v225, s[24:27], s93 offen offset:1024 lds
    s_waitcnt lgkmcnt(3)
    v_mfma_f32_32x32x16_bf16 v[136:151], a[16:19], a[16:19], v[136:151]
    v_bfe_u32 v209, v1, 3, 1
    v_bfe_u32 v210, v1, 1, 1
    v_lshl_add_u32 v209, v209, 1, v210
    v_and_b32 v210, 1, v1
    v_mfma_f32_16x16x32_bf16 v[152:155], v[156:159], a[16:19], v[152:155]
    v_lshlrev_b32 v210, 4, v210
    v_mov_b32 v214, 0x3f80
    buffer_load_dwordx4 v226, s[24:27], s93 offen offset:2048 lds
    s_waitcnt lgkmcnt(2)
    v_mfma_f32_32x32x16_bf16 v[136:151], a[20:23], a[20:23], v[136:151]
    v_lshlrev_b32 v210, v210, v214
    v_cmp_eq_u32 vcc, v208, v203
    s_nop 1
    v_cndmask_b32 v210, 0, v210, vcc
    v_lshl_add_u32 v209, v207, 2, v209
    v_mfma_f32_16x16x32_bf16 v[152:155], v[156:159], a[20:23], v[152:155]
    v_cmp_eq_u32 vcc, 0, v209
    s_nop 1
    v_cndmask_b32 v32, 0, v210, vcc
    buffer_load_dwordx4 v227, s[24:27], s93 offen offset:3072 lds
    s_waitcnt lgkmcnt(1)
    v_mfma_f32_32x32x16_bf16 v[136:151], a[24:27], a[24:27], v[136:151]
    v_cmp_eq_u32 vcc, 1, v209
    s_nop 1
    v_cndmask_b32 v33, 0, v210, vcc
    v_cmp_eq_u32 vcc, 2, v209
    s_nop 1
    v_cndmask_b32 v34, 0, v210, vcc
    v_mfma_f32_16x16x32_bf16 v[152:155], v[156:159], a[24:27], v[152:155]
    v_cmp_eq_u32 vcc, 3, v209
    s_nop 1
    v_cndmask_b32 v35, 0, v210, vcc
    s_waitcnt vmcnt(16)
    ds_read_b128 a[32:35], v228 offset:32768
    ds_read_b128 a[36:39], v229 offset:32768
    ds_read_b128 a[40:43], v230 offset:32768
    ds_read_b128 a[44:47], v231 offset:32768
    s_add_u32 m0, s91, 80128
    s_add_u32 s93, s93, 128
    s_cmp_eq_u32 s93, s90
    s_cselect_b32 s93, s94, s93
    buffer_load_dwordx4 v224, s[24:27], s93 offen lds
    s_waitcnt lgkmcnt(4)
    v_mfma_f32_32x32x16_bf16 v[136:151], a[28:31], a[28:31], v[136:151]
    v_cmp_eq_u32 vcc, 4, v209
    s_nop 1
    v_cndmask_b32 v36, 0, v210, vcc
    v_cmp_eq_u32 vcc, 5, v209
    s_nop 1
    v_cndmask_b32 v37, 0, v210, vcc
    v_mfma_f32_16x16x32_bf16 v[152:155], v[156:159], a[28:31], v[152:155]
    v_cmp_eq_u32 vcc, 6, v209
    s_nop 1
    v_cndmask_b32 v38, 0, v210, vcc
    buffer_load_dwordx4 v225, s[24:27], s93 offen offset:1024 lds
    s_waitcnt lgkmcnt(3)
    v_mfma_f32_32x32x16_bf16 v[136:151], a[32:35], a[32:35], v[136:151]
    v_cmp_eq_u32 vcc, 7, v209
    s_nop 1
    v_cndmask_b32 v39, 0, v210, vcc
    v_lshrrev_b32 v252, 5, v1
    v_lshlrev_b32 v252, 9, v252
    v_mfma_f32_16x16x32_bf16 v[152:155], v[156:159], a[32:35], v[152:155]
    v_sub_u32 v236, v2, v252
    v_sub_u32 v237, v3, v252
    buffer_load_dwordx4 v226, s[24:27], s93 offen offset:2048 lds
    s_waitcnt lgkmcnt(2)
    v_mfma_f32_32x32x16_bf16 v[136:151], a[36:39], a[36:39], v[136:151]
    v_sub_u32 v238, v4, v252
    v_sub_u32 v239, v5, v252
    v_bfe_u32 v252, v1, 4, 1
    v_xor_b32 v252, s89, v252
    v_mfma_f32_16x16x32_bf16 v[152:155], v[156:159], a[36:39], v[152:155]
    v_lshlrev_b32 v252, 2, v252
    v_and_b32 v253, 7, v1
    buffer_load_dwordx4 v227, s[24:27], s93 offen offset:3072 lds
    s_waitcnt lgkmcnt(1)
    v_mfma_f32_32x32x16_bf16 v[136:151], a[40:43], a[40:43], v[136:151]
    v_xor_b32 v252, v252, v253
    v_lshrrev_b32 v253, 3, v1
    v_mul_u32_u24 v253, 1152, v253
    v_lshl_add_u32 v252, v252, 4, v253
    v_mfma_f32_16x16x32_bf16 v[152:155], v[156:159], a[40:43], v[152:155]
    s_and_b32 s12, s62, 1
    s_mul_i32 s12, s12, 18432
    s_waitcnt vmcnt(16)
    ds_read_b128 a[48:51], v228 offset:49152
    ds_read_b128 a[52:55], v229 offset:49152
    ds_read_b128 a[56:59], v230 offset:49152
    ds_read_b128 a[60:63], v231 offset:49152
    s_add_u32 m0, s91, 84224
    s_add_u32 s93, s93, 128
    s_cmp_eq_u32 s93, s90
    s_cselect_b32 s93, s94, s93
    buffer_load_dwordx4 v224, s[24:27], s93 offen lds
    s_waitcnt lgkmcnt(4)
    v_mfma_f32_32x32x16_bf16 v[136:151], a[44:47], a[44:47], v[136:151]
    s_mul_i32 s13, s89, 36864
    s_add_u32 s13, s13, s12
    v_add_u32 v240, s13, v252
    v_add_u32 v241, 8192, v240
    v_mfma_f32_16x16x32_bf16 v[152:155], v[156:159], a[44:47], v[152:155]
    s_mul_i32 s13, s89, -36864
    s_add_u32 s13, s13, s12
    buffer_load_dwordx4 v225, s[24:27], s93 offen offset:1024 lds
    s_waitcnt lgkmcnt(3)
    v_mfma_f32_32x32x16_bf16 v[136:151], a[48:51], a[48:51], v[136:151]
    s_add_u32 s13, s13, 36864
    v_add_u32 v242, s13, v252
    v_add_u32 v243, 8192, v242
    s_lshr_b32 s13, s62, 1
    v_mfma_f32_16x16x32_bf16 v[152:155], v[156:159], a[48:51], v[152:155]
    s_xor_b32 s13, s13, s61
    s_mul_i32 s13, s13, 41472
    buffer_load_dwordx4 v226, s[24:27], s93 offen offset:2048 lds
    s_waitcnt lgkmcnt(2)
    v_mfma_f32_32x32x16_bf16 v[136:151], a[52:55], a[52:55], v[136:151]
    s_lshr_b32 s12, s12, 1
    s_add_u32 s13, s13, s12
    v_add_u32 v244, s13, v252
    v_add_u32 v245, 22016, v244
    v_mfma_f32_16x16x32_bf16 v[152:155], v[156:159], a[52:55], v[152:155]
    s_lshr_b32 s13, s61, 1
    s_mul_i32 s13, s13, 663552
    buffer_load_dwordx4 v227, s[24:27], s93 offen offset:3072 lds
    s_waitcnt lgkmcnt(1)
    v_mfma_f32_32x32x16_bf16 v[136:151], a[56:59], a[56:59], v[136:151]
    s_lshr_b32 s12, s62, 1
    s_add_u32 s0, s12, s87
    s_add_u32 s1, s0, 2
    s_and_b32 s0, s0, 3
    v_mfma_f32_16x16x32_bf16 v[152:155], v[156:159], a[56:59], v[152:155]
    s_mul_i32 s0, s0, 73728
    s_add_u32 s0, s0, s13
    s_waitcnt vmcnt(14)
    ds_read_b128 a[64:67], v232
    ds_read_b128 a[68:71], v233
    ds_read_b128 a[72:75], v234
    ds_read_b128 a[76:79], v235
    s_add_u32 m0, s91, 88320
    s_add_u32 s93, s93, 128
    s_cmp_eq_u32 s93, s90
    s_cselect_b32 s93, s94, s93
    buffer_load_dwordx4 v224, s[24:27], s93 offen lds
    s_waitcnt lgkmcnt(4)
    v_mfma_f32_32x32x16_bf16 v[136:151], a[60:63], a[60:63], v[136:151]
    s_and_b32 s1, s1, 3
    s_mul_i32 s1, s1, 73728
    s_add_u32 s1, s1, s13
    s_mul_i32 s99, s89, -73728
    v_mfma_f32_16x16x32_bf16 v[152:155], v[156:159], a[60:63], v[152:155]
    s_add_u32 s99, s99, 36864
    s_mul_i32 s99, s99, s12
    buffer_load_dwordx4 v225, s[24:27], s93 offen offset:1024 lds
    s_waitcnt lgkmcnt(3)
    v_mfma_f32_32x32x16_bf16 v[136:151], a[64:67], a[64:67], v[136:151]
    s_add_u32 s99, s99, s13
    s_add_u32 s99, s99, 294912
    s_mul_i32 s12, s89, 368640
    s_sub_u32 s13, 368640, s12
    v_mfma_f32_16x16x32_bf16 v[152:155], v[156:159], a[64:67], v[152:155]
    s_add_u32 s3, s0, s13
    s_add_u32 s0, s0, s12
    buffer_load_dwordx4 v226, s[24:27], s93 offen offset:2048 lds
    s_waitcnt lgkmcnt(2)
    v_mfma_f32_32x32x16_bf16 v[136:151], a[68:71], a[68:71], v[136:151]
    s_add_u32 s9, s1, s13
    s_add_u32 s1, s1, s12
    s_mul_i32 s12, s89, 640
    s_add_u32 s13, s88, 0
    v_mfma_f32_16x16x32_bf16 v[152:155], v[156:159], a[68:71], v[152:155]
    s_and_b32 s13, s13, 3
    s_lshl_b32 s13, s13, 7
    buffer_load_dwordx4 v227, s[24:27], s93 offen offset:3072 lds
    s_waitcnt lgkmcnt(1)
    v_mfma_f32_32x32x16_bf16 v[136:151], a[72:75], a[72:75], v[136:151]
    s_add_u32 s19, s13, s12
    s_add_u32 s13, s88, 1
    s_and_b32 s13, s13, 3
    s_lshl_b32 s13, s13, 7
    v_mfma_f32_16x16x32_bf16 v[152:155], v[156:159], a[72:75], v[152:155]
    s_add_u32 s10, s13, s12
    s_add_u32 s13, s88, 2
    s_waitcnt vmcnt(12)
    ds_read_b128 a[80:83], v232 offset:4096
    ds_read_b128 a[84:87], v233 offset:4096
    ds_read_b128 a[88:91], v234 offset:4096
    ds_read_b128 a[92:95], v235 offset:4096
    s_waitcnt lgkmcnt(4)
    v_mfma_f32_32x32x16_bf16 v[136:151], a[76:79], a[76:79], v[136:151]
    s_and_b32 s13, s13, 3
    s_lshl_b32 s13, s13, 7
    s_add_u32 s11, s13, s12
    s_add_u32 s13, s88, 3
    v_mfma_f32_16x16x32_bf16 v[152:155], v[156:159], a[76:79], v[152:155]
    s_and_b32 s13, s13, 3
    s_lshl_b32 s13, s13, 7
    s_barrier
    s_add_u32 m0, s84, 6400
    s_add_u32 s16, s13, s12
    buffer_load_dwordx4 v14, s[28:31], s64 offen lds
    s_waitcnt lgkmcnt(3)
    v_mfma_f32_32x32x16_bf16 v[136:151], a[80:83], a[80:83], v[136:151]
    v_add_u32 v246, s82, v30
    v_and_b32 v253, 15, v1
    v_mul_u32_u24 v253, 1152, v253
    v_and_b32 v252, 48, v1
    v_mfma_f32_16x16x32_bf16 v[152:155], v[156:159], a[80:83], v[152:155]
    v_add_u32 v247, v252, v253
    v_lshrrev_b32 v252, 3, v1
    buffer_load_dwordx4 v15, s[28:31], s64 offen offset:1024 lds
    s_waitcnt lgkmcnt(2)
    v_mfma_f32_32x32x16_bf16 v[136:151], a[84:87], a[84:87], v[136:151]
    v_add_u32 v252, s88, v252
    v_and_b32 v252, 3, v252
    v_lshl_add_u32 v252, v252, 7, s12
    v_mov_b32 v253, 512
    v_mfma_f32_16x16x32_bf16 v[152:155], v[156:159], a[84:87], v[152:155]
    v_cmp_gt_u32 vcc, 32, v1
    s_nop 1
    v_cndmask_b32 v252, v253, v252, vcc
    s_waitcnt lgkmcnt(1)
    v_mfma_f32_32x32x16_bf16 v[136:151], a[88:91], a[88:91], v[136:151]
    v_and_b32 v253, 7, v1
    s_lshl_b32 s13, s89, 2
    v_xor_b32 v253, s13, v253
    v_lshl_add_u32 v248, v253, 4, v252
    v_mfma_f32_16x16x32_bf16 v[152:155], v[156:159], a[88:91], v[152:155]
    s_and_b32 s13, s62, 1
    s_xor_b32 s13, s13, s61
    s_waitcnt vmcnt(10)
    ds_read_b128 a[96:99], v232 offset:8192
    ds_read_b128 a[100:103], v233 offset:8192
    ds_read_b128 a[104:107], v234 offset:8192
    ds_read_b128 a[108:111], v235 offset:8192
    s_waitcnt lgkmcnt(4)
    v_mfma_f32_32x32x16_bf16 v[136:151], a[92:95], a[92:95], v[136:151]
    s_mul_i32 s13, s13, 36
    s_and_b32 s12, s62, 2
    s_add_u32 s13, s13, s12
    s_add_u32 s13, s13, 16
    v_mfma_f32_16x16x32_bf16 v[152:155], v[156:159], a[92:95], v[152:155]
    s_mul_i32 s13, s13, 1152
    s_add_u32 s12, s13, 128
    buffer_load_dwordx4 v16, s[28:31], s64 offen offset:2048 lds
    s_waitcnt lgkmcnt(3)
    v_mfma_f32_32x32x16_bf16 v[136:151], a[96:99], a[96:99], v[136:151]
    v_bfe_u32 v252, v1, 2, 2
    v_lshrrev_b32 v253, 5, v1
    v_lshl_add_u32 v252, v253, 2, v252
    v_lshlrev_b32 v252, 10, v252
    v_mfma_f32_16x16x32_bf16 v[152:155], v[156:159], a[96:99], v[152:155]
    v_bfe_u32 v253, v1, 4, 1
    v_lshl_add_u32 v252, v253, 5, v252
    buffer_load_dwordx4 v17, s[28:31], s64 offen offset:3072 lds
    s_waitcnt lgkmcnt(2)
    v_mfma_f32_32x32x16_bf16 v[136:151], a[100:103], a[100:103], v[136:151]
    v_and_b32 v253, 3, v1
    v_lshl_add_u32 v252, v253, 3, v252
    v_add_u32 v249, 129280, v252
    v_add_u32 v208, 0, v0
    v_mfma_f32_16x16x32_bf16 v[152:155], v[156:159], a[100:103], v[152:155]
    v_min_u32 v208, 323, v208
    v_mul_u32_u24 v209, 7282, v208
    s_waitcnt lgkmcnt(1)
    v_mfma_f32_32x32x16_bf16 v[136:151], a[104:107], a[104:107], v[136:151]
    v_lshrrev_b32 v209, 16, v209
    v_mul_u32_u24 v210, 9, v209
    v_sub_u32 v210, v208, v210
    v_add_u32 v208, 20, v209
    v_mfma_f32_16x16x32_bf16 v[152:155], v[156:159], a[104:107], v[152:155]
    v_subrev_u32 v215, 18, v209
    v_cmp_gt_u32 vcc, 2, v215
    s_waitcnt vmcnt(8)
    ds_read_b128 a[112:115], v232 offset:12288
    ds_read_b128 a[116:119], v233 offset:12288
    ds_read_b128 a[120:123], v234 offset:12288
    ds_read_b128 a[124:127], v235 offset:12288
    s_waitcnt lgkmcnt(4)
    v_mfma_f32_32x32x16_bf16 v[136:151], a[108:111], a[108:111], v[136:151]
    v_cndmask_b32 v209, v209, v208, vcc
    v_mul_u32_u24 v215, 40, v209
    v_lshl_add_u32 v215, v210, 2, v215
    v_add_u32 v208, 256, v0
    v_mfma_f32_16x16x32_bf16 v[152:155], v[156:159], a[108:111], v[152:155]
    v_min_u32 v208, 323, v208
    v_mul_u32_u24 v209, 7282, v208
    s_add_u32 m0, s84, 22784
    v_lshrrev_b32 v209, 16, v209
    buffer_load_dwordx4 v18, s[32:35], s73 offen lds
    s_waitcnt lgkmcnt(3)
    v_mfma_f32_32x32x16_bf16 v[136:151], a[112:115], a[112:115], v[136:151]
    v_mul_u32_u24 v210, 9, v209
    v_sub_u32 v210, v208, v210
    v_add_u32 v208, 20, v209
    v_subrev_u32 v216, 18, v209
    v_mfma_f32_16x16x32_bf16 v[152:155], v[156:159], a[112:115], v[152:155]
    v_cmp_gt_u32 vcc, 2, v216
    s_nop 1
    v_cndmask_b32 v209, v209, v208, vcc
    buffer_load_dwordx4 v19, s[32:35], s73 offen offset:1024 lds
    s_waitcnt lgkmcnt(2)
    v_mfma_f32_32x32x16_bf16 v[136:151], a[116:119], a[116:119], v[136:151]
    v_mul_u32_u24 v216, 40, v209
    v_lshl_add_u32 v216, v210, 2, v216
    v_cmp_gt_u32 vcc, 68, v0
    v_mov_b32 v208, 163824
    v_mfma_f32_16x16x32_bf16 v[152:155], v[156:159], a[116:119], v[152:155]
    v_cndmask_b32 v216, v208, v216, vcc
    v_accvgpr_write_b32 a184, 0
    s_waitcnt lgkmcnt(1)
    v_mfma_f32_32x32x16_bf16 v[136:151], a[120:123], a[120:123], v[136:151]
    v_accvgpr_write_b32 a185, 0
    v_accvgpr_write_b32 a188, 0
    v_accvgpr_write_b32 a189, 0
    v_accvgpr_write_b32 a200, 0
    v_mfma_f32_16x16x32_bf16 v[152:155], v[156:159], a[120:123], v[152:155]
    v_accvgpr_write_b32 a201, 0
    v_accvgpr_write_b32 a204, 0
    s_waitcnt vmcnt(6)
    ds_read_b128 a[128:131], v232 offset:16384
    ds_read_b128 a[132:135], v233 offset:16384
    ds_read_b128 a[136:139], v234 offset:16384
    ds_read_b128 a[140:143], v235 offset:16384
    s_waitcnt lgkmcnt(4)
    v_mfma_f32_32x32x16_bf16 v[136:151], a[124:127], a[124:127], v[136:151]
    v_accvgpr_write_b32 a205, 0
    s_mov_b32 vcc_lo, 0xaaaaaaaa
    s_mov_b32 vcc_hi, 0xaaaaaaaa
    s_mov_b32 s6, 0xcccccccc
    v_mfma_f32_16x16x32_bf16 v[152:155], v[156:159], a[124:127], v[152:155]
    s_mov_b32 s7, 0xcccccccc
    s_mov_b32 s14, 0xff00ff00
    ds_write_b32 v215, v194
    ds_write_b32 v216, v195
    buffer_load_dwordx4 v20, s[32:35], s73 offen offset:2048 lds
    s_waitcnt lgkmcnt(5)
    v_mfma_f32_32x32x16_bf16 v[136:151], a[128:131], a[128:131], v[136:151]
    s_mov_b32 s15, 0xff00ff00
    s_and_b32 s96, s60, 7
    s_lshl_b32 s96, s96, 1
    s_add_u32 s96, s96, s89
    v_mfma_f32_16x16x32_bf16 v[152:155], v[156:159], a[128:131], v[152:155]
    s_lshl_b32 s96, s96, 2
    s_add_u32 s96, s96, s62
    buffer_load_dwordx4 v21, s[32:35], s73 offen offset:3072 lds
    s_waitcnt lgkmcnt(4)
    v_mfma_f32_32x32x16_bf16 v[136:151], a[132:135], a[132:135], v[136:151]
    s_lshr_b32 s92, s61, 1
    s_lshl_b32 s17, s92, 6
    s_add_u32 s17, s17, s96
    s_mul_i32 s96, s96, 82944
    v_mfma_f32_16x16x32_bf16 v[152:155], v[156:159], a[132:135], v[152:155]
    s_mul_i32 s92, s92, 1152
    s_add_u32 s96, s96, s92
    s_waitcnt lgkmcnt(3)
    v_mfma_f32_32x32x16_bf16 v[136:151], a[136:139], a[136:139], v[136:151]
    v_min_u32 v183, 40, v1
    v_lshlrev_b32 v183, 7, v183
    v_min_u32 v180, 44, v1
    v_mul_u32_u24 v181, 13, v180
    v_mfma_f32_16x16x32_bf16 v[152:155], v[156:159], a[136:139], v[152:155]
    v_lshrrev_b32 v181, 6, v181
    v_mul_u32_u24 v182, 5, v181
    s_waitcnt lgkmcnt(2)
    v_mfma_f32_32x32x16_bf16 v[136:151], a[140:143], a[140:143], v[136:151]
    v_sub_u32 v180, v180, v182
    v_add_u32 v182, 1, v180
    v_lshrrev_b32 v182, 2, v182
    v_lshl_add_u32 v180, v182, 1, v180
    v_mfma_f32_16x16x32_bf16 v[152:155], v[156:159], a[140:143], v[152:155]
    v_lshlrev_b32 v180, 7, v180
    v_mul_u32_u24 v181, 9216, v181
    v_add3_u32 v180, v180, v181, s96
    v_mov_b32 v168, -1
    v_mov_b32 v169, -1
    v_mov_b32 v170, -1
    v_mov_b32 v171, -1
    s_lshl_b32 s4, s61, 2
    s_add_u32 s4, s4, s62
    s_lshl_b32 s5, s4, 15
    s_add_u32 s5, s5, 1048576
    v_lshlrev_b32 v177, 2, v1
    v_and_b32 v173, 15, v1
    v_lshl_add_u32 v173, v173, 12, v255
    v_and_b32 v164, 3, v1
    v_lshlrev_b32 v178, 2, v164
    v_lshrrev_b32 v165, 3, v1
    v_mul_u32_u24 v166, 1920, v165
    v_add_u32 v174, v166, v30
    v_add_u32 v175, 16384, v174
    v_lshrrev_b32 v165, 2, v1
    v_lshlrev_b32 v166, 7, v165
    v_lshl_add_u32 v165, v164, 4, v166
    v_accvgpr_write_b32 a251, v165
    v_lshl_add_u32 v165, v164, 3, v166
    v_accvgpr_write_b32 a252, v165
    s_lshr_b32 s4, s62, 1
    s_mul_i32 s4, s4, 160
    s_mul_i32 s8, s62, 720
    s_add_u32 s4, s4, s8
    v_min_u32 v165, 44, v1
    v_lshl_add_u32 v165, v165, 4, s4
    v_accvgpr_write_b32 a254, v165
    s_lshl_b32 s8, s61, 12
    s_add_u32 s4, s4, s8
    s_add_u32 s4, s4, 3145728
    v_lshrrev_b32 v165, 4, v1
    v_lshl_add_u32 v166, v164, 2, v165
    v_and_b32 v165, 1, v165
    v_lshl_add_u32 v165, v164, 1, v165
    v_add_u32 v165, 16, v165
    v_sub_u32 v165, v165, v166
    v_bfe_u32 v164, v1, 2, 1
    v_mad_i32_i24 v166, v164, v165, v166
    v_lshl_add_u32 v166, v166, 1, s4
    v_accvgpr_write_b32 a253, v166
    s_mul_i32 s8, s60, 48
    s_add_u32 s4, s4, s8
    v_add_u32 v176, s4, v177
    v_and_b32 v164, 31, v1
    v_lshrrev_b32 v165, 5, v1
    v_mad_u32_u24 v164, v164, 5, v165
    v_mul_u32_u24 v165, 43, v164
    v_lshrrev_b32 v165, 8, v165
    v_mul_u32_u24 v165, 1952, v165
    v_lshl_add_u32 v165, v164, 4, v165
    v_accvgpr_write_b32 a248, v165
    v_add_u32 v164, 2, v164
    v_mul_u32_u24 v165, 43, v164
    v_lshrrev_b32 v165, 8, v165
    v_mul_u32_u24 v165, 1952, v165
    v_lshl_add_u32 v165, v164, 4, v165
    v_accvgpr_write_b32 a249, v165
    v_add_u32 v164, 2, v164
    v_mul_u32_u24 v165, 43, v164
    v_lshrrev_b32 v165, 8, v165
    v_mul_u32_u24 v165, 1952, v165
    v_lshl_add_u32 v165, v164, 4, v165
    v_accvgpr_write_b32 a250, v165
    s_lshl_b32 s4, s60, 7
    s_add_u32 s4, s4, s5
    s_lshl_b32 s96, s63, 2
    s_add_u32 s96, s96, s62
    s_mul_i32 s93, s96, 21504
    s_add_u32 s93, s93, 4194304
    s_xor_b32 s96, s96, 4
    s_mul_i32 s94, s96, 21504
    s_add_u32 s94, s94, 4194304
    s_lshl_b32 s96, s60, 1
    s_add_u32 s96, s96, s89
    s_mul_i32 s96, s96, 589824
    s_lshr_b32 s92, s61, 1
    s_mul_i32 s92, s92, 9216
    s_add_u32 s96, s96, s92
    s_add_u32 s90, s96, 33554432
    s_add_u32 s91, s96, 33558528
    s_add_u32 s92, s96, 33562624
    s_add_u32 s8, s93, 18432
    s_waitcnt lgkmcnt(0)
    s_barrier
    s_or_b32 s96, s61, s62
    s_cmp_lg_u32 s96, 0
    s_cbranch_scc1 L_nordy
    s_mov_b64 exec, 1
    buffer_store_byte v254, v196, s[52:55], s60 offen sc1
    s_mov_b64 exec, -1
L_nordy:
    s_add_u32 m0, s84, 39168
    s_nop 0
    buffer_load_dwordx4 v14, s[28:31], s65 offen lds
    buffer_load_dwordx4 v15, s[28:31], s65 offen offset:1024 lds
    v_mul_f32 v160, 0x3ae38e39, v152
    v_cndmask_b32 v136, v136, v137, vcc
    v_cndmask_b32 v137, v138, v139, vcc
    v_cndmask_b32 v138, v140, v141, vcc
    v_cndmask_b32 v139, v142, v143, vcc
    v_cndmask_b32 v140, v144, v145, vcc
    v_cndmask_b32 v141, v146, v147, vcc
    v_cndmask_b32 v142, v148, v149, vcc
    v_cndmask_b32 v143, v150, v151, vcc
    v_cvt_pk_bf16_f32 v184, 0, -v160
    s_mov_b32 vcc_lo, 0xffff0000
    s_mov_b32 vcc_hi, 0xffff0000
    v_mov_b32 v185, v184
    v_mov_b32 v186, v184
    v_mov_b32 v187, v184
    v_mov_b32 v188, v184
    v_mov_b32 v189, v184
    v_mov_b32 v190, v184
    v_mov_b32 v191, v184
    v_mov_b32 v192, v184
    v_mov_b32 v193, v184
    v_mov_b32 v194, v184
    v_mov_b32 v195, v184
    v_mov_b32 v196, v184
    v_mov_b32 v197, v184
    v_mov_b32 v198, v184
    v_mov_b32 v199, v184
    v_cndmask_b32_e64 v136, v136, v137, s[6:7]
    v_cndmask_b32_e64 v137, v138, v139, s[6:7]
    v_mfma_f32_32x32x16_bf16 v[200:215], v[32:35], a[0:3], v[184:199]
    buffer_load_dwordx4 v16, s[28:31], s65 offen offset:2048 lds
    v_cndmask_b32_e64 v138, v140, v141, s[6:7]
    v_cndmask_b32_e64 v139, v142, v143, s[6:7]
    s_mov_b32 s6, 0xf0f0f0f0
    s_mov_b32 s7, 0xf0f0f0f0
    v_cndmask_b32_e64 v136, v136, v137, s[14:15]
    v_cndmask_b32_e64 v137, v138, v139, s[14:15]
    v_cndmask_b32 v161, v136, v137, vcc
    v_mov_b32 v162, v161
    v_mfma_f32_32x32x16_bf16 v[200:215], v[36:39], a[4:7], v[200:215]
    buffer_load_dwordx4 v17, s[28:31], s65 offen offset:3072 lds
    v_permlane32_swap_b32 v161, v162
    v_cndmask_b32_e64 v161, v161, v162, s[6:7]
    v_mul_f32 v161, 0x3ae38e39, v161
    v_fma_f32 v161, -v160, v160, v161
    v_max_f32 v161, 0, v161
    v_cvt_pk_bf16_f32 v163, 0, v161
    v_mfma_f32_32x32x16_bf16 v[216:231], v[32:35], a[8:11], v[184:199]
    s_add_u32 m0, s84, 55552
    s_nop 0
    buffer_load_dwordx4 v18, s[32:35], s74 offen lds
    v_add_f32 v163, 0x3727c5ac, v163
    v_cvt_pk_bf16_f32 v163, 0, v163
    v_sqrt_f32 v163, v163
    ds_read_b64_tr_b16 a[176:177], v22
    ds_read_b64_tr_b16 a[178:179], v22 offset:160
    v_cvt_pk_bf16_f32 v163, 0, v163
    v_mfma_f32_32x32x16_bf16 v[216:231], v[36:39], a[12:15], v[216:231]
    buffer_load_dwordx4 v19, s[32:35], s74 offen offset:1024 lds
    v_rcp_f32 v31, v163
    ds_read_b64_tr_b16 a[180:181], v22 offset:320
    ds_read_b64_tr_b16 a[182:183], v22 offset:480
    v_fma_f32 v162, -v163, v31, 1.0
    v_fma_f32 v31, v162, v31, v31
    ds_read_b64_tr_b16 a[186:187], v22 offset:640
    ds_read_b64_tr_b16 a[192:193], v23
    ds_read_b64_tr_b16 a[194:195], v23 offset:160
    ds_read_b64_tr_b16 a[196:197], v23 offset:320
    ds_read_b64_tr_b16 a[198:199], v23 offset:480
    ds_read_b64_tr_b16 a[202:203], v23 offset:640
    buffer_load_dwordx4 v20, s[32:35], s74 offen offset:2048 lds
    v_cvt_pk_bf16_f32 v200, 0, v200
    v_cvt_pk_bf16_f32 v201, 0, v201
    v_mul_f32 v200, v200, v31
    v_mul_f32 v201, v201, v31
    v_cvt_pk_bf16_f32 v232, v200, v201
    v_accvgpr_write_b32 a0, v232
    v_cvt_pk_bf16_f32 v202, 0, v202
    v_cvt_pk_bf16_f32 v203, 0, v203
    v_mul_f32 v202, v202, v31
    v_mul_f32 v203, v203, v31
    v_cvt_pk_bf16_f32 v233, v202, v203
    v_accvgpr_write_b32 a1, v233
    v_cvt_pk_bf16_f32 v204, 0, v204
    v_cvt_pk_bf16_f32 v205, 0, v205
    v_mul_f32 v204, v204, v31
    buffer_load_dwordx4 v21, s[32:35], s74 offen offset:3072 lds
    s_add_u32 m0, s84, 71936
    v_mul_f32 v205, v205, v31
    v_cvt_pk_bf16_f32 v232, v204, v205
    v_accvgpr_write_b32 a2, v232
    v_cvt_pk_bf16_f32 v206, 0, v206
    v_cvt_pk_bf16_f32 v207, 0, v207
    v_mul_f32 v206, v206, v31
    v_mul_f32 v207, v207, v31
    v_cvt_pk_bf16_f32 v233, v206, v207
    v_accvgpr_write_b32 a3, v233
    v_cvt_pk_bf16_f32 v208, 0, v208
    v_cvt_pk_bf16_f32 v209, 0, v209
    v_mul_f32 v208, v208, v31
    v_mul_f32 v209, v209, v31
    v_cvt_pk_bf16_f32 v232, v208, v209
    buffer_load_dwordx4 v14, s[28:31], s66 offen lds
    v_accvgpr_write_b32 a4, v232
    v_cvt_pk_bf16_f32 v210, 0, v210
    v_cvt_pk_bf16_f32 v211, 0, v211
    v_mul_f32 v210, v210, v31
    v_mul_f32 v211, v211, v31
    v_cvt_pk_bf16_f32 v233, v210, v211
    v_accvgpr_write_b32 a5, v233
    v_cvt_pk_bf16_f32 v212, 0, v212
    v_cvt_pk_bf16_f32 v213, 0, v213
    v_mul_f32 v212, v212, v31
    v_mul_f32 v213, v213, v31
    v_cvt_pk_bf16_f32 v232, v212, v213
    v_accvgpr_write_b32 a6, v232
    v_cvt_pk_bf16_f32 v214, 0, v214
    v_cvt_pk_bf16_f32 v215, 0, v215
    v_mul_f32 v214, v214, v31
    v_mul_f32 v215, v215, v31
    v_cvt_pk_bf16_f32 v233, v214, v215
    v_accvgpr_write_b32 a7, v233
    v_mfma_f32_32x32x16_bf16 v[200:215], v[32:35], a[16:19], v[184:199]
    s_waitcnt vmcnt(13)
    s_barrier
    ds_read_b64_tr_b16 a[144:145], v8 offset:6400
    ds_read_b64_tr_b16 a[146:147], v8 offset:6656
    ds_read_b64_tr_b16 a[148:149], v12 offset:6400
    ds_read_b64_tr_b16 a[150:151], v12 offset:6656
    ds_read_b64_tr_b16 a[152:153], v10 offset:6400
    ds_read_b64_tr_b16 a[154:155], v10 offset:6656
    ds_read_b64_tr_b16 a[156:157], v6 offset:6400
    ds_read_b64_tr_b16 a[158:159], v6 offset:6656
    ds_read_b64_tr_b16 a[160:161], v8 offset:7424
    ds_read_b64_tr_b16 a[162:163], v8 offset:7680
    ds_read_b64_tr_b16 a[164:165], v12 offset:7424
    ds_read_b64_tr_b16 a[166:167], v12 offset:7680
    ds_read_b64_tr_b16 a[168:169], v10 offset:7424
    ds_read_b64_tr_b16 a[170:171], v10 offset:7680
    v_mfma_f32_32x32x16_bf16 v[200:215], v[36:39], a[20:23], v[200:215]
    buffer_load_dwordx4 v15, s[28:31], s66 offen offset:1024 lds
    v_cvt_pk_bf16_f32 v216, 0, v216
    v_cvt_pk_bf16_f32 v217, 0, v217
    v_mul_f32 v216, v216, v31
    v_mul_f32 v217, v217, v31
    v_cvt_pk_bf16_f32 v232, v216, v217
    s_waitcnt lgkmcnt(12)
    v_mfma_f32_32x32x16_bf16 v[56:71], a[144:147], a[0:3], 0
    ds_read_b64_tr_b16 a[172:173], v6 offset:7424
    ds_read_b64_tr_b16 a[174:175], v6 offset:7680
    v_accvgpr_write_b32 a8, v232
    v_cvt_pk_bf16_f32 v218, 0, v218
    v_cvt_pk_bf16_f32 v219, 0, v219
    v_mul_f32 v218, v218, v31
    s_waitcnt lgkmcnt(12)
    v_mfma_f32_32x32x16_bf16 v[88:103], a[148:151], a[0:3], 0
    ds_read_b64_tr_b16 a[144:145], v8 offset:8448
    ds_read_b64_tr_b16 a[146:147], v8 offset:8704
    s_waitcnt lgkmcnt(10)
    v_mul_f32 v219, v219, v31
    v_cvt_pk_bf16_f32 v233, v218, v219
    v_accvgpr_write_b32 a9, v233
    v_mfma_f32_32x32x16_bf16 v[72:87], a[152:155], a[0:3], 0
    ds_read_b64_tr_b16 a[148:149], v12 offset:8448
    ds_read_b64_tr_b16 a[150:151], v12 offset:8704
    v_cvt_pk_bf16_f32 v220, 0, v220
    v_cvt_pk_bf16_f32 v221, 0, v221
    v_mul_f32 v220, v220, v31
    v_mul_f32 v221, v221, v31
    v_mfma_f32_32x32x16_bf16 v[40:55], a[156:159], a[0:3], 0
    ds_read_b64_tr_b16 a[152:153], v10 offset:8448
    ds_read_b64_tr_b16 a[154:155], v10 offset:8704
    s_waitcnt lgkmcnt(10)
    v_cvt_pk_bf16_f32 v232, v220, v221
    v_accvgpr_write_b32 a10, v232
    v_cvt_pk_bf16_f32 v222, 0, v222
    v_mfma_f32_32x32x16_bf16 v[56:71], a[160:163], a[4:7], v[56:71]
    ds_read_b64_tr_b16 a[156:157], v6 offset:8448
    ds_read_b64_tr_b16 a[158:159], v6 offset:8704
    v_cvt_pk_bf16_f32 v223, 0, v223
    v_mul_f32 v222, v222, v31
    v_mul_f32 v223, v223, v31
    v_cvt_pk_bf16_f32 v233, v222, v223
    v_mfma_f32_32x32x16_bf16 v[88:103], a[164:167], a[4:7], v[88:103]
    ds_read_b64_tr_b16 a[160:161], v8 offset:9472
    ds_read_b64_tr_b16 a[162:163], v8 offset:9728
    s_waitcnt lgkmcnt(10)
    buffer_load_dwordx4 v16, s[28:31], s66 offen offset:2048 lds
    v_accvgpr_write_b32 a11, v233
    v_cvt_pk_bf16_f32 v224, 0, v224
    v_mfma_f32_32x32x16_bf16 v[72:87], a[168:171], a[4:7], v[72:87]
    ds_read_b64_tr_b16 a[164:165], v12 offset:9472
    ds_read_b64_tr_b16 a[166:167], v12 offset:9728
    v_cvt_pk_bf16_f32 v225, 0, v225
    v_mul_f32 v224, v224, v31
    v_mul_f32 v225, v225, v31
    v_cvt_pk_bf16_f32 v232, v224, v225
    v_mfma_f32_32x32x16_bf16 v[40:55], a[172:175], a[4:7], v[40:55]
    ds_read_b64_tr_b16 a[168:169], v10 offset:9472
    ds_read_b64_tr_b16 a[170:171], v10 offset:9728
    s_waitcnt lgkmcnt(10)
    v_accvgpr_write_b32 a12, v232
    v_cvt_pk_bf16_f32 v226, 0, v226
    v_cvt_pk_bf16_f32 v227, 0, v227
    v_mfma_f32_32x32x16_bf16 v[56:71], a[144:147], a[8:11], v[56:71]
    ds_read_b64_tr_b16 a[172:173], v6 offset:9472
    ds_read_b64_tr_b16 a[174:175], v6 offset:9728
    v_mul_f32 v226, v226, v31
    v_mul_f32 v227, v227, v31
    v_cvt_pk_bf16_f32 v233, v226, v227
    v_accvgpr_write_b32 a13, v233
    v_mfma_f32_32x32x16_bf16 v[88:103], a[148:151], a[8:11], v[88:103]
    s_waitcnt vmcnt(11)
    s_barrier
    ds_read_b64_tr_b16 a[144:145], v2 offset:22784
    ds_read_b64_tr_b16 a[146:147], v2 offset:23296
    s_waitcnt lgkmcnt(10)
    v_cvt_pk_bf16_f32 v228, 0, v228
    v_mfma_f32_32x32x16_bf16 v[72:87], a[152:155], a[8:11], v[72:87]
    ds_read_b64_tr_b16 a[148:149], v4 offset:22784
    ds_read_b64_tr_b16 a[150:151], v4 offset:23296
    v_cvt_pk_bf16_f32 v229, 0, v229
    v_mul_f32 v228, v228, v31
    v_mul_f32 v229, v229, v31
    v_cvt_pk_bf16_f32 v232, v228, v229
    v_mfma_f32_32x32x16_bf16 v[40:55], a[156:159], a[8:11], v[40:55]
    ds_read_b64_tr_b16 a[152:153], v2 offset:30976
    ds_read_b64_tr_b16 a[154:155], v2 offset:31488
    s_waitcnt lgkmcnt(10)
    v_accvgpr_write_b32 a14, v232
    v_cvt_pk_bf16_f32 v230, 0, v230
    v_cvt_pk_bf16_f32 v231, 0, v231
    buffer_load_dwordx4 v17, s[28:31], s66 offen offset:3072 lds
    s_add_u32 m0, s84, 88320
    v_mul_f32 v230, v230, v31
    v_mul_f32 v231, v231, v31
    v_cvt_pk_bf16_f32 v233, v230, v231
    v_accvgpr_write_b32 a15, v233
    v_mfma_f32_32x32x16_bf16 v[216:231], v[32:35], a[24:27], v[184:199]
    s_nop 0
    v_mfma_f32_32x32x16_bf16 v[56:71], a[160:163], a[12:15], v[56:71]
    ds_read_b64_tr_b16 a[156:157], v4 offset:30976
    ds_read_b64_tr_b16 a[158:159], v4 offset:31488
    v_mfma_f32_32x32x16_bf16 v[216:231], v[36:39], a[28:31], v[216:231]
    v_cvt_pk_bf16_f32 v200, 0, v200
    v_cvt_pk_bf16_f32 v201, 0, v201
    v_mul_f32 v200, v200, v31
    v_mul_f32 v201, v201, v31
    v_cvt_pk_bf16_f32 v232, v200, v201
    v_accvgpr_write_b32 a16, v232
    v_mfma_f32_32x32x16_bf16 v[88:103], a[164:167], a[12:15], v[88:103]
    ds_read_b64_tr_b16 a[160:161], v2 offset:24832
    ds_read_b64_tr_b16 a[162:163], v2 offset:25344
    s_waitcnt lgkmcnt(10)
    v_cvt_pk_bf16_f32 v202, 0, v202
    v_cvt_pk_bf16_f32 v203, 0, v203
    v_mul_f32 v202, v202, v31
    v_mfma_f32_32x32x16_bf16 v[72:87], a[168:171], a[12:15], v[72:87]
    ds_read_b64_tr_b16 a[164:165], v4 offset:24832
    ds_read_b64_tr_b16 a[166:167], v4 offset:25344
    v_mul_f32 v203, v203, v31
    v_cvt_pk_bf16_f32 v233, v202, v203
    v_accvgpr_write_b32 a17, v233
    v_cvt_pk_bf16_f32 v204, 0, v204
    v_mfma_f32_32x32x16_bf16 v[40:55], a[172:175], a[12:15], v[40:55]
    ds_read_b64_tr_b16 a[168:169], v2 offset:33024
    ds_read_b64_tr_b16 a[170:171], v2 offset:33536
    s_waitcnt lgkmcnt(10)
    v_cvt_pk_bf16_f32 v205, 0, v205
    v_mul_f32 v204, v204, v31
    v_mul_f32 v205, v205, v31
    v_mfma_f32_32x32x16_bf16 v[104:119], a[144:147], a[0:3], 0
    ds_read_b64_tr_b16 a[172:173], v4 offset:33024
    ds_read_b64_tr_b16 a[174:175], v4 offset:33536
    v_cvt_pk_bf16_f32 v232, v204, v205
    v_accvgpr_write_b32 a18, v232
    v_cvt_pk_bf16_f32 v206, 0, v206
    v_mfma_f32_32x32x16_bf16 v[120:135], a[148:151], a[0:3], 0
    ds_read_b64_tr_b16 a[144:145], v2 offset:26880
    ds_read_b64_tr_b16 a[146:147], v2 offset:27392
    s_waitcnt lgkmcnt(10)
    v_cvt_pk_bf16_f32 v207, 0, v207
    v_mul_f32 v206, v206, v31
    v_mul_f32 v207, v207, v31
    v_mfma_f32_32x32x16_bf16 v[136:151], a[152:155], a[0:3], 0
    ds_read_b64_tr_b16 a[148:149], v4 offset:26880
    ds_read_b64_tr_b16 a[150:151], v4 offset:27392
    buffer_load_dwordx4 v18, s[32:35], s75 offen lds
    v_cvt_pk_bf16_f32 v233, v206, v207
    v_accvgpr_write_b32 a19, v233
    v_mfma_f32_32x32x16_bf16 v[152:167], a[156:159], a[0:3], 0
    ds_read_b64_tr_b16 a[152:153], v2 offset:35072
    ds_read_b64_tr_b16 a[154:155], v2 offset:35584
    s_waitcnt lgkmcnt(10)
    v_cvt_pk_bf16_f32 v208, 0, v208
    v_cvt_pk_bf16_f32 v209, 0, v209
    v_mul_f32 v208, v208, v31
    v_mfma_f32_32x32x16_bf16 v[104:119], a[160:163], a[4:7], v[104:119]
    ds_read_b64_tr_b16 a[156:157], v4 offset:35072
    ds_read_b64_tr_b16 a[158:159], v4 offset:35584
    v_mul_f32 v209, v209, v31
    v_cvt_pk_bf16_f32 v232, v208, v209
    v_accvgpr_write_b32 a20, v232
    v_cvt_pk_bf16_f32 v210, 0, v210
    v_mfma_f32_32x32x16_bf16 v[120:135], a[164:167], a[4:7], v[120:135]
    ds_read_b64_tr_b16 a[160:161], v2 offset:28928
    ds_read_b64_tr_b16 a[162:163], v2 offset:29440
    s_waitcnt lgkmcnt(10)
    buffer_load_dwordx4 v19, s[32:35], s75 offen offset:1024 lds
    v_cvt_pk_bf16_f32 v211, 0, v211
    v_mul_f32 v210, v210, v31
    v_mfma_f32_32x32x16_bf16 v[136:151], a[168:171], a[4:7], v[136:151]
    ds_read_b64_tr_b16 a[164:165], v4 offset:28928
    ds_read_b64_tr_b16 a[166:167], v4 offset:29440
    v_mul_f32 v211, v211, v31
    v_cvt_pk_bf16_f32 v233, v210, v211
    v_accvgpr_write_b32 a21, v233
    v_cvt_pk_bf16_f32 v212, 0, v212
    v_mfma_f32_32x32x16_bf16 v[152:167], a[172:175], a[4:7], v[152:167]
    ds_read_b64_tr_b16 a[168:169], v2 offset:37120
    ds_read_b64_tr_b16 a[170:171], v2 offset:37632
    s_waitcnt lgkmcnt(10)
    buffer_load_dwordx4 v20, s[32:35], s75 offen offset:2048 lds
    v_cvt_pk_bf16_f32 v213, 0, v213
    v_mul_f32 v212, v212, v31
    v_mfma_f32_32x32x16_bf16 v[104:119], a[144:147], a[8:11], v[104:119]
    ds_read_b64_tr_b16 a[172:173], v4 offset:37120
    ds_read_b64_tr_b16 a[174:175], v4 offset:37632
    v_mul_f32 v213, v213, v31
    v_cvt_pk_bf16_f32 v232, v212, v213
    v_accvgpr_write_b32 a22, v232
    v_cvt_pk_bf16_f32 v214, 0, v214
    v_mfma_f32_32x32x16_bf16 v[120:135], a[148:151], a[8:11], v[120:135]
    s_waitcnt vmcnt(11)
    s_barrier
    ds_read_b64_tr_b16 a[144:145], v8 offset:39168
    ds_read_b64_tr_b16 a[146:147], v8 offset:39424
    s_waitcnt lgkmcnt(10)
    buffer_load_dwordx4 v21, s[32:35], s75 offen offset:3072 lds
    s_add_u32 m0, s84, 104704
    v_mfma_f32_32x32x16_bf16 v[136:151], a[152:155], a[8:11], v[136:151]
    ds_read_b64_tr_b16 a[148:149], v12 offset:39168
    ds_read_b64_tr_b16 a[150:151], v12 offset:39424
    v_cvt_pk_bf16_f32 v215, 0, v215
    v_mul_f32 v214, v214, v31
    v_mul_f32 v215, v215, v31
    v_cvt_pk_bf16_f32 v233, v214, v215
    v_mfma_f32_32x32x16_bf16 v[152:167], a[156:159], a[8:11], v[152:167]
    ds_read_b64_tr_b16 a[152:153], v10 offset:39168
    ds_read_b64_tr_b16 a[154:155], v10 offset:39424
    s_waitcnt lgkmcnt(10)
    buffer_load_dwordx4 v14, s[28:31], s67 offen lds
    v_accvgpr_write_b32 a23, v233
    v_mfma_f32_32x32x16_bf16 v[200:215], v[32:35], a[32:35], v[184:199]
    v_mfma_f32_32x32x16_bf16 v[200:215], v[36:39], a[36:39], v[200:215]
    v_cvt_pk_bf16_f32 v216, 0, v216
    v_cvt_pk_bf16_f32 v217, 0, v217
    v_mul_f32 v216, v216, v31
    v_mul_f32 v217, v217, v31
    v_cvt_pk_bf16_f32 v232, v216, v217
    v_accvgpr_write_b32 a24, v232
    v_mfma_f32_32x32x16_bf16 v[104:119], a[160:163], a[12:15], v[104:119]
    ds_read_b64_tr_b16 a[156:157], v6 offset:39168
    ds_read_b64_tr_b16 a[158:159], v6 offset:39424
    v_cvt_pk_bf16_f32 v218, 0, v218
    v_cvt_pk_bf16_f32 v219, 0, v219
    v_mul_f32 v218, v218, v31
    v_mul_f32 v219, v219, v31
    v_mfma_f32_32x32x16_bf16 v[120:135], a[164:167], a[12:15], v[120:135]
    ds_read_b64_tr_b16 a[160:161], v8 offset:40192
    ds_read_b64_tr_b16 a[162:163], v8 offset:40448
    s_waitcnt lgkmcnt(10)
    v_cvt_pk_bf16_f32 v233, v218, v219
    v_accvgpr_write_b32 a25, v233
    v_cvt_pk_bf16_f32 v220, 0, v220
    v_mfma_f32_32x32x16_bf16 v[136:151], a[168:171], a[12:15], v[136:151]
    ds_read_b64_tr_b16 a[164:165], v12 offset:40192
    ds_read_b64_tr_b16 a[166:167], v12 offset:40448
    v_cvt_pk_bf16_f32 v221, 0, v221
    v_mul_f32 v220, v220, v31
    v_mul_f32 v221, v221, v31
    v_cvt_pk_bf16_f32 v232, v220, v221
    v_mfma_f32_32x32x16_bf16 v[152:167], a[172:175], a[12:15], v[152:167]
    ds_read_b64_tr_b16 a[168:169], v10 offset:40192
    ds_read_b64_tr_b16 a[170:171], v10 offset:40448
    s_waitcnt lgkmcnt(10)
    v_accvgpr_write_b32 a26, v232
    v_cvt_pk_bf16_f32 v222, 0, v222
    v_cvt_pk_bf16_f32 v223, 0, v223
    v_mfma_f32_32x32x16_bf16 v[56:71], a[144:147], a[16:19], v[56:71]
    ds_read_b64_tr_b16 a[172:173], v6 offset:40192
    ds_read_b64_tr_b16 a[174:175], v6 offset:40448
    buffer_load_dwordx4 v15, s[28:31], s67 offen offset:1024 lds
    v_mul_f32 v222, v222, v31
    v_mul_f32 v223, v223, v31
    v_cvt_pk_bf16_f32 v233, v222, v223
    v_mfma_f32_32x32x16_bf16 v[88:103], a[148:151], a[16:19], v[88:103]
    ds_read_b64_tr_b16 a[144:145], v8 offset:41216
    ds_read_b64_tr_b16 a[146:147], v8 offset:41472
    s_waitcnt lgkmcnt(10)
    v_accvgpr_write_b32 a27, v233
    v_cvt_pk_bf16_f32 v224, 0, v224
    v_cvt_pk_bf16_f32 v225, 0, v225
    v_mfma_f32_32x32x16_bf16 v[72:87], a[152:155], a[16:19], v[72:87]
    ds_read_b64_tr_b16 a[148:149], v12 offset:41216
    ds_read_b64_tr_b16 a[150:151], v12 offset:41472
    v_mul_f32 v224, v224, v31
    v_mul_f32 v225, v225, v31
    v_cvt_pk_bf16_f32 v232, v224, v225
    v_accvgpr_write_b32 a28, v232
    v_mfma_f32_32x32x16_bf16 v[40:55], a[156:159], a[16:19], v[40:55]
    ds_read_b64_tr_b16 a[152:153], v10 offset:41216
    ds_read_b64_tr_b16 a[154:155], v10 offset:41472
    s_waitcnt lgkmcnt(10)
    v_cvt_pk_bf16_f32 v226, 0, v226
    v_cvt_pk_bf16_f32 v227, 0, v227
    v_mul_f32 v226, v226, v31
    v_mfma_f32_32x32x16_bf16 v[56:71], a[160:163], a[20:23], v[56:71]
    ds_read_b64_tr_b16 a[156:157], v6 offset:41216
    ds_read_b64_tr_b16 a[158:159], v6 offset:41472
    v_mul_f32 v227, v227, v31
    v_cvt_pk_bf16_f32 v233, v226, v227
    v_accvgpr_write_b32 a29, v233
    v_cvt_pk_bf16_f32 v228, 0, v228
    v_mfma_f32_32x32x16_bf16 v[88:103], a[164:167], a[20:23], v[88:103]
    ds_read_b64_tr_b16 a[160:161], v8 offset:42240
    ds_read_b64_tr_b16 a[162:163], v8 offset:42496
    s_waitcnt lgkmcnt(10)
    v_cvt_pk_bf16_f32 v229, 0, v229
    v_mul_f32 v228, v228, v31
    v_mul_f32 v229, v229, v31
    v_mfma_f32_32x32x16_bf16 v[72:87], a[168:171], a[20:23], v[72:87]
    ds_read_b64_tr_b16 a[164:165], v12 offset:42240
    ds_read_b64_tr_b16 a[166:167], v12 offset:42496
    v_cvt_pk_bf16_f32 v232, v228, v229
    v_accvgpr_write_b32 a30, v232
    v_cvt_pk_bf16_f32 v230, 0, v230
    v_mfma_f32_32x32x16_bf16 v[40:55], a[172:175], a[20:23], v[40:55]
    ds_read_b64_tr_b16 a[168:169], v10 offset:42240
    ds_read_b64_tr_b16 a[170:171], v10 offset:42496
    s_waitcnt lgkmcnt(10)
    buffer_store_dwordx4 v[168:171], v174, s[48:51], s4 offen sc1
    v_cvt_pk_bf16_f32 v231, 0, v231
    v_mul_f32 v230, v230, v31
    v_mfma_f32_32x32x16_bf16 v[56:71], a[144:147], a[24:27], v[56:71]
    ds_read_b64_tr_b16 a[172:173], v6 offset:42240
    ds_read_b64_tr_b16 a[174:175], v6 offset:42496
    v_mul_f32 v231, v231, v31
    v_cvt_pk_bf16_f32 v233, v230, v231
    v_accvgpr_write_b32 a31, v233
    v_mfma_f32_32x32x16_bf16 v[216:231], v[32:35], a[40:43], v[184:199]
    buffer_load_dwordx4 v16, s[28:31], s67 offen offset:2048 lds
    v_mfma_f32_32x32x16_bf16 v[216:231], v[36:39], a[44:47], v[216:231]
    v_cvt_pk_bf16_f32 v200, 0, v200
    v_cvt_pk_bf16_f32 v201, 0, v201
    v_mul_f32 v200, v200, v31
    v_mul_f32 v201, v201, v31
    v_cvt_pk_bf16_f32 v232, v200, v201
    v_accvgpr_write_b32 a32, v232
    v_mfma_f32_32x32x16_bf16 v[88:103], a[148:151], a[24:27], v[88:103]
    s_waitcnt vmcnt(12)
    s_barrier
    ds_read_b64_tr_b16 a[144:145], v2 offset:55552
    ds_read_b64_tr_b16 a[146:147], v2 offset:56064
    s_waitcnt lgkmcnt(10)
    v_cvt_pk_bf16_f32 v202, 0, v202
    v_mfma_f32_32x32x16_bf16 v[72:87], a[152:155], a[24:27], v[72:87]
    ds_read_b64_tr_b16 a[148:149], v4 offset:55552
    ds_read_b64_tr_b16 a[150:151], v4 offset:56064
    v_cvt_pk_bf16_f32 v203, 0, v203
    v_mul_f32 v202, v202, v31
    v_mul_f32 v203, v203, v31
    v_cvt_pk_bf16_f32 v233, v202, v203
    v_mfma_f32_32x32x16_bf16 v[40:55], a[156:159], a[24:27], v[40:55]
    ds_read_b64_tr_b16 a[152:153], v2 offset:63744
    ds_read_b64_tr_b16 a[154:155], v2 offset:64256
    s_waitcnt lgkmcnt(10)
    v_accvgpr_write_b32 a33, v233
    v_cvt_pk_bf16_f32 v204, 0, v204
    v_cvt_pk_bf16_f32 v205, 0, v205
    v_mfma_f32_32x32x16_bf16 v[56:71], a[160:163], a[28:31], v[56:71]
    ds_read_b64_tr_b16 a[156:157], v4 offset:63744
    ds_read_b64_tr_b16 a[158:159], v4 offset:64256
    v_mul_f32 v204, v204, v31
    v_mul_f32 v205, v205, v31
    v_cvt_pk_bf16_f32 v232, v204, v205
    v_accvgpr_write_b32 a34, v232
    v_mfma_f32_32x32x16_bf16 v[88:103], a[164:167], a[28:31], v[88:103]
    ds_read_b64_tr_b16 a[160:161], v2 offset:57600
    ds_read_b64_tr_b16 a[162:163], v2 offset:58112
    s_waitcnt lgkmcnt(10)
    v_cvt_pk_bf16_f32 v206, 0, v206
    v_cvt_pk_bf16_f32 v207, 0, v207
    v_mul_f32 v206, v206, v31
    v_mfma_f32_32x32x16_bf16 v[72:87], a[168:171], a[28:31], v[72:87]
    ds_read_b64_tr_b16 a[164:165], v4 offset:57600
    ds_read_b64_tr_b16 a[166:167], v4 offset:58112
    buffer_load_dwordx4 v17, s[28:31], s67 offen offset:3072 lds
    s_add_u32 m0, s84, 6400
    v_mul_f32 v207, v207, v31
    v_cvt_pk_bf16_f32 v233, v206, v207
    v_mfma_f32_32x32x16_bf16 v[40:55], a[172:175], a[28:31], v[40:55]
    ds_read_b64_tr_b16 a[168:169], v3 offset:1280
    ds_read_b64_tr_b16 a[170:171], v3 offset:1792
    s_waitcnt lgkmcnt(10)
    v_accvgpr_write_b32 a35, v233
    v_cvt_pk_bf16_f32 v208, 0, v208
    v_cvt_pk_bf16_f32 v209, 0, v209
    v_mfma_f32_32x32x16_bf16 v[104:119], a[144:147], a[16:19], v[104:119]
    ds_read_b64_tr_b16 a[172:173], v5 offset:1280
    ds_read_b64_tr_b16 a[174:175], v5 offset:1792
    v_mul_f32 v208, v208, v31
    v_mul_f32 v209, v209, v31
    v_cvt_pk_bf16_f32 v232, v208, v209
    v_accvgpr_write_b32 a36, v232
    v_mfma_f32_32x32x16_bf16 v[120:135], a[148:151], a[16:19], v[120:135]
    ds_read_b64_tr_b16 a[144:145], v2 offset:59648
    ds_read_b64_tr_b16 a[146:147], v2 offset:60160
    s_waitcnt lgkmcnt(10)
    v_cvt_pk_bf16_f32 v210, 0, v210
    v_cvt_pk_bf16_f32 v211, 0, v211
    v_mul_f32 v210, v210, v31
    v_mfma_f32_32x32x16_bf16 v[136:151], a[152:155], a[16:19], v[136:151]
    ds_read_b64_tr_b16 a[148:149], v4 offset:59648
    ds_read_b64_tr_b16 a[150:151], v4 offset:60160
    v_mul_f32 v211, v211, v31
    v_cvt_pk_bf16_f32 v233, v210, v211
    v_accvgpr_write_b32 a37, v233
    v_cvt_pk_bf16_f32 v212, 0, v212
    v_mfma_f32_32x32x16_bf16 v[152:167], a[156:159], a[16:19], v[152:167]
    ds_read_b64_tr_b16 a[152:153], v3 offset:3328
    ds_read_b64_tr_b16 a[154:155], v3 offset:3840
    s_waitcnt lgkmcnt(10)
    v_cvt_pk_bf16_f32 v213, 0, v213
    v_mul_f32 v212, v212, v31
    v_mul_f32 v213, v213, v31
    v_mfma_f32_32x32x16_bf16 v[104:119], a[160:163], a[20:23], v[104:119]
    ds_read_b64_tr_b16 a[156:157], v5 offset:3328
    ds_read_b64_tr_b16 a[158:159], v5 offset:3840
    v_cvt_pk_bf16_f32 v232, v212, v213
    v_accvgpr_write_b32 a38, v232
    v_cvt_pk_bf16_f32 v214, 0, v214
    v_mfma_f32_32x32x16_bf16 v[120:135], a[164:167], a[20:23], v[120:135]
    ds_read_b64_tr_b16 a[160:161], v2 offset:61696
    ds_read_b64_tr_b16 a[162:163], v2 offset:62208
    s_waitcnt lgkmcnt(10)
    buffer_store_dwordx4 v[168:171], v175, s[48:51], s4 offen sc1
    buffer_store_dword v168, v176, s[48:51], 0 offen sc1
    v_cvt_pk_bf16_f32 v215, 0, v215
    v_mfma_f32_32x32x16_bf16 v[136:151], a[168:171], a[20:23], v[136:151]
    ds_read_b64_tr_b16 a[164:165], v4 offset:61696
    ds_read_b64_tr_b16 a[166:167], v4 offset:62208
    v_mul_f32 v214, v214, v31
    v_mul_f32 v215, v215, v31
    v_cvt_pk_bf16_f32 v233, v214, v215
    v_accvgpr_write_b32 a39, v233
    v_mfma_f32_32x32x16_bf16 v[200:215], v[32:35], a[48:51], v[184:199]
    v_mfma_f32_32x32x16_bf16 v[200:215], v[36:39], a[52:55], v[200:215]
    buffer_load_dwordx4 v18, s[32:35], s76 offen lds
    v_cvt_pk_bf16_f32 v216, 0, v216
    v_cvt_pk_bf16_f32 v217, 0, v217
    v_mul_f32 v216, v216, v31
    v_mul_f32 v217, v217, v31
    v_cvt_pk_bf16_f32 v232, v216, v217
    v_mfma_f32_32x32x16_bf16 v[152:167], a[172:175], a[20:23], v[152:167]
    ds_read_b64_tr_b16 a[168:169], v3 offset:5376
    ds_read_b64_tr_b16 a[170:171], v3 offset:5888
    s_waitcnt lgkmcnt(10)
    v_accvgpr_write_b32 a40, v232
    v_cvt_pk_bf16_f32 v218, 0, v218
    v_cvt_pk_bf16_f32 v219, 0, v219
    v_mfma_f32_32x32x16_bf16 v[104:119], a[144:147], a[24:27], v[104:119]
    ds_read_b64_tr_b16 a[172:173], v5 offset:5376
    ds_read_b64_tr_b16 a[174:175], v5 offset:5888
    buffer_load_dwordx4 v19, s[32:35], s76 offen offset:1024 lds
    v_mul_f32 v218, v218, v31
    v_mul_f32 v219, v219, v31
    v_cvt_pk_bf16_f32 v233, v218, v219
    v_mfma_f32_32x32x16_bf16 v[120:135], a[148:151], a[24:27], v[120:135]
    s_waitcnt vmcnt(13)
    s_barrier
    ds_read_b64_tr_b16 a[144:145], v9 offset:7424
    ds_read_b64_tr_b16 a[146:147], v9 offset:7680
    s_waitcnt lgkmcnt(10)
    v_accvgpr_write_b32 a41, v233
    v_mfma_f32_32x32x16_bf16 v[136:151], a[152:155], a[24:27], v[136:151]
    ds_read_b64_tr_b16 a[148:149], v13 offset:7424
    ds_read_b64_tr_b16 a[150:151], v13 offset:7680
    buffer_load_dwordx4 v20, s[32:35], s76 offen offset:2048 lds
    v_cvt_pk_bf16_f32 v220, 0, v220
    v_cvt_pk_bf16_f32 v221, 0, v221
    v_mul_f32 v220, v220, v31
    v_mfma_f32_32x32x16_bf16 v[152:167], a[156:159], a[24:27], v[152:167]
    ds_read_b64_tr_b16 a[152:153], v11 offset:7424
    ds_read_b64_tr_b16 a[154:155], v11 offset:7680
    s_waitcnt lgkmcnt(10)
    v_mul_f32 v221, v221, v31
    v_cvt_pk_bf16_f32 v232, v220, v221
    v_accvgpr_write_b32 a42, v232
    v_mfma_f32_32x32x16_bf16 v[104:119], a[160:163], a[28:31], v[104:119]
    ds_read_b64_tr_b16 a[156:157], v7 offset:7424
    ds_read_b64_tr_b16 a[158:159], v7 offset:7680
    buffer_load_dwordx4 v21, s[32:35], s76 offen offset:3072 lds
    s_add_u32 m0, s84, 22784
    v_cvt_pk_bf16_f32 v222, 0, v222
    v_mfma_f32_32x32x16_bf16 v[120:135], a[164:167], a[28:31], v[120:135]
    ds_read_b64_tr_b16 a[160:161], v9 offset:8448
    ds_read_b64_tr_b16 a[162:163], v9 offset:8704
    s_waitcnt lgkmcnt(10)
    v_cvt_pk_bf16_f32 v223, 0, v223
    v_mul_f32 v222, v222, v31
    v_mul_f32 v223, v223, v31
    v_mfma_f32_32x32x16_bf16 v[136:151], a[168:171], a[28:31], v[136:151]
    ds_read_b64_tr_b16 a[164:165], v13 offset:8448
    ds_read_b64_tr_b16 a[166:167], v13 offset:8704
    buffer_load_dwordx4 v14, s[28:31], s68 offen lds
    v_cvt_pk_bf16_f32 v233, v222, v223
    v_accvgpr_write_b32 a43, v233
    v_mfma_f32_32x32x16_bf16 v[152:167], a[172:175], a[28:31], v[152:167]
    ds_read_b64_tr_b16 a[168:169], v11 offset:8448
    ds_read_b64_tr_b16 a[170:171], v11 offset:8704
    s_waitcnt lgkmcnt(10)
    v_cvt_pk_bf16_f32 v224, 0, v224
    v_cvt_pk_bf16_f32 v225, 0, v225
    v_mul_f32 v224, v224, v31
    v_mfma_f32_32x32x16_bf16 v[56:71], a[144:147], a[32:35], v[56:71]
    ds_read_b64_tr_b16 a[172:173], v7 offset:8448
    ds_read_b64_tr_b16 a[174:175], v7 offset:8704
    v_mul_f32 v225, v225, v31
    v_cvt_pk_bf16_f32 v232, v224, v225
    v_accvgpr_write_b32 a44, v232
    v_cvt_pk_bf16_f32 v226, 0, v226
    v_mfma_f32_32x32x16_bf16 v[88:103], a[148:151], a[32:35], v[88:103]
    ds_read_b64_tr_b16 a[144:145], v9 offset:9472
    ds_read_b64_tr_b16 a[146:147], v9 offset:9728
    s_waitcnt lgkmcnt(10)
    v_cvt_pk_bf16_f32 v227, 0, v227
    v_mul_f32 v226, v226, v31
    v_mul_f32 v227, v227, v31
    v_mfma_f32_32x32x16_bf16 v[72:87], a[152:155], a[32:35], v[72:87]
    ds_read_b64_tr_b16 a[148:149], v13 offset:9472
    ds_read_b64_tr_b16 a[150:151], v13 offset:9728
    v_cvt_pk_bf16_f32 v233, v226, v227
    v_accvgpr_write_b32 a45, v233
    v_cvt_pk_bf16_f32 v228, 0, v228
    v_mfma_f32_32x32x16_bf16 v[40:55], a[156:159], a[32:35], v[40:55]
    ds_read_b64_tr_b16 a[152:153], v11 offset:9472
    ds_read_b64_tr_b16 a[154:155], v11 offset:9728
    s_waitcnt lgkmcnt(10)
    v_cvt_pk_bf16_f32 v229, 0, v229
    v_mul_f32 v228, v228, v31
    v_mul_f32 v229, v229, v31
    v_mfma_f32_32x32x16_bf16 v[56:71], a[160:163], a[36:39], v[56:71]
    ds_read_b64_tr_b16 a[156:157], v7 offset:9472
    ds_read_b64_tr_b16 a[158:159], v7 offset:9728
    v_cvt_pk_bf16_f32 v232, v228, v229
    v_accvgpr_write_b32 a46, v232
    v_cvt_pk_bf16_f32 v230, 0, v230
    v_mfma_f32_32x32x16_bf16 v[88:103], a[164:167], a[36:39], v[88:103]
    ds_read_b64_tr_b16 a[160:161], v9 offset:10496
    ds_read_b64_tr_b16 a[162:163], v9 offset:10752
    s_waitcnt lgkmcnt(10)
    buffer_store_dwordx4 v[168:171], v30, s[48:51], s8 offen sc1
    v_cvt_pk_bf16_f32 v231, 0, v231
    v_mul_f32 v230, v230, v31
    v_mfma_f32_32x32x16_bf16 v[72:87], a[168:171], a[36:39], v[72:87]
    ds_read_b64_tr_b16 a[164:165], v13 offset:10496
    ds_read_b64_tr_b16 a[166:167], v13 offset:10752
    v_mul_f32 v231, v231, v31
    v_cvt_pk_bf16_f32 v233, v230, v231
    v_accvgpr_write_b32 a47, v233
    v_mfma_f32_32x32x16_bf16 v[216:231], v[32:35], a[56:59], v[184:199]
    buffer_load_dwordx4 v15, s[28:31], s68 offen offset:1024 lds
    v_mfma_f32_32x32x16_bf16 v[216:231], v[36:39], a[60:63], v[216:231]
    v_cvt_pk_bf16_f32 v200, 0, v200
    v_cvt_pk_bf16_f32 v201, 0, v201
    v_mul_f32 v200, v200, v31
    v_mul_f32 v201, v201, v31
    v_cvt_pk_bf16_f32 v232, v200, v201
    v_accvgpr_write_b32 a48, v232
    v_mfma_f32_32x32x16_bf16 v[40:55], a[172:175], a[36:39], v[40:55]
    ds_read_b64_tr_b16 a[168:169], v11 offset:10496
    ds_read_b64_tr_b16 a[170:171], v11 offset:10752
    s_waitcnt lgkmcnt(10)
    v_cvt_pk_bf16_f32 v202, 0, v202
    v_cvt_pk_bf16_f32 v203, 0, v203
    v_mul_f32 v202, v202, v31
    v_mfma_f32_32x32x16_bf16 v[56:71], a[144:147], a[40:43], v[56:71]
    ds_read_b64_tr_b16 a[172:173], v7 offset:10496
    ds_read_b64_tr_b16 a[174:175], v7 offset:10752
    v_mul_f32 v203, v203, v31
    v_cvt_pk_bf16_f32 v233, v202, v203
    v_accvgpr_write_b32 a49, v233
    v_cvt_pk_bf16_f32 v204, 0, v204
    v_mfma_f32_32x32x16_bf16 v[88:103], a[148:151], a[40:43], v[88:103]
    s_waitcnt vmcnt(14)
    s_barrier
    ds_read_b64_tr_b16 a[144:145], v3 offset:23808
    ds_read_b64_tr_b16 a[146:147], v3 offset:24320
    s_waitcnt lgkmcnt(10)
    v_cvt_pk_bf16_f32 v205, 0, v205
    v_mfma_f32_32x32x16_bf16 v[72:87], a[152:155], a[40:43], v[72:87]
    ds_read_b64_tr_b16 a[148:149], v5 offset:23808
    ds_read_b64_tr_b16 a[150:151], v5 offset:24320
    v_mul_f32 v204, v204, v31
    v_mul_f32 v205, v205, v31
    v_cvt_pk_bf16_f32 v232, v204, v205
    v_accvgpr_write_b32 a50, v232
    v_mfma_f32_32x32x16_bf16 v[40:55], a[156:159], a[40:43], v[40:55]
    ds_read_b64_tr_b16 a[152:153], v3 offset:32000
    ds_read_b64_tr_b16 a[154:155], v3 offset:32512
    s_waitcnt lgkmcnt(10)
    v_cvt_pk_bf16_f32 v206, 0, v206
    v_cvt_pk_bf16_f32 v207, 0, v207
    v_mul_f32 v206, v206, v31
    v_mfma_f32_32x32x16_bf16 v[56:71], a[160:163], a[44:47], v[56:71]
    ds_read_b64_tr_b16 a[156:157], v5 offset:32000
    ds_read_b64_tr_b16 a[158:159], v5 offset:32512
    buffer_load_dwordx4 v16, s[28:31], s68 offen offset:2048 lds
    v_mul_f32 v207, v207, v31
    v_cvt_pk_bf16_f32 v233, v206, v207
    v_accvgpr_write_b32 a51, v233
    v_mfma_f32_32x32x16_bf16 v[88:103], a[164:167], a[44:47], v[88:103]
    ds_read_b64_tr_b16 a[160:161], v3 offset:25856
    ds_read_b64_tr_b16 a[162:163], v3 offset:26368
    s_waitcnt lgkmcnt(10)
    buffer_load_dword v179, v178, s[52:55], 0 offen sc1
    v_cvt_pk_bf16_f32 v208, 0, v208
    v_cvt_pk_bf16_f32 v209, 0, v209
    v_mfma_f32_32x32x16_bf16 v[72:87], a[168:171], a[44:47], v[72:87]
    ds_read_b64_tr_b16 a[164:165], v5 offset:25856
    ds_read_b64_tr_b16 a[166:167], v5 offset:26368
    v_mul_f32 v208, v208, v31
    v_mul_f32 v209, v209, v31
    v_cvt_pk_bf16_f32 v232, v208, v209
    v_accvgpr_write_b32 a52, v232
    v_mfma_f32_32x32x16_bf16 v[40:55], a[172:175], a[44:47], v[40:55]
    ds_read_b64_tr_b16 a[168:169], v3 offset:34048
    ds_read_b64_tr_b16 a[170:171], v3 offset:34560
    s_waitcnt lgkmcnt(10)
    v_cvt_pk_bf16_f32 v210, 0, v210
    v_cvt_pk_bf16_f32 v211, 0, v211
    v_mul_f32 v210, v210, v31
    v_mfma_f32_32x32x16_bf16 v[104:119], a[144:147], a[32:35], v[104:119]
    ds_read_b64_tr_b16 a[172:173], v5 offset:34048
    ds_read_b64_tr_b16 a[174:175], v5 offset:34560
    v_mul_f32 v211, v211, v31
    v_cvt_pk_bf16_f32 v233, v210, v211
    v_accvgpr_write_b32 a53, v233
    v_cvt_pk_bf16_f32 v212, 0, v212
    v_mfma_f32_32x32x16_bf16 v[120:135], a[148:151], a[32:35], v[120:135]
    ds_read_b64_tr_b16 a[144:145], v3 offset:27904
    ds_read_b64_tr_b16 a[146:147], v3 offset:28416
    s_waitcnt lgkmcnt(10)
    v_cvt_pk_bf16_f32 v213, 0, v213
    v_mul_f32 v212, v212, v31
    v_mul_f32 v213, v213, v31
    v_mfma_f32_32x32x16_bf16 v[136:151], a[152:155], a[32:35], v[136:151]
    ds_read_b64_tr_b16 a[148:149], v5 offset:27904
    ds_read_b64_tr_b16 a[150:151], v5 offset:28416
    v_cvt_pk_bf16_f32 v232, v212, v213
    v_accvgpr_write_b32 a54, v232
    v_cvt_pk_bf16_f32 v214, 0, v214
    v_mfma_f32_32x32x16_bf16 v[152:167], a[156:159], a[32:35], v[152:167]
    ds_read_b64_tr_b16 a[152:153], v3 offset:36096
    ds_read_b64_tr_b16 a[154:155], v3 offset:36608
    s_waitcnt lgkmcnt(10)
    v_cvt_pk_bf16_f32 v215, 0, v215
    v_mul_f32 v214, v214, v31
    v_mul_f32 v215, v215, v31
    v_mfma_f32_32x32x16_bf16 v[104:119], a[160:163], a[36:39], v[104:119]
    ds_read_b64_tr_b16 a[156:157], v5 offset:36096
    ds_read_b64_tr_b16 a[158:159], v5 offset:36608
    buffer_store_dwordx4 v[168:171], v30, s[48:51], s8 offen offset:1024 sc1
    v_cvt_pk_bf16_f32 v233, v214, v215
    v_accvgpr_write_b32 a55, v233
    v_mfma_f32_32x32x16_bf16 v[200:215], v[32:35], a[64:67], v[184:199]
    v_mfma_f32_32x32x16_bf16 v[200:215], v[36:39], a[68:71], v[200:215]
    buffer_load_dwordx4 v17, s[28:31], s68 offen offset:3072 lds
    s_add_u32 m0, s84, 39168
    v_cvt_pk_bf16_f32 v216, 0, v216
    v_cvt_pk_bf16_f32 v217, 0, v217
    v_mul_f32 v216, v216, v31
    v_mul_f32 v217, v217, v31
    v_mfma_f32_32x32x16_bf16 v[120:135], a[164:167], a[36:39], v[120:135]
    ds_read_b64_tr_b16 a[160:161], v3 offset:29952
    ds_read_b64_tr_b16 a[162:163], v3 offset:30464
    s_waitcnt lgkmcnt(10)
    v_cvt_pk_bf16_f32 v232, v216, v217
    v_accvgpr_write_b32 a56, v232
    v_cvt_pk_bf16_f32 v218, 0, v218
    v_mfma_f32_32x32x16_bf16 v[136:151], a[168:171], a[36:39], v[136:151]
    ds_read_b64_tr_b16 a[164:165], v5 offset:29952
    ds_read_b64_tr_b16 a[166:167], v5 offset:30464
    v_cvt_pk_bf16_f32 v219, 0, v219
    v_mul_f32 v218, v218, v31
    v_mul_f32 v219, v219, v31
    v_cvt_pk_bf16_f32 v233, v218, v219
    v_mfma_f32_32x32x16_bf16 v[152:167], a[172:175], a[36:39], v[152:167]
    ds_read_b64_tr_b16 a[168:169], v3 offset:38144
    ds_read_b64_tr_b16 a[170:171], v3 offset:38656
    s_waitcnt lgkmcnt(10)
    s_waitcnt vmcnt(11)
    v_accvgpr_write_b32 a57, v233
    v_cvt_pk_bf16_f32 v220, 0, v220
    v_mfma_f32_32x32x16_bf16 v[104:119], a[144:147], a[40:43], v[104:119]
    ds_read_b64_tr_b16 a[172:173], v5 offset:38144
    ds_read_b64_tr_b16 a[174:175], v5 offset:38656
    v_cvt_pk_bf16_f32 v221, 0, v221
    v_mul_f32 v220, v220, v31
    v_mul_f32 v221, v221, v31
    v_cvt_pk_bf16_f32 v232, v220, v221
    v_mfma_f32_32x32x16_bf16 v[120:135], a[148:151], a[40:43], v[120:135]
    s_barrier
    ds_read_b64_tr_b16 a[144:145], v9 offset:40192
    ds_read_b64_tr_b16 a[146:147], v9 offset:40448
    s_waitcnt lgkmcnt(10)
    v_accvgpr_write_b32 a58, v232
    v_cvt_pk_bf16_f32 v222, 0, v222
    v_mfma_f32_32x32x16_bf16 v[136:151], a[152:155], a[40:43], v[136:151]
    ds_read_b64_tr_b16 a[148:149], v13 offset:40192
    ds_read_b64_tr_b16 a[150:151], v13 offset:40448
    v_cvt_pk_bf16_f32 v223, 0, v223
    v_mul_f32 v222, v222, v31
    v_mul_f32 v223, v223, v31
    v_cvt_pk_bf16_f32 v233, v222, v223
    v_mfma_f32_32x32x16_bf16 v[152:167], a[156:159], a[40:43], v[152:167]
    ds_read_b64_tr_b16 a[152:153], v11 offset:40192
    ds_read_b64_tr_b16 a[154:155], v11 offset:40448
    s_waitcnt lgkmcnt(10)
    buffer_load_dwordx4 v18, s[32:35], s77 offen lds
    v_accvgpr_write_b32 a59, v233
    v_cvt_pk_bf16_f32 v224, 0, v224
    v_mfma_f32_32x32x16_bf16 v[104:119], a[160:163], a[44:47], v[104:119]
    ds_read_b64_tr_b16 a[156:157], v7 offset:40192
    ds_read_b64_tr_b16 a[158:159], v7 offset:40448
    v_cvt_pk_bf16_f32 v225, 0, v225
    v_mul_f32 v224, v224, v31
    v_mul_f32 v225, v225, v31
    v_cvt_pk_bf16_f32 v232, v224, v225
    v_mfma_f32_32x32x16_bf16 v[120:135], a[164:167], a[44:47], v[120:135]
    ds_read_b64_tr_b16 a[160:161], v9 offset:41216
    ds_read_b64_tr_b16 a[162:163], v9 offset:41472
    s_waitcnt lgkmcnt(10)
    buffer_load_dwordx4 v19, s[32:35], s77 offen offset:1024 lds
    v_accvgpr_write_b32 a60, v232
    v_cvt_pk_bf16_f32 v226, 0, v226
    v_mfma_f32_32x32x16_bf16 v[136:151], a[168:171], a[44:47], v[136:151]
    ds_read_b64_tr_b16 a[164:165], v13 offset:41216
    ds_read_b64_tr_b16 a[166:167], v13 offset:41472
    buffer_store_dword v168, v177, s[48:51], s8 offen offset:2048 sc1
    v_cvt_pk_bf16_f32 v227, 0, v227
    v_mul_f32 v226, v226, v31
    v_mul_f32 v227, v227, v31
    v_mfma_f32_32x32x16_bf16 v[152:167], a[172:175], a[44:47], v[152:167]
    ds_read_b64_tr_b16 a[168:169], v11 offset:41216
    ds_read_b64_tr_b16 a[170:171], v11 offset:41472
    s_waitcnt lgkmcnt(10)
    buffer_load_dwordx4 v20, s[32:35], s77 offen offset:2048 lds
    v_cvt_pk_bf16_f32 v233, v226, v227
    v_accvgpr_write_b32 a61, v233
    v_mfma_f32_32x32x16_bf16 v[56:71], a[144:147], a[48:51], v[56:71]
    ds_read_b64_tr_b16 a[172:173], v7 offset:41216
    ds_read_b64_tr_b16 a[174:175], v7 offset:41472
    v_cvt_pk_bf16_f32 v228, 0, v228
    v_cvt_pk_bf16_f32 v229, 0, v229
    v_mul_f32 v228, v228, v31
    v_mul_f32 v229, v229, v31
    v_mfma_f32_32x32x16_bf16 v[88:103], a[148:151], a[48:51], v[88:103]
    ds_read_b64_tr_b16 a[144:145], v9 offset:42240
    ds_read_b64_tr_b16 a[146:147], v9 offset:42496
    s_waitcnt lgkmcnt(10)
    buffer_load_dwordx4 v21, s[32:35], s77 offen offset:3072 lds
    s_add_u32 m0, s84, 55552
    v_cvt_pk_bf16_f32 v232, v228, v229
    v_mfma_f32_32x32x16_bf16 v[72:87], a[152:155], a[48:51], v[72:87]
    ds_read_b64_tr_b16 a[148:149], v13 offset:42240
    ds_read_b64_tr_b16 a[150:151], v13 offset:42496
    v_accvgpr_write_b32 a62, v232
    v_cvt_pk_bf16_f32 v230, 0, v230
    v_cvt_pk_bf16_f32 v231, 0, v231
    v_mul_f32 v230, v230, v31
    v_mfma_f32_32x32x16_bf16 v[40:55], a[156:159], a[48:51], v[40:55]
    ds_read_b64_tr_b16 a[152:153], v11 offset:42240
    ds_read_b64_tr_b16 a[154:155], v11 offset:42496
    s_waitcnt lgkmcnt(10)
    v_mul_f32 v231, v231, v31
    v_cvt_pk_bf16_f32 v233, v230, v231
    v_accvgpr_write_b32 a63, v233
    v_mfma_f32_32x32x16_bf16 v[216:231], v[32:35], a[72:75], v[184:199]
    buffer_load_dwordx4 v14, s[28:31], s69 offen lds
    v_mfma_f32_32x32x16_bf16 v[216:231], v[36:39], a[76:79], v[216:231]
    v_cvt_pk_bf16_f32 v200, 0, v200
    v_cvt_pk_bf16_f32 v201, 0, v201
    v_mul_f32 v200, v200, v31
    v_mul_f32 v201, v201, v31
    v_cvt_pk_bf16_f32 v232, v200, v201
    v_accvgpr_write_b32 a64, v232
    v_mfma_f32_32x32x16_bf16 v[56:71], a[160:163], a[52:55], v[56:71]
    ds_read_b64_tr_b16 a[156:157], v7 offset:42240
    ds_read_b64_tr_b16 a[158:159], v7 offset:42496
    v_cvt_pk_bf16_f32 v202, 0, v202
    v_cvt_pk_bf16_f32 v203, 0, v203
    v_mul_f32 v202, v202, v31
    v_mul_f32 v203, v203, v31
    v_mfma_f32_32x32x16_bf16 v[88:103], a[164:167], a[52:55], v[88:103]
    ds_read_b64_tr_b16 a[160:161], v9 offset:43264
    ds_read_b64_tr_b16 a[162:163], v9 offset:43520
    s_waitcnt lgkmcnt(10)
    v_cvt_pk_bf16_f32 v233, v202, v203
    v_accvgpr_write_b32 a65, v233
    v_cvt_pk_bf16_f32 v204, 0, v204
    v_mfma_f32_32x32x16_bf16 v[72:87], a[168:171], a[52:55], v[72:87]
    ds_read_b64_tr_b16 a[164:165], v13 offset:43264
    ds_read_b64_tr_b16 a[166:167], v13 offset:43520
    v_cvt_pk_bf16_f32 v205, 0, v205
    v_mul_f32 v204, v204, v31
    v_mul_f32 v205, v205, v31
    v_cvt_pk_bf16_f32 v232, v204, v205
    v_mfma_f32_32x32x16_bf16 v[40:55], a[172:175], a[52:55], v[40:55]
    ds_read_b64_tr_b16 a[168:169], v11 offset:43264
    ds_read_b64_tr_b16 a[170:171], v11 offset:43520
    s_waitcnt lgkmcnt(10)
    v_accvgpr_write_b32 a66, v232
    v_cvt_pk_bf16_f32 v206, 0, v206
    v_cvt_pk_bf16_f32 v207, 0, v207
    v_mfma_f32_32x32x16_bf16 v[56:71], a[144:147], a[56:59], v[56:71]
    ds_read_b64_tr_b16 a[172:173], v7 offset:43264
    ds_read_b64_tr_b16 a[174:175], v7 offset:43520
    v_mul_f32 v206, v206, v31
    v_mul_f32 v207, v207, v31
    v_cvt_pk_bf16_f32 v233, v206, v207
    v_accvgpr_write_b32 a67, v233
    v_mfma_f32_32x32x16_bf16 v[88:103], a[148:151], a[56:59], v[88:103]
    s_waitcnt vmcnt(13)
    s_barrier
    ds_read_b64_tr_b16 a[144:145], v2 offset:6400
    ds_read_b64_tr_b16 a[146:147], v2 offset:6912
    s_waitcnt lgkmcnt(10)
    buffer_load_dwordx4 v15, s[28:31], s69 offen offset:1024 lds
    v_mfma_f32_32x32x16_bf16 v[72:87], a[152:155], a[56:59], v[72:87]
    ds_read_b64_tr_b16 a[148:149], v4 offset:6400
    ds_read_b64_tr_b16 a[150:151], v4 offset:6912
    v_cvt_pk_bf16_f32 v208, 0, v208
    v_cvt_pk_bf16_f32 v209, 0, v209
    v_mul_f32 v208, v208, v31
    v_mul_f32 v209, v209, v31
    v_mfma_f32_32x32x16_bf16 v[40:55], a[156:159], a[56:59], v[40:55]
    ds_read_b64_tr_b16 a[152:153], v2 offset:14592
    ds_read_b64_tr_b16 a[154:155], v2 offset:15104
    s_waitcnt lgkmcnt(10)
    v_cvt_pk_bf16_f32 v232, v208, v209
    v_accvgpr_write_b32 a68, v232
    v_cvt_pk_bf16_f32 v210, 0, v210
    v_mfma_f32_32x32x16_bf16 v[56:71], a[160:163], a[60:63], v[56:71]
    ds_read_b64_tr_b16 a[156:157], v4 offset:14592
    ds_read_b64_tr_b16 a[158:159], v4 offset:15104
    v_cvt_pk_bf16_f32 v211, 0, v211
    v_mul_f32 v210, v210, v31
    v_mul_f32 v211, v211, v31
    v_cvt_pk_bf16_f32 v233, v210, v211
    v_mfma_f32_32x32x16_bf16 v[88:103], a[164:167], a[60:63], v[88:103]
    ds_read_b64_tr_b16 a[160:161], v2 offset:8448
    ds_read_b64_tr_b16 a[162:163], v2 offset:8960
    s_waitcnt lgkmcnt(10)
    v_accvgpr_write_b32 a69, v233
    v_cvt_pk_bf16_f32 v212, 0, v212
    v_cvt_pk_bf16_f32 v213, 0, v213
    v_mfma_f32_32x32x16_bf16 v[72:87], a[168:171], a[60:63], v[72:87]
    ds_read_b64_tr_b16 a[164:165], v4 offset:8448
    ds_read_b64_tr_b16 a[166:167], v4 offset:8960
    v_mul_f32 v212, v212, v31
    v_mul_f32 v213, v213, v31
    v_cvt_pk_bf16_f32 v232, v212, v213
    v_accvgpr_write_b32 a70, v232
    v_mfma_f32_32x32x16_bf16 v[40:55], a[172:175], a[60:63], v[40:55]
    ds_read_b64_tr_b16 a[168:169], v2 offset:16640
    ds_read_b64_tr_b16 a[170:171], v2 offset:17152
    s_waitcnt lgkmcnt(10)
    v_cvt_pk_bf16_f32 v214, 0, v214
    v_cvt_pk_bf16_f32 v215, 0, v215
    v_mul_f32 v214, v214, v31
    v_mfma_f32_32x32x16_bf16 v[104:119], a[144:147], a[48:51], v[104:119]
    ds_read_b64_tr_b16 a[172:173], v4 offset:16640
    ds_read_b64_tr_b16 a[174:175], v4 offset:17152
    buffer_store_dwordx4 v[168:171], v29, s[48:51], s92 offen sc1
    v_mul_f32 v215, v215, v31
    v_cvt_pk_bf16_f32 v233, v214, v215
    v_accvgpr_write_b32 a71, v233
    v_mfma_f32_32x32x16_bf16 v[200:215], v[32:35], a[80:83], v[184:199]
    s_waitcnt vmcnt(10)
    v_cmp_ne_u32_e64 s[14:15], s100, v179
    v_mfma_f32_32x32x16_bf16 v[200:215], v[36:39], a[84:87], v[200:215]
    buffer_load_dwordx4 v16, s[28:31], s69 offen offset:2048 lds
    s_cmp_lg_u64 s[14:15], 0
    s_cbranch_scc1 L_slow_2
L_back_3:
    v_cvt_pk_bf16_f32 v216, 0, v216
    v_cvt_pk_bf16_f32 v217, 0, v217
    v_mul_f32 v216, v216, v31
    v_mfma_f32_32x32x16_bf16 v[120:135], a[148:151], a[48:51], v[120:135]
    ds_read_b64_tr_b16 a[144:145], v2 offset:10496
    ds_read_b64_tr_b16 a[146:147], v2 offset:11008
    s_waitcnt lgkmcnt(10)
    v_mul_f32 v217, v217, v31
    v_cvt_pk_bf16_f32 v232, v216, v217
    v_accvgpr_write_b32 a72, v232
    v_mfma_f32_32x32x16_bf16 v[136:151], a[152:155], a[48:51], v[136:151]
    ds_read_b64_tr_b16 a[148:149], v4 offset:10496
    ds_read_b64_tr_b16 a[150:151], v4 offset:11008
    s_mov_b64 exec, 1
    buffer_store_dword v254, v255, s[48:51], s95 offen sc1
    s_mov_b64 exec, -1
    v_cvt_pk_bf16_f32 v218, 0, v218
    v_mfma_f32_32x32x16_bf16 v[152:167], a[156:159], a[48:51], v[152:167]
    ds_read_b64_tr_b16 a[152:153], v2 offset:18688
    ds_read_b64_tr_b16 a[154:155], v2 offset:19200
    s_waitcnt lgkmcnt(10)
    s_lshl_b32 s14, s61, 8
    s_andn2_b32 vcc_lo, 1, s60
    v_cvt_pk_bf16_f32 v219, 0, v219
    v_mfma_f32_32x32x16_bf16 v[104:119], a[160:163], a[52:55], v[104:119]
    ds_read_b64_tr_b16 a[156:157], v4 offset:18688
    ds_read_b64_tr_b16 a[158:159], v4 offset:19200
    s_cmp_lg_u32 vcc_lo, 0
    s_cbranch_scc1 L_pfs3_0
    buffer_load_dword a255, v180, s[32:35], 0 offen offset:256
L_pfs3_0:
    v_mul_f32 v218, v218, v31
    v_mfma_f32_32x32x16_bf16 v[120:135], a[164:167], a[52:55], v[120:135]
    ds_read_b64_tr_b16 a[160:161], v2 offset:12544
    ds_read_b64_tr_b16 a[162:163], v2 offset:13056
    s_waitcnt lgkmcnt(10)
    v_mul_f32 v219, v219, v31
    v_cvt_pk_bf16_f32 v233, v218, v219
    v_accvgpr_write_b32 a73, v233
    v_mfma_f32_32x32x16_bf16 v[136:151], a[168:171], a[52:55], v[136:151]
    ds_read_b64_tr_b16 a[164:165], v4 offset:12544
    ds_read_b64_tr_b16 a[166:167], v4 offset:13056
    v_cvt_pk_bf16_f32 v220, 0, v220
    v_cvt_pk_bf16_f32 v221, 0, v221
    v_mul_f32 v220, v220, v31
    v_mul_f32 v221, v221, v31
    v_mfma_f32_32x32x16_bf16 v[152:167], a[172:175], a[52:55], v[152:167]
    ds_read_b64_tr_b16 a[168:169], v2 offset:20736
    ds_read_b64_tr_b16 a[170:171], v2 offset:21248
    s_waitcnt lgkmcnt(10)
    buffer_load_dwordx4 v17, s[28:31], s69 offen offset:3072 lds
    s_add_u32 m0, s84, 71936
    v_cvt_pk_bf16_f32 v232, v220, v221
    v_mfma_f32_32x32x16_bf16 v[104:119], a[144:147], a[56:59], v[104:119]
    ds_read_b64_tr_b16 a[172:173], v4 offset:20736
    ds_read_b64_tr_b16 a[174:175], v4 offset:21248
    v_accvgpr_write_b32 a74, v232
    v_cvt_pk_bf16_f32 v222, 0, v222
    v_cvt_pk_bf16_f32 v223, 0, v223
    v_mul_f32 v222, v222, v31
    v_mfma_f32_32x32x16_bf16 v[120:135], a[148:151], a[56:59], v[120:135]
    s_waitcnt vmcnt(11)
    s_barrier
    ds_read_b64_tr_b16 a[144:145], v8 offset:22784
    ds_read_b64_tr_b16 a[146:147], v8 offset:23040
    s_waitcnt lgkmcnt(10)
    v_mul_f32 v223, v223, v31
    v_mfma_f32_32x32x16_bf16 v[136:151], a[152:155], a[56:59], v[136:151]
    ds_read_b64_tr_b16 a[148:149], v12 offset:22784
    ds_read_b64_tr_b16 a[150:151], v12 offset:23040
    v_cvt_pk_bf16_f32 v233, v222, v223
    v_accvgpr_write_b32 a75, v233
    v_cvt_pk_bf16_f32 v224, 0, v224
    v_mfma_f32_32x32x16_bf16 v[152:167], a[156:159], a[56:59], v[152:167]
    ds_read_b64_tr_b16 a[152:153], v10 offset:22784
    ds_read_b64_tr_b16 a[154:155], v10 offset:23040
    s_waitcnt lgkmcnt(10)
    v_cvt_pk_bf16_f32 v225, 0, v225
    v_mul_f32 v224, v224, v31
    v_mul_f32 v225, v225, v31
    v_mfma_f32_32x32x16_bf16 v[104:119], a[160:163], a[60:63], v[104:119]
    ds_read_b64_tr_b16 a[156:157], v6 offset:22784
    ds_read_b64_tr_b16 a[158:159], v6 offset:23040
    v_cvt_pk_bf16_f32 v232, v224, v225
    v_accvgpr_write_b32 a76, v232
    v_cvt_pk_bf16_f32 v226, 0, v226
    v_mfma_f32_32x32x16_bf16 v[120:135], a[164:167], a[60:63], v[120:135]
    ds_read_b64_tr_b16 a[160:161], v8 offset:23808
    ds_read_b64_tr_b16 a[162:163], v8 offset:24064
    s_waitcnt lgkmcnt(10)
    v_cvt_pk_bf16_f32 v227, 0, v227
    v_mul_f32 v226, v226, v31
    v_mul_f32 v227, v227, v31
    v_mfma_f32_32x32x16_bf16 v[136:151], a[168:171], a[60:63], v[136:151]
    ds_read_b64_tr_b16 a[164:165], v12 offset:23808
    ds_read_b64_tr_b16 a[166:167], v12 offset:24064
    buffer_store_dwordx4 v[168:171], v29, s[48:51], s92 offen offset:512 sc1
    v_cvt_pk_bf16_f32 v233, v226, v227
    v_accvgpr_write_b32 a77, v233
    v_mfma_f32_32x32x16_bf16 v[152:167], a[172:175], a[60:63], v[152:167]
    ds_read_b64_tr_b16 a[168:169], v10 offset:23808
    ds_read_b64_tr_b16 a[170:171], v10 offset:24064
    s_waitcnt lgkmcnt(10)
    v_cvt_pk_bf16_f32 v228, 0, v228
    v_cvt_pk_bf16_f32 v229, 0, v229
    v_mul_f32 v228, v228, v31
    v_mfma_f32_32x32x16_bf16 v[56:71], a[144:147], a[64:67], v[56:71]
    ds_read_b64_tr_b16 a[172:173], v6 offset:23808
    ds_read_b64_tr_b16 a[174:175], v6 offset:24064
    buffer_load_dwordx4 v18, s[32:35], s78 offen lds
    v_mul_f32 v229, v229, v31
    v_cvt_pk_bf16_f32 v232, v228, v229
    v_accvgpr_write_b32 a78, v232
    v_mfma_f32_32x32x16_bf16 v[88:103], a[148:151], a[64:67], v[88:103]
    ds_read_b64_tr_b16 a[144:145], v8 offset:24832
    ds_read_b64_tr_b16 a[146:147], v8 offset:25088
    s_waitcnt lgkmcnt(10)
    v_cvt_pk_bf16_f32 v230, 0, v230
    v_cvt_pk_bf16_f32 v231, 0, v231
    v_mul_f32 v230, v230, v31
    v_mfma_f32_32x32x16_bf16 v[72:87], a[152:155], a[64:67], v[72:87]
    ds_read_b64_tr_b16 a[148:149], v12 offset:24832
    ds_read_b64_tr_b16 a[150:151], v12 offset:25088
    buffer_load_dwordx4 v19, s[32:35], s78 offen offset:1024 lds
    v_mul_f32 v231, v231, v31
    v_cvt_pk_bf16_f32 v233, v230, v231
    v_accvgpr_write_b32 a79, v233
    v_mfma_f32_32x32x16_bf16 v[216:231], v[32:35], a[88:91], v[184:199]
    v_mfma_f32_32x32x16_bf16 v[216:231], v[36:39], a[92:95], v[216:231]
    buffer_load_dwordx4 v20, s[32:35], s78 offen offset:2048 lds
    v_cvt_pk_bf16_f32 v200, 0, v200
    v_cvt_pk_bf16_f32 v201, 0, v201
    v_mul_f32 v200, v200, v31
    v_mul_f32 v201, v201, v31
    v_cvt_pk_bf16_f32 v232, v200, v201
    v_mfma_f32_32x32x16_bf16 v[40:55], a[156:159], a[64:67], v[40:55]
    ds_read_b64_tr_b16 a[152:153], v10 offset:24832
    ds_read_b64_tr_b16 a[154:155], v10 offset:25088
    s_waitcnt lgkmcnt(10)
    v_accvgpr_write_b32 a80, v232
    v_cvt_pk_bf16_f32 v202, 0, v202
    v_cvt_pk_bf16_f32 v203, 0, v203
    v_mfma_f32_32x32x16_bf16 v[56:71], a[160:163], a[68:71], v[56:71]
    ds_read_b64_tr_b16 a[156:157], v6 offset:24832
    ds_read_b64_tr_b16 a[158:159], v6 offset:25088
    v_mul_f32 v202, v202, v31
    v_mul_f32 v203, v203, v31
    v_cvt_pk_bf16_f32 v233, v202, v203
    v_accvgpr_write_b32 a81, v233
    v_mfma_f32_32x32x16_bf16 v[88:103], a[164:167], a[68:71], v[88:103]
    ds_read_b64_tr_b16 a[160:161], v8 offset:25856
    ds_read_b64_tr_b16 a[162:163], v8 offset:26112
    s_waitcnt lgkmcnt(10)
    buffer_load_dwordx4 v21, s[32:35], s78 offen offset:3072 lds
    s_add_u32 m0, s84, 88320
    v_cvt_pk_bf16_f32 v204, 0, v204
    v_mfma_f32_32x32x16_bf16 v[72:87], a[168:171], a[68:71], v[72:87]
    ds_read_b64_tr_b16 a[164:165], v12 offset:25856
    ds_read_b64_tr_b16 a[166:167], v12 offset:26112
    v_cvt_pk_bf16_f32 v205, 0, v205
    v_mul_f32 v204, v204, v31
    v_mul_f32 v205, v205, v31
    v_cvt_pk_bf16_f32 v232, v204, v205
    v_mfma_f32_32x32x16_bf16 v[40:55], a[172:175], a[68:71], v[40:55]
    ds_read_b64_tr_b16 a[168:169], v10 offset:25856
    ds_read_b64_tr_b16 a[170:171], v10 offset:26112
    s_waitcnt lgkmcnt(10)
    buffer_load_dwordx4 v14, s[28:31], s70 offen lds
    v_accvgpr_write_b32 a82, v232
    v_cvt_pk_bf16_f32 v206, 0, v206
    v_mfma_f32_32x32x16_bf16 v[56:71], a[144:147], a[72:75], v[56:71]
    ds_read_b64_tr_b16 a[172:173], v6 offset:25856
    ds_read_b64_tr_b16 a[174:175], v6 offset:26112
    v_cvt_pk_bf16_f32 v207, 0, v207
    v_mul_f32 v206, v206, v31
    v_mul_f32 v207, v207, v31
    v_cvt_pk_bf16_f32 v233, v206, v207
    v_mfma_f32_32x32x16_bf16 v[88:103], a[148:151], a[72:75], v[88:103]
    s_waitcnt vmcnt(12)
    s_barrier
    ds_read_b64_tr_b16 a[144:145], v2 offset:39168
    ds_read_b64_tr_b16 a[146:147], v2 offset:39680
    s_waitcnt lgkmcnt(10)
    v_accvgpr_write_b32 a83, v233
    v_mfma_f32_32x32x16_bf16 v[72:87], a[152:155], a[72:75], v[72:87]
    ds_read_b64_tr_b16 a[148:149], v4 offset:39168
    ds_read_b64_tr_b16 a[150:151], v4 offset:39680
    v_cvt_pk_bf16_f32 v208, 0, v208
    v_cvt_pk_bf16_f32 v209, 0, v209
    v_mul_f32 v208, v208, v31
    v_mul_f32 v209, v209, v31
    v_mfma_f32_32x32x16_bf16 v[40:55], a[156:159], a[72:75], v[40:55]
    ds_read_b64_tr_b16 a[152:153], v2 offset:47360
    ds_read_b64_tr_b16 a[154:155], v2 offset:47872
    s_waitcnt lgkmcnt(10)
    s_cmp_lg_u32 vcc_lo, 1
    s_cbranch_scc1 L_pfs4_1
    buffer_load_dword a255, v180, s[32:35], 0 offen offset:256
L_pfs4_1:
    v_mfma_f32_32x32x16_bf16 v[56:71], a[160:163], a[76:79], v[56:71]
    ds_read_b64_tr_b16 a[156:157], v4 offset:47360
    ds_read_b64_tr_b16 a[158:159], v4 offset:47872
    v_cvt_pk_bf16_f32 v232, v208, v209
    v_accvgpr_write_b32 a84, v232
    v_cvt_pk_bf16_f32 v210, 0, v210
    v_mfma_f32_32x32x16_bf16 v[88:103], a[164:167], a[76:79], v[88:103]
    ds_read_b64_tr_b16 a[160:161], v2 offset:41216
    ds_read_b64_tr_b16 a[162:163], v2 offset:41728
    s_waitcnt lgkmcnt(10)
    v_cvt_pk_bf16_f32 v211, 0, v211
    v_mul_f32 v210, v210, v31
    v_mul_f32 v211, v211, v31
    v_mfma_f32_32x32x16_bf16 v[72:87], a[168:171], a[76:79], v[72:87]
    ds_read_b64_tr_b16 a[164:165], v4 offset:41216
    ds_read_b64_tr_b16 a[166:167], v4 offset:41728
    buffer_load_dwordx4 v15, s[28:31], s70 offen offset:1024 lds
    v_cvt_pk_bf16_f32 v233, v210, v211
    v_accvgpr_write_b32 a85, v233
    v_mfma_f32_32x32x16_bf16 v[40:55], a[172:175], a[76:79], v[40:55]
    ds_read_b64_tr_b16 a[168:169], v2 offset:49408
    ds_read_b64_tr_b16 a[170:171], v2 offset:49920
    s_waitcnt lgkmcnt(10)
    v_cvt_pk_bf16_f32 v212, 0, v212
    v_cvt_pk_bf16_f32 v213, 0, v213
    v_mul_f32 v212, v212, v31
    v_mfma_f32_32x32x16_bf16 v[104:119], a[144:147], a[64:67], v[104:119]
    ds_read_b64_tr_b16 a[172:173], v4 offset:49408
    ds_read_b64_tr_b16 a[174:175], v4 offset:49920
    v_mul_f32 v213, v213, v31
    v_cvt_pk_bf16_f32 v232, v212, v213
    v_accvgpr_write_b32 a86, v232
    v_cvt_pk_bf16_f32 v214, 0, v214
    v_mfma_f32_32x32x16_bf16 v[120:135], a[148:151], a[64:67], v[120:135]
    ds_read_b64_tr_b16 a[144:145], v2 offset:43264
    ds_read_b64_tr_b16 a[146:147], v2 offset:43776
    s_waitcnt lgkmcnt(10)
    v_cvt_pk_bf16_f32 v215, 0, v215
    v_mul_f32 v214, v214, v31
    v_mul_f32 v215, v215, v31
    v_mfma_f32_32x32x16_bf16 v[136:151], a[152:155], a[64:67], v[136:151]
    ds_read_b64_tr_b16 a[148:149], v4 offset:43264
    ds_read_b64_tr_b16 a[150:151], v4 offset:43776
    v_cvt_pk_bf16_f32 v233, v214, v215
    v_accvgpr_write_b32 a87, v233
    v_mfma_f32_32x32x16_bf16 v[200:215], v[32:35], a[96:99], v[184:199]
    v_mfma_f32_32x32x16_bf16 v[200:215], v[36:39], a[100:103], v[200:215]
    v_cvt_pk_bf16_f32 v216, 0, v216
    v_cvt_pk_bf16_f32 v217, 0, v217
    v_mul_f32 v216, v216, v31
    v_mul_f32 v217, v217, v31
    v_cvt_pk_bf16_f32 v232, v216, v217
    v_accvgpr_write_b32 a88, v232
    v_mfma_f32_32x32x16_bf16 v[152:167], a[156:159], a[64:67], v[152:167]
    ds_read_b64_tr_b16 a[152:153], v2 offset:51456
    ds_read_b64_tr_b16 a[154:155], v2 offset:51968
    s_waitcnt lgkmcnt(10)
    buffer_load_dwordx4 v16, s[28:31], s70 offen offset:2048 lds
    v_cvt_pk_bf16_f32 v218, 0, v218
    v_cvt_pk_bf16_f32 v219, 0, v219
    v_mfma_f32_32x32x16_bf16 v[104:119], a[160:163], a[68:71], v[104:119]
    ds_read_b64_tr_b16 a[156:157], v4 offset:51456
    ds_read_b64_tr_b16 a[158:159], v4 offset:51968
    v_mul_f32 v218, v218, v31
    v_mul_f32 v219, v219, v31
    v_cvt_pk_bf16_f32 v233, v218, v219
    v_accvgpr_write_b32 a89, v233
    v_mfma_f32_32x32x16_bf16 v[120:135], a[164:167], a[68:71], v[120:135]
    ds_read_b64_tr_b16 a[160:161], v2 offset:45312
    ds_read_b64_tr_b16 a[162:163], v2 offset:45824
    s_waitcnt lgkmcnt(10)
    v_cvt_pk_bf16_f32 v220, 0, v220
    v_cvt_pk_bf16_f32 v221, 0, v221
    v_mul_f32 v220, v220, v31
    v_mfma_f32_32x32x16_bf16 v[136:151], a[168:171], a[68:71], v[136:151]
    ds_read_b64_tr_b16 a[164:165], v4 offset:45312
    ds_read_b64_tr_b16 a[166:167], v4 offset:45824
    v_mul_f32 v221, v221, v31
    v_cvt_pk_bf16_f32 v232, v220, v221
    v_accvgpr_write_b32 a90, v232
    v_cvt_pk_bf16_f32 v222, 0, v222
    v_mfma_f32_32x32x16_bf16 v[152:167], a[172:175], a[68:71], v[152:167]
    ds_read_b64_tr_b16 a[168:169], v2 offset:53504
    ds_read_b64_tr_b16 a[170:171], v2 offset:54016
    s_waitcnt lgkmcnt(10)
    v_cvt_pk_bf16_f32 v223, 0, v223
    v_mul_f32 v222, v222, v31
    v_mul_f32 v223, v223, v31
    v_mfma_f32_32x32x16_bf16 v[104:119], a[144:147], a[72:75], v[104:119]
    ds_read_b64_tr_b16 a[172:173], v4 offset:53504
    ds_read_b64_tr_b16 a[174:175], v4 offset:54016
    v_cvt_pk_bf16_f32 v233, v222, v223
    v_accvgpr_write_b32 a91, v233
    v_cvt_pk_bf16_f32 v224, 0, v224
    v_mfma_f32_32x32x16_bf16 v[120:135], a[148:151], a[72:75], v[120:135]
    s_waitcnt vmcnt(8)
    s_barrier
    ds_read_b64_tr_b16 a[144:145], v8 offset:55552
    ds_read_b64_tr_b16 a[146:147], v8 offset:55808
    s_waitcnt lgkmcnt(10)
    v_cvt_pk_bf16_f32 v225, 0, v225
    v_mfma_f32_32x32x16_bf16 v[136:151], a[152:155], a[72:75], v[136:151]
    ds_read_b64_tr_b16 a[148:149], v12 offset:55552
    ds_read_b64_tr_b16 a[150:151], v12 offset:55808
    buffer_load_dwordx4 v17, s[28:31], s70 offen offset:3072 lds
    s_add_u32 m0, s84, 104704
    v_mul_f32 v224, v224, v31
    v_mul_f32 v225, v225, v31
    v_mfma_f32_32x32x16_bf16 v[152:167], a[156:159], a[72:75], v[152:167]
    ds_read_b64_tr_b16 a[152:153], v10 offset:55552
    ds_read_b64_tr_b16 a[154:155], v10 offset:55808
    s_waitcnt lgkmcnt(10)
    v_cvt_pk_bf16_f32 v232, v224, v225
    v_accvgpr_write_b32 a92, v232
    v_cvt_pk_bf16_f32 v226, 0, v226
    v_mfma_f32_32x32x16_bf16 v[104:119], a[160:163], a[76:79], v[104:119]
    ds_read_b64_tr_b16 a[156:157], v6 offset:55552
    ds_read_b64_tr_b16 a[158:159], v6 offset:55808
    v_cvt_pk_bf16_f32 v227, 0, v227
    v_mul_f32 v226, v226, v31
    v_mul_f32 v227, v227, v31
    v_cvt_pk_bf16_f32 v233, v226, v227
    v_mfma_f32_32x32x16_bf16 v[120:135], a[164:167], a[76:79], v[120:135]
    ds_read_b64_tr_b16 a[160:161], v8 offset:56576
    ds_read_b64_tr_b16 a[162:163], v8 offset:56832
    s_waitcnt lgkmcnt(10)
    v_accvgpr_write_b32 a93, v233
    v_cvt_pk_bf16_f32 v228, 0, v228
    v_cvt_pk_bf16_f32 v229, 0, v229
    v_mfma_f32_32x32x16_bf16 v[136:151], a[168:171], a[76:79], v[136:151]
    ds_read_b64_tr_b16 a[164:165], v12 offset:56576
    ds_read_b64_tr_b16 a[166:167], v12 offset:56832
    v_mul_f32 v228, v228, v31
    v_mul_f32 v229, v229, v31
    v_cvt_pk_bf16_f32 v232, v228, v229
    v_accvgpr_write_b32 a94, v232
    v_mfma_f32_32x32x16_bf16 v[152:167], a[172:175], a[76:79], v[152:167]
    ds_read_b64_tr_b16 a[168:169], v10 offset:56576
    ds_read_b64_tr_b16 a[170:171], v10 offset:56832
    s_waitcnt lgkmcnt(10)
    v_cvt_pk_bf16_f32 v230, 0, v230
    v_cvt_pk_bf16_f32 v231, 0, v231
    v_mul_f32 v230, v230, v31
    v_mfma_f32_32x32x16_bf16 v[56:71], a[144:147], a[80:83], v[56:71]
    ds_read_b64_tr_b16 a[172:173], v6 offset:56576
    ds_read_b64_tr_b16 a[174:175], v6 offset:56832
    v_mul_f32 v231, v231, v31
    v_cvt_pk_bf16_f32 v233, v230, v231
    v_accvgpr_write_b32 a95, v233
    v_mfma_f32_32x32x16_bf16 v[216:231], v[32:35], a[104:107], v[184:199]
    buffer_load_dwordx4 v18, s[32:35], s79 offen lds
    buffer_load_dword v172, v173, s[48:51], s14 offen sc1
    v_mfma_f32_32x32x16_bf16 v[216:231], v[36:39], a[108:111], v[216:231]
    v_cvt_pk_bf16_f32 v200, 0, v200
    v_cvt_pk_bf16_f32 v201, 0, v201
    v_mul_f32 v200, v200, v31
    v_mul_f32 v201, v201, v31
    v_cvt_pk_bf16_f32 v232, v200, v201
    v_accvgpr_write_b32 a96, v232
    v_mfma_f32_32x32x16_bf16 v[88:103], a[148:151], a[80:83], v[88:103]
    ds_read_b64_tr_b16 a[144:145], v8 offset:57600
    ds_read_b64_tr_b16 a[146:147], v8 offset:57856
    s_waitcnt lgkmcnt(10)
    buffer_load_dwordx4 v19, s[32:35], s79 offen offset:1024 lds
    v_cvt_pk_bf16_f32 v202, 0, v202
    v_cvt_pk_bf16_f32 v203, 0, v203
    v_mfma_f32_32x32x16_bf16 v[72:87], a[152:155], a[80:83], v[72:87]
    ds_read_b64_tr_b16 a[148:149], v12 offset:57600
    ds_read_b64_tr_b16 a[150:151], v12 offset:57856
    v_mul_f32 v202, v202, v31
    v_mul_f32 v203, v203, v31
    v_cvt_pk_bf16_f32 v233, v202, v203
    v_accvgpr_write_b32 a97, v233
    v_mfma_f32_32x32x16_bf16 v[40:55], a[156:159], a[80:83], v[40:55]
    ds_read_b64_tr_b16 a[152:153], v10 offset:57600
    ds_read_b64_tr_b16 a[154:155], v10 offset:57856
    s_waitcnt lgkmcnt(10)
    buffer_load_dwordx4 v20, s[32:35], s79 offen offset:2048 lds
    s_andn2_b32 vcc_lo, 1, s60
    v_cvt_pk_bf16_f32 v204, 0, v204
    v_mfma_f32_32x32x16_bf16 v[56:71], a[160:163], a[84:87], v[56:71]
    ds_read_b64_tr_b16 a[156:157], v6 offset:57600
    ds_read_b64_tr_b16 a[158:159], v6 offset:57856
    s_cmp_lg_u32 vcc_lo, 0
    s_cbranch_scc1 L_pfs8_0
    s_mul_i32 s18, s17, 10368
    buffer_load_dword a255, v183, s[36:39], s18 offen
L_pfs8_0:
    v_mfma_f32_32x32x16_bf16 v[88:103], a[164:167], a[84:87], v[88:103]
    ds_read_b64_tr_b16 a[160:161], v8 offset:58624
    ds_read_b64_tr_b16 a[162:163], v8 offset:58880
    s_waitcnt lgkmcnt(10)
    buffer_load_dwordx4 v21, s[32:35], s79 offen offset:3072 lds
    s_add_u32 m0, s84, 6400
    v_cvt_pk_bf16_f32 v205, 0, v205
    v_mfma_f32_32x32x16_bf16 v[72:87], a[168:171], a[84:87], v[72:87]
    ds_read_b64_tr_b16 a[164:165], v12 offset:58624
    ds_read_b64_tr_b16 a[166:167], v12 offset:58880
    v_mul_f32 v204, v204, v31
    v_mul_f32 v205, v205, v31
    v_cvt_pk_bf16_f32 v232, v204, v205
    v_accvgpr_write_b32 a98, v232
    v_mfma_f32_32x32x16_bf16 v[40:55], a[172:175], a[84:87], v[40:55]
    ds_read_b64_tr_b16 a[168:169], v10 offset:58624
    ds_read_b64_tr_b16 a[170:171], v10 offset:58880
    s_waitcnt lgkmcnt(10)
    v_cvt_pk_bf16_f32 v206, 0, v206
    v_cvt_pk_bf16_f32 v207, 0, v207
    v_mul_f32 v206, v206, v31
    v_mfma_f32_32x32x16_bf16 v[56:71], a[144:147], a[88:91], v[56:71]
    ds_read_b64_tr_b16 a[172:173], v6 offset:58624
    ds_read_b64_tr_b16 a[174:175], v6 offset:58880
    buffer_load_dwordx4 v14, s[28:31], s71 offen lds
    v_mul_f32 v207, v207, v31
    v_cvt_pk_bf16_f32 v233, v206, v207
    v_accvgpr_write_b32 a99, v233
    v_mfma_f32_32x32x16_bf16 v[88:103], a[148:151], a[88:91], v[88:103]
    s_waitcnt vmcnt(10)
    s_barrier
    ds_read_b64_tr_b16 a[144:145], v3 offset:7424
    ds_read_b64_tr_b16 a[146:147], v3 offset:7936
    s_waitcnt lgkmcnt(10)
    v_cvt_pk_bf16_f32 v208, 0, v208
    v_mfma_f32_32x32x16_bf16 v[72:87], a[152:155], a[88:91], v[72:87]
    ds_read_b64_tr_b16 a[148:149], v5 offset:7424
    ds_read_b64_tr_b16 a[150:151], v5 offset:7936
    v_cvt_pk_bf16_f32 v209, 0, v209
    v_mul_f32 v208, v208, v31
    v_mul_f32 v209, v209, v31
    v_cvt_pk_bf16_f32 v232, v208, v209
    v_mfma_f32_32x32x16_bf16 v[40:55], a[156:159], a[88:91], v[40:55]
    ds_read_b64_tr_b16 a[152:153], v3 offset:15616
    ds_read_b64_tr_b16 a[154:155], v3 offset:16128
    s_waitcnt lgkmcnt(10)
    v_accvgpr_write_b32 a100, v232
    v_cvt_pk_bf16_f32 v210, 0, v210
    v_cvt_pk_bf16_f32 v211, 0, v211
    v_mfma_f32_32x32x16_bf16 v[56:71], a[160:163], a[92:95], v[56:71]
    ds_read_b64_tr_b16 a[156:157], v5 offset:15616
    ds_read_b64_tr_b16 a[158:159], v5 offset:16128
    v_mul_f32 v210, v210, v31
    v_mul_f32 v211, v211, v31
    v_cvt_pk_bf16_f32 v233, v210, v211
    v_accvgpr_write_b32 a101, v233
    v_mfma_f32_32x32x16_bf16 v[88:103], a[164:167], a[92:95], v[88:103]
    ds_read_b64_tr_b16 a[160:161], v3 offset:9472
    ds_read_b64_tr_b16 a[162:163], v3 offset:9984
    s_waitcnt lgkmcnt(10)
    v_cvt_pk_bf16_f32 v212, 0, v212
    v_cvt_pk_bf16_f32 v213, 0, v213
    v_mul_f32 v212, v212, v31
    v_mfma_f32_32x32x16_bf16 v[72:87], a[168:171], a[92:95], v[72:87]
    ds_read_b64_tr_b16 a[164:165], v5 offset:9472
    ds_read_b64_tr_b16 a[166:167], v5 offset:9984
    v_mul_f32 v213, v213, v31
    v_cvt_pk_bf16_f32 v232, v212, v213
    v_accvgpr_write_b32 a102, v232
    v_cvt_pk_bf16_f32 v214, 0, v214
    v_mfma_f32_32x32x16_bf16 v[40:55], a[172:175], a[92:95], v[40:55]
    ds_read_b64_tr_b16 a[168:169], v3 offset:17664
    ds_read_b64_tr_b16 a[170:171], v3 offset:18176
    s_waitcnt lgkmcnt(10)
    buffer_load_dwordx4 v15, s[28:31], s71 offen offset:1024 lds
    v_cvt_pk_bf16_f32 v215, 0, v215
    v_mul_f32 v214, v214, v31
    v_mfma_f32_32x32x16_bf16 v[104:119], a[144:147], a[80:83], v[104:119]
    ds_read_b64_tr_b16 a[172:173], v5 offset:17664
    ds_read_b64_tr_b16 a[174:175], v5 offset:18176
    v_mul_f32 v215, v215, v31
    v_cvt_pk_bf16_f32 v233, v214, v215
    v_accvgpr_write_b32 a103, v233
    v_mfma_f32_32x32x16_bf16 v[200:215], v[32:35], a[112:115], v[184:199]
    v_mfma_f32_32x32x16_bf16 v[200:215], v[36:39], a[116:119], v[200:215]
    v_cvt_pk_bf16_f32 v216, 0, v216
    v_cvt_pk_bf16_f32 v217, 0, v217
    v_mul_f32 v216, v216, v31
    v_mul_f32 v217, v217, v31
    v_cvt_pk_bf16_f32 v232, v216, v217
    v_accvgpr_write_b32 a104, v232
    v_mfma_f32_32x32x16_bf16 v[120:135], a[148:151], a[80:83], v[120:135]
    ds_read_b64_tr_b16 a[144:145], v3 offset:11520
    ds_read_b64_tr_b16 a[146:147], v3 offset:12032
    s_waitcnt lgkmcnt(10)
    v_cvt_pk_bf16_f32 v218, 0, v218
    v_cvt_pk_bf16_f32 v219, 0, v219
    v_mul_f32 v218, v218, v31
    v_mfma_f32_32x32x16_bf16 v[136:151], a[152:155], a[80:83], v[136:151]
    ds_read_b64_tr_b16 a[148:149], v5 offset:11520
    ds_read_b64_tr_b16 a[150:151], v5 offset:12032
    v_mul_f32 v219, v219, v31
    v_cvt_pk_bf16_f32 v233, v218, v219
    v_accvgpr_write_b32 a105, v233
    v_cvt_pk_bf16_f32 v220, 0, v220
    v_mfma_f32_32x32x16_bf16 v[152:167], a[156:159], a[80:83], v[152:167]
    ds_read_b64_tr_b16 a[152:153], v3 offset:19712
    ds_read_b64_tr_b16 a[154:155], v3 offset:20224
    s_waitcnt lgkmcnt(10)
    v_cvt_pk_bf16_f32 v221, 0, v221
    v_mul_f32 v220, v220, v31
    v_mul_f32 v221, v221, v31
    v_mfma_f32_32x32x16_bf16 v[104:119], a[160:163], a[84:87], v[104:119]
    ds_read_b64_tr_b16 a[156:157], v5 offset:19712
    ds_read_b64_tr_b16 a[158:159], v5 offset:20224
    buffer_load_dwordx4 v16, s[28:31], s71 offen offset:2048 lds
    v_cvt_pk_bf16_f32 v232, v220, v221
    v_accvgpr_write_b32 a106, v232
    v_mfma_f32_32x32x16_bf16 v[120:135], a[164:167], a[84:87], v[120:135]
    ds_read_b64_tr_b16 a[160:161], v3 offset:13568
    ds_read_b64_tr_b16 a[162:163], v3 offset:14080
    s_waitcnt lgkmcnt(10)
    v_cvt_pk_bf16_f32 v222, 0, v222
    v_cvt_pk_bf16_f32 v223, 0, v223
    v_mul_f32 v222, v222, v31
    v_mfma_f32_32x32x16_bf16 v[136:151], a[168:171], a[84:87], v[136:151]
    ds_read_b64_tr_b16 a[164:165], v5 offset:13568
    ds_read_b64_tr_b16 a[166:167], v5 offset:14080
    s_cmp_lg_u32 vcc_lo, 1
    s_cbranch_scc1 L_pfs9_1
    s_mul_i32 s18, s17, 10368
    buffer_load_dword a255, v183, s[36:39], s18 offen
L_pfs9_1:
    v_mfma_f32_32x32x16_bf16 v[152:167], a[172:175], a[84:87], v[152:167]
    ds_read_b64_tr_b16 a[168:169], v3 offset:21760
    ds_read_b64_tr_b16 a[170:171], v3 offset:22272
    s_waitcnt lgkmcnt(10)
    v_mul_f32 v223, v223, v31
    v_cvt_pk_bf16_f32 v233, v222, v223
    v_accvgpr_write_b32 a107, v233
    v_mfma_f32_32x32x16_bf16 v[104:119], a[144:147], a[88:91], v[104:119]
    ds_read_b64_tr_b16 a[172:173], v5 offset:21760
    ds_read_b64_tr_b16 a[174:175], v5 offset:22272
    v_cvt_pk_bf16_f32 v224, 0, v224
    v_cvt_pk_bf16_f32 v225, 0, v225
    v_mul_f32 v224, v224, v31
    v_mul_f32 v225, v225, v31
    v_mfma_f32_32x32x16_bf16 v[120:135], a[148:151], a[88:91], v[120:135]
    s_waitcnt vmcnt(8)
    s_barrier
    ds_read_b64_tr_b16 a[144:145], v9 offset:23808
    ds_read_b64_tr_b16 a[146:147], v9 offset:24064
    s_waitcnt lgkmcnt(10)
    v_cvt_pk_bf16_f32 v232, v224, v225
    v_mfma_f32_32x32x16_bf16 v[136:151], a[152:155], a[88:91], v[136:151]
    ds_read_b64_tr_b16 a[148:149], v13 offset:23808
    ds_read_b64_tr_b16 a[150:151], v13 offset:24064
    v_accvgpr_write_b32 a108, v232
    v_cvt_pk_bf16_f32 v226, 0, v226
    v_cvt_pk_bf16_f32 v227, 0, v227
    v_mul_f32 v226, v226, v31
    v_mfma_f32_32x32x16_bf16 v[152:167], a[156:159], a[88:91], v[152:167]
    ds_read_b64_tr_b16 a[152:153], v11 offset:23808
    ds_read_b64_tr_b16 a[154:155], v11 offset:24064
    s_waitcnt lgkmcnt(10)
    buffer_load_dwordx4 v17, s[28:31], s71 offen offset:3072 lds
    s_add_u32 m0, s84, 22784
    v_mul_f32 v227, v227, v31
    v_mfma_f32_32x32x16_bf16 v[104:119], a[160:163], a[92:95], v[104:119]
    ds_read_b64_tr_b16 a[156:157], v7 offset:23808
    ds_read_b64_tr_b16 a[158:159], v7 offset:24064
    v_cvt_pk_bf16_f32 v233, v226, v227
    v_accvgpr_write_b32 a109, v233
    v_cvt_pk_bf16_f32 v228, 0, v228
    v_mfma_f32_32x32x16_bf16 v[120:135], a[164:167], a[92:95], v[120:135]
    ds_read_b64_tr_b16 a[160:161], v9 offset:24832
    ds_read_b64_tr_b16 a[162:163], v9 offset:25088
    s_waitcnt lgkmcnt(10)
    v_cvt_pk_bf16_f32 v229, 0, v229
    v_mul_f32 v228, v228, v31
    v_mul_f32 v229, v229, v31
    v_mfma_f32_32x32x16_bf16 v[136:151], a[168:171], a[92:95], v[136:151]
    ds_read_b64_tr_b16 a[164:165], v13 offset:24832
    ds_read_b64_tr_b16 a[166:167], v13 offset:25088
    v_cvt_pk_bf16_f32 v232, v228, v229
    v_accvgpr_write_b32 a110, v232
    v_cvt_pk_bf16_f32 v230, 0, v230
    v_mfma_f32_32x32x16_bf16 v[152:167], a[172:175], a[92:95], v[152:167]
    ds_read_b64_tr_b16 a[168:169], v11 offset:24832
    ds_read_b64_tr_b16 a[170:171], v11 offset:25088
    s_waitcnt lgkmcnt(10)
    v_cvt_pk_bf16_f32 v231, 0, v231
    v_mul_f32 v230, v230, v31
    v_mul_f32 v231, v231, v31
    v_mfma_f32_32x32x16_bf16 v[56:71], a[144:147], a[96:99], v[56:71]
    ds_read_b64_tr_b16 a[172:173], v7 offset:24832
    ds_read_b64_tr_b16 a[174:175], v7 offset:25088
    v_cvt_pk_bf16_f32 v233, v230, v231
    v_accvgpr_write_b32 a111, v233
    v_mfma_f32_32x32x16_bf16 v[216:231], v[32:35], a[120:123], v[184:199]
    v_mfma_f32_32x32x16_bf16 v[216:231], v[36:39], a[124:127], v[216:231]
    buffer_load_dwordx4 v18, s[32:35], s80 offen lds
    v_cvt_pk_bf16_f32 v200, 0, v200
    v_cvt_pk_bf16_f32 v201, 0, v201
    v_mul_f32 v200, v200, v31
    v_mul_f32 v201, v201, v31
    v_cvt_pk_bf16_f32 v232, v200, v201
    v_mfma_f32_32x32x16_bf16 v[88:103], a[148:151], a[96:99], v[88:103]
    ds_read_b64_tr_b16 a[144:145], v9 offset:25856
    ds_read_b64_tr_b16 a[146:147], v9 offset:26112
    s_waitcnt lgkmcnt(10)
    v_accvgpr_write_b32 a112, v232
    v_cvt_pk_bf16_f32 v202, 0, v202
    v_cvt_pk_bf16_f32 v203, 0, v203
    v_mfma_f32_32x32x16_bf16 v[72:87], a[152:155], a[96:99], v[72:87]
    ds_read_b64_tr_b16 a[148:149], v13 offset:25856
    ds_read_b64_tr_b16 a[150:151], v13 offset:26112
    buffer_load_dwordx4 v19, s[32:35], s80 offen offset:1024 lds
    v_mul_f32 v202, v202, v31
    v_mul_f32 v203, v203, v31
    v_cvt_pk_bf16_f32 v233, v202, v203
    v_mfma_f32_32x32x16_bf16 v[40:55], a[156:159], a[96:99], v[40:55]
    ds_read_b64_tr_b16 a[152:153], v11 offset:25856
    ds_read_b64_tr_b16 a[154:155], v11 offset:26112
    s_waitcnt lgkmcnt(10)
    s_waitcnt vmcnt(9)
    v_cmp_ne_u32_e64 s[6:7], 1, v172
    v_accvgpr_write_b32 a113, v233
    v_mfma_f32_32x32x16_bf16 v[56:71], a[160:163], a[100:103], v[56:71]
    ds_read_b64_tr_b16 a[156:157], v7 offset:25856
    ds_read_b64_tr_b16 a[158:159], v7 offset:26112
    buffer_load_dwordx4 v20, s[32:35], s80 offen offset:2048 lds
    s_cmp_lg_u64 s[6:7], 0
    s_cbranch_scc1 L_slow_7
L_back_8:
    v_cvt_pk_bf16_f32 v204, 0, v204
    v_mfma_f32_32x32x16_bf16 v[88:103], a[164:167], a[100:103], v[88:103]
    ds_read_b64_tr_b16 a[160:161], v9 offset:26880
    ds_read_b64_tr_b16 a[162:163], v9 offset:27136
    s_waitcnt lgkmcnt(10)
    v_cvt_pk_bf16_f32 v205, 0, v205
    v_mul_f32 v204, v204, v31
    v_mul_f32 v205, v205, v31
    v_mfma_f32_32x32x16_bf16 v[72:87], a[168:171], a[100:103], v[72:87]
    ds_read_b64_tr_b16 a[164:165], v13 offset:26880
    ds_read_b64_tr_b16 a[166:167], v13 offset:27136
    buffer_load_dwordx4 v21, s[32:35], s80 offen offset:3072 lds
    s_add_u32 m0, s84, 39168
    v_cvt_pk_bf16_f32 v232, v204, v205
    v_mfma_f32_32x32x16_bf16 v[40:55], a[172:175], a[100:103], v[40:55]
    ds_read_b64_tr_b16 a[168:169], v11 offset:26880
    ds_read_b64_tr_b16 a[170:171], v11 offset:27136
    s_waitcnt lgkmcnt(10)
    v_accvgpr_write_b32 a114, v232
    v_cvt_pk_bf16_f32 v206, 0, v206
    v_cvt_pk_bf16_f32 v207, 0, v207
    v_mfma_f32_32x32x16_bf16 v[56:71], a[144:147], a[104:107], v[56:71]
    ds_read_b64_tr_b16 a[172:173], v7 offset:26880
    ds_read_b64_tr_b16 a[174:175], v7 offset:27136
    buffer_load_dwordx4 v14, s[28:31], s72 offen lds
    v_mul_f32 v206, v206, v31
    v_mul_f32 v207, v207, v31
    v_cvt_pk_bf16_f32 v233, v206, v207
    v_mfma_f32_32x32x16_bf16 v[88:103], a[148:151], a[104:107], v[88:103]
    s_waitcnt vmcnt(9)
    s_barrier
    ds_read_b64_tr_b16 a[144:145], v3 offset:40192
    ds_read_b64_tr_b16 a[146:147], v3 offset:40704
    s_waitcnt lgkmcnt(10)
    v_accvgpr_write_b32 a115, v233
    v_mfma_f32_32x32x16_bf16 v[72:87], a[152:155], a[104:107], v[72:87]
    ds_read_b64_tr_b16 a[148:149], v5 offset:40192
    ds_read_b64_tr_b16 a[150:151], v5 offset:40704
    v_cvt_pk_bf16_f32 v208, 0, v208
    v_cvt_pk_bf16_f32 v209, 0, v209
    v_mul_f32 v208, v208, v31
    v_mul_f32 v209, v209, v31
    v_mfma_f32_32x32x16_bf16 v[40:55], a[156:159], a[104:107], v[40:55]
    ds_read_b64_tr_b16 a[152:153], v3 offset:48384
    ds_read_b64_tr_b16 a[154:155], v3 offset:48896
    s_waitcnt lgkmcnt(10)
    v_cvt_pk_bf16_f32 v232, v208, v209
    v_accvgpr_write_b32 a116, v232
    v_cvt_pk_bf16_f32 v210, 0, v210
    v_mfma_f32_32x32x16_bf16 v[56:71], a[160:163], a[108:111], v[56:71]
    ds_read_b64_tr_b16 a[156:157], v5 offset:48384
    ds_read_b64_tr_b16 a[158:159], v5 offset:48896
    s_andn2_b32 vcc_lo, 1, s60
    s_cmp_lg_u32 vcc_lo, 0
    s_cbranch_scc1 L_pfs10_0
    s_mul_i32 s18, s17, 10368
    s_add_u32 s18, s18, 5120
    buffer_load_dword a255, v183, s[36:39], s18 offen
    s_mul_i32 s18, s17, 1296
    s_mov_b64 exec, 0x7ff
    buffer_load_dword a255, v183, s[40:43], s18 offen
    s_mov_b64 exec, -1
L_pfs10_0:
    v_mfma_f32_32x32x16_bf16 v[88:103], a[164:167], a[108:111], v[88:103]
    ds_read_b64_tr_b16 a[160:161], v3 offset:42240
    ds_read_b64_tr_b16 a[162:163], v3 offset:42752
    s_waitcnt lgkmcnt(10)
    v_cvt_pk_bf16_f32 v211, 0, v211
    v_mul_f32 v210, v210, v31
    v_mul_f32 v211, v211, v31
    v_mfma_f32_32x32x16_bf16 v[72:87], a[168:171], a[108:111], v[72:87]
    ds_read_b64_tr_b16 a[164:165], v5 offset:42240
    ds_read_b64_tr_b16 a[166:167], v5 offset:42752
    v_cvt_pk_bf16_f32 v233, v210, v211
    v_accvgpr_write_b32 a117, v233
    v_cvt_pk_bf16_f32 v212, 0, v212
    v_mfma_f32_32x32x16_bf16 v[40:55], a[172:175], a[108:111], v[40:55]
    ds_read_b64_tr_b16 a[168:169], v3 offset:50432
    ds_read_b64_tr_b16 a[170:171], v3 offset:50944
    s_waitcnt lgkmcnt(10)
    buffer_load_dwordx4 v15, s[28:31], s72 offen offset:1024 lds
    v_cvt_pk_bf16_f32 v213, 0, v213
    v_mul_f32 v212, v212, v31
    v_mfma_f32_32x32x16_bf16 v[104:119], a[144:147], a[96:99], v[104:119]
    ds_read_b64_tr_b16 a[172:173], v5 offset:50432
    ds_read_b64_tr_b16 a[174:175], v5 offset:50944
    v_mul_f32 v213, v213, v31
    v_cvt_pk_bf16_f32 v232, v212, v213
    v_accvgpr_write_b32 a118, v232
    v_cvt_pk_bf16_f32 v214, 0, v214
    v_mfma_f32_32x32x16_bf16 v[120:135], a[148:151], a[96:99], v[120:135]
    ds_read_b64_tr_b16 a[144:145], v3 offset:44288
    ds_read_b64_tr_b16 a[146:147], v3 offset:44800
    s_waitcnt lgkmcnt(10)
    v_cvt_pk_bf16_f32 v215, 0, v215
    v_mul_f32 v214, v214, v31
    v_mul_f32 v215, v215, v31
    v_mfma_f32_32x32x16_bf16 v[136:151], a[152:155], a[96:99], v[136:151]
    ds_read_b64_tr_b16 a[148:149], v5 offset:44288
    ds_read_b64_tr_b16 a[150:151], v5 offset:44800
    v_cvt_pk_bf16_f32 v233, v214, v215
    v_accvgpr_write_b32 a119, v233
    v_mfma_f32_32x32x16_bf16 v[200:215], v[32:35], a[128:131], v[184:199]
    v_mfma_f32_32x32x16_bf16 v[200:215], v[36:39], a[132:135], v[200:215]
    v_cvt_pk_bf16_f32 v216, 0, v216
    v_cvt_pk_bf16_f32 v217, 0, v217
    v_mul_f32 v216, v216, v31
    v_mul_f32 v217, v217, v31
    v_cvt_pk_bf16_f32 v232, v216, v217
    v_accvgpr_write_b32 a120, v232
    v_mfma_f32_32x32x16_bf16 v[152:167], a[156:159], a[96:99], v[152:167]
    ds_read_b64_tr_b16 a[152:153], v3 offset:52480
    ds_read_b64_tr_b16 a[154:155], v3 offset:52992
    s_waitcnt lgkmcnt(10)
    v_cvt_pk_bf16_f32 v218, 0, v218
    v_cvt_pk_bf16_f32 v219, 0, v219
    v_mul_f32 v218, v218, v31
    v_mfma_f32_32x32x16_bf16 v[104:119], a[160:163], a[100:103], v[104:119]
    ds_read_b64_tr_b16 a[156:157], v5 offset:52480
    ds_read_b64_tr_b16 a[158:159], v5 offset:52992
    buffer_load_dwordx4 v16, s[28:31], s72 offen offset:2048 lds
    v_mul_f32 v219, v219, v31
    v_cvt_pk_bf16_f32 v233, v218, v219
    v_accvgpr_write_b32 a121, v233
    v_mfma_f32_32x32x16_bf16 v[120:135], a[164:167], a[100:103], v[120:135]
    ds_read_b64_tr_b16 a[160:161], v3 offset:46336
    ds_read_b64_tr_b16 a[162:163], v3 offset:46848
    s_waitcnt lgkmcnt(10)
    v_cvt_pk_bf16_f32 v220, 0, v220
    v_cvt_pk_bf16_f32 v221, 0, v221
    v_mul_f32 v220, v220, v31
    v_mfma_f32_32x32x16_bf16 v[136:151], a[168:171], a[100:103], v[136:151]
    ds_read_b64_tr_b16 a[164:165], v5 offset:46336
    ds_read_b64_tr_b16 a[166:167], v5 offset:46848
    v_mul_f32 v221, v221, v31
    v_cvt_pk_bf16_f32 v232, v220, v221
    v_accvgpr_write_b32 a122, v232
    v_cvt_pk_bf16_f32 v222, 0, v222
    v_mfma_f32_32x32x16_bf16 v[152:167], a[172:175], a[100:103], v[152:167]
    ds_read_b64_tr_b16 a[168:169], v3 offset:54528
    ds_read_b64_tr_b16 a[170:171], v3 offset:55040
    s_waitcnt lgkmcnt(10)
    v_cvt_pk_bf16_f32 v223, 0, v223
    v_mul_f32 v222, v222, v31
    v_mul_f32 v223, v223, v31
    v_mfma_f32_32x32x16_bf16 v[104:119], a[144:147], a[104:107], v[104:119]
    ds_read_b64_tr_b16 a[172:173], v5 offset:54528
    ds_read_b64_tr_b16 a[174:175], v5 offset:55040
    v_cvt_pk_bf16_f32 v233, v222, v223
    v_accvgpr_write_b32 a123, v233
    v_cvt_pk_bf16_f32 v224, 0, v224
    v_mfma_f32_32x32x16_bf16 v[120:135], a[148:151], a[104:107], v[120:135]
    s_waitcnt vmcnt(7)
    s_barrier
    ds_read_b64_tr_b16 a[144:145], v8 offset:6400
    ds_read_b64_tr_b16 a[146:147], v8 offset:6656
    s_waitcnt lgkmcnt(10)
    v_cvt_pk_bf16_f32 v225, 0, v225
    v_mfma_f32_32x32x16_bf16 v[136:151], a[152:155], a[104:107], v[136:151]
    ds_read_b64_tr_b16 a[148:149], v12 offset:6400
    ds_read_b64_tr_b16 a[150:151], v12 offset:6656
    v_mul_f32 v224, v224, v31
    v_mul_f32 v225, v225, v31
    v_cvt_pk_bf16_f32 v232, v224, v225
    v_accvgpr_write_b32 a124, v232
    v_mfma_f32_32x32x16_bf16 v[152:167], a[156:159], a[104:107], v[152:167]
    ds_read_b64_tr_b16 a[152:153], v10 offset:6400
    ds_read_b64_tr_b16 a[154:155], v10 offset:6656
    s_waitcnt lgkmcnt(10)
    buffer_load_dwordx4 v17, s[28:31], s72 offen offset:3072 lds
    s_add_u32 m0, s84, 55552
    v_cvt_pk_bf16_f32 v226, 0, v226
    v_mfma_f32_32x32x16_bf16 v[104:119], a[160:163], a[108:111], v[104:119]
    ds_read_b64_tr_b16 a[156:157], v6 offset:6400
    ds_read_b64_tr_b16 a[158:159], v6 offset:6656
    v_cvt_pk_bf16_f32 v227, 0, v227
    v_mul_f32 v226, v226, v31
    v_mul_f32 v227, v227, v31
    v_cvt_pk_bf16_f32 v233, v226, v227
    v_mfma_f32_32x32x16_bf16 v[120:135], a[164:167], a[108:111], v[120:135]
    ds_read_b64_tr_b16 a[160:161], v8 offset:7424
    ds_read_b64_tr_b16 a[162:163], v8 offset:7680
    s_waitcnt lgkmcnt(10)
    v_accvgpr_write_b32 a125, v233
    v_cvt_pk_bf16_f32 v228, 0, v228
    v_cvt_pk_bf16_f32 v229, 0, v229
    v_mfma_f32_32x32x16_bf16 v[136:151], a[168:171], a[108:111], v[136:151]
    ds_read_b64_tr_b16 a[164:165], v12 offset:7424
    ds_read_b64_tr_b16 a[166:167], v12 offset:7680
    s_cmp_lg_u32 vcc_lo, 1
    s_cbranch_scc1 L_pfs11_1
    s_mul_i32 s18, s17, 10368
    s_add_u32 s18, s18, 5120
    buffer_load_dword a255, v183, s[36:39], s18 offen
    s_mul_i32 s18, s17, 1296
    s_mov_b64 exec, 0x7ff
    buffer_load_dword a255, v183, s[40:43], s18 offen
    s_mov_b64 exec, -1
L_pfs11_1:
    v_mfma_f32_32x32x16_bf16 v[152:167], a[172:175], a[108:111], v[152:167]
    ds_read_b64_tr_b16 a[168:169], v10 offset:7424
    ds_read_b64_tr_b16 a[170:171], v10 offset:7680
    s_waitcnt lgkmcnt(10)
    v_mul_f32 v228, v228, v31
    v_mul_f32 v229, v229, v31
    v_cvt_pk_bf16_f32 v232, v228, v229
    v_mfma_f32_32x32x16_bf16 v[56:71], a[144:147], a[112:115], v[56:71]
    ds_read_b64_tr_b16 a[172:173], v6 offset:7424
    ds_read_b64_tr_b16 a[174:175], v6 offset:7680
    v_accvgpr_write_b32 a126, v232
    v_cvt_pk_bf16_f32 v230, 0, v230
    v_cvt_pk_bf16_f32 v231, 0, v231
    v_mul_f32 v230, v230, v31
    v_mfma_f32_32x32x16_bf16 v[88:103], a[148:151], a[112:115], v[88:103]
    ds_read_b64_tr_b16 a[144:145], v8 offset:8448
    ds_read_b64_tr_b16 a[146:147], v8 offset:8704
    s_waitcnt lgkmcnt(10)
    v_mul_f32 v231, v231, v31
    v_cvt_pk_bf16_f32 v233, v230, v231
    v_accvgpr_write_b32 a127, v233
    v_mfma_f32_32x32x16_bf16 v[216:231], v[32:35], a[136:139], v[184:199]
    buffer_load_dwordx4 v18, s[32:35], s81 offen lds
    v_mfma_f32_32x32x16_bf16 v[216:231], v[36:39], a[140:143], v[216:231]
    v_cvt_pk_bf16_f32 v200, 0, v200
    v_cvt_pk_bf16_f32 v201, 0, v201
    v_mul_f32 v200, v200, v31
    v_mul_f32 v201, v201, v31
    v_cvt_pk_bf16_f32 v232, v200, v201
    v_accvgpr_write_b32 a128, v232
    v_mfma_f32_32x32x16_bf16 v[72:87], a[152:155], a[112:115], v[72:87]
    ds_read_b64_tr_b16 a[148:149], v12 offset:8448
    ds_read_b64_tr_b16 a[150:151], v12 offset:8704
    buffer_load_dwordx4 v19, s[32:35], s81 offen offset:1024 lds
    v_cvt_pk_bf16_f32 v202, 0, v202
    v_cvt_pk_bf16_f32 v203, 0, v203
    v_mul_f32 v202, v202, v31
    v_mfma_f32_32x32x16_bf16 v[40:55], a[156:159], a[112:115], v[40:55]
    ds_read_b64_tr_b16 a[152:153], v10 offset:8448
    ds_read_b64_tr_b16 a[154:155], v10 offset:8704
    s_waitcnt lgkmcnt(10)
    v_mul_f32 v203, v203, v31
    v_cvt_pk_bf16_f32 v233, v202, v203
    v_accvgpr_write_b32 a129, v233
    v_mfma_f32_32x32x16_bf16 v[56:71], a[160:163], a[116:119], v[56:71]
    ds_read_b64_tr_b16 a[156:157], v6 offset:8448
    ds_read_b64_tr_b16 a[158:159], v6 offset:8704
    buffer_load_dwordx4 v20, s[32:35], s81 offen offset:2048 lds
    v_cvt_pk_bf16_f32 v204, 0, v204
    v_cvt_pk_bf16_f32 v205, 0, v205
    v_mul_f32 v204, v204, v31
    v_mfma_f32_32x32x16_bf16 v[88:103], a[164:167], a[116:119], v[88:103]
    ds_read_b64_tr_b16 a[160:161], v8 offset:9472
    ds_read_b64_tr_b16 a[162:163], v8 offset:9728
    s_waitcnt lgkmcnt(10)
    v_mul_f32 v205, v205, v31
    v_cvt_pk_bf16_f32 v232, v204, v205
    v_accvgpr_write_b32 a130, v232
    v_mfma_f32_32x32x16_bf16 v[72:87], a[168:171], a[116:119], v[72:87]
    ds_read_b64_tr_b16 a[164:165], v12 offset:9472
    ds_read_b64_tr_b16 a[166:167], v12 offset:9728
    buffer_load_dwordx4 v21, s[32:35], s81 offen offset:3072 lds
    v_add_u32 v18, s97, v18
    v_cvt_pk_bf16_f32 v206, 0, v206
    v_cvt_pk_bf16_f32 v207, 0, v207
    v_mfma_f32_32x32x16_bf16 v[40:55], a[172:175], a[116:119], v[40:55]
    ds_read_b64_tr_b16 a[168:169], v10 offset:9472
    ds_read_b64_tr_b16 a[170:171], v10 offset:9728
    s_waitcnt lgkmcnt(10)
    v_add_u32 v19, s97, v19
    s_add_u32 m0, s83, 71936
    v_mul_f32 v206, v206, v31
    v_mfma_f32_32x32x16_bf16 v[56:71], a[144:147], a[120:123], v[56:71]
    ds_read_b64_tr_b16 a[172:173], v6 offset:9472
    ds_read_b64_tr_b16 a[174:175], v6 offset:9728
    buffer_load_dwordx4 v18, s[32:35], s73 offen lds
    v_mul_f32 v207, v207, v31
    v_cvt_pk_bf16_f32 v233, v206, v207
    v_accvgpr_write_b32 a131, v233
    v_mfma_f32_32x32x16_bf16 v[88:103], a[148:151], a[120:123], v[88:103]
    s_waitcnt vmcnt(9)
    s_barrier
    ds_read_b64_tr_b16 a[144:145], v2 offset:22784
    ds_read_b64_tr_b16 a[146:147], v2 offset:23296
    s_waitcnt lgkmcnt(10)
    v_cvt_pk_bf16_f32 v208, 0, v208
    v_mfma_f32_32x32x16_bf16 v[72:87], a[152:155], a[120:123], v[72:87]
    ds_read_b64_tr_b16 a[148:149], v4 offset:22784
    ds_read_b64_tr_b16 a[150:151], v4 offset:23296
    buffer_load_dwordx4 v19, s[32:35], s73 offen offset:1024 lds
    s_add_u32 m0, s83, 80128
    v_cvt_pk_bf16_f32 v209, 0, v209
    v_mul_f32 v208, v208, v31
    v_mfma_f32_32x32x16_bf16 v[40:55], a[156:159], a[120:123], v[40:55]
    ds_read_b64_tr_b16 a[152:153], v2 offset:30976
    ds_read_b64_tr_b16 a[154:155], v2 offset:31488
    s_waitcnt lgkmcnt(10)
    v_mul_f32 v209, v209, v31
    v_cvt_pk_bf16_f32 v232, v208, v209
    v_accvgpr_write_b32 a132, v232
    v_mfma_f32_32x32x16_bf16 v[56:71], a[160:163], a[124:127], v[56:71]
    ds_read_b64_tr_b16 a[156:157], v4 offset:30976
    ds_read_b64_tr_b16 a[158:159], v4 offset:31488
    v_cvt_pk_bf16_f32 v210, 0, v210
    v_cvt_pk_bf16_f32 v211, 0, v211
    v_mul_f32 v210, v210, v31
    v_mul_f32 v211, v211, v31
    v_mfma_f32_32x32x16_bf16 v[88:103], a[164:167], a[124:127], v[88:103]
    ds_read_b64_tr_b16 a[160:161], v2 offset:24832
    ds_read_b64_tr_b16 a[162:163], v2 offset:25344
    s_waitcnt lgkmcnt(10)
    buffer_load_dwordx4 v18, s[32:35], s74 offen lds
    v_cvt_pk_bf16_f32 v233, v210, v211
    v_accvgpr_write_b32 a133, v233
    v_mfma_f32_32x32x16_bf16 v[72:87], a[168:171], a[124:127], v[72:87]
    ds_read_b64_tr_b16 a[164:165], v4 offset:24832
    ds_read_b64_tr_b16 a[166:167], v4 offset:25344
    v_cvt_pk_bf16_f32 v212, 0, v212
    v_cvt_pk_bf16_f32 v213, 0, v213
    v_mul_f32 v212, v212, v31
    v_mul_f32 v213, v213, v31
    v_mfma_f32_32x32x16_bf16 v[40:55], a[172:175], a[124:127], v[40:55]
    ds_read_b64_tr_b16 a[168:169], v2 offset:33024
    ds_read_b64_tr_b16 a[170:171], v2 offset:33536
    s_waitcnt lgkmcnt(10)
    buffer_load_dwordx4 v19, s[32:35], s74 offen offset:1024 lds
    s_add_u32 m0, s83, 88320
    v_cvt_pk_bf16_f32 v232, v212, v213
    v_mfma_f32_32x32x16_bf16 v[104:119], a[144:147], a[112:115], v[104:119]
    ds_read_b64_tr_b16 a[172:173], v4 offset:33024
    ds_read_b64_tr_b16 a[174:175], v4 offset:33536
    v_accvgpr_write_b32 a134, v232
    v_cvt_pk_bf16_f32 v214, 0, v214
    v_cvt_pk_bf16_f32 v215, 0, v215
    v_mul_f32 v214, v214, v31
    v_mfma_f32_32x32x16_bf16 v[120:135], a[148:151], a[112:115], v[120:135]
    ds_read_b64_tr_b16 a[144:145], v2 offset:26880
    ds_read_b64_tr_b16 a[146:147], v2 offset:27392
    s_waitcnt lgkmcnt(10)
    buffer_load_dwordx4 v18, s[32:35], s75 offen lds
    v_mul_f32 v215, v215, v31
    v_cvt_pk_bf16_f32 v233, v214, v215
    v_mfma_f32_32x32x16_bf16 v[136:151], a[152:155], a[112:115], v[136:151]
    ds_read_b64_tr_b16 a[148:149], v4 offset:26880
    ds_read_b64_tr_b16 a[150:151], v4 offset:27392
    v_accvgpr_write_b32 a135, v233
    v_cvt_pk_bf16_f32 v216, 0, v216
    v_cvt_pk_bf16_f32 v217, 0, v217
    v_mul_f32 v216, v216, v31
    v_mfma_f32_32x32x16_bf16 v[152:167], a[156:159], a[112:115], v[152:167]
    ds_read_b64_tr_b16 a[152:153], v2 offset:35072
    ds_read_b64_tr_b16 a[154:155], v2 offset:35584
    s_waitcnt lgkmcnt(10)
    buffer_load_dwordx4 v19, s[32:35], s75 offen offset:1024 lds
    s_add_u32 m0, s83, 96512
    v_mul_f32 v217, v217, v31
    v_mfma_f32_32x32x16_bf16 v[104:119], a[160:163], a[116:119], v[104:119]
    ds_read_b64_tr_b16 a[156:157], v4 offset:35072
    ds_read_b64_tr_b16 a[158:159], v4 offset:35584
    v_cvt_pk_bf16_f32 v232, v216, v217
    v_accvgpr_write_b32 a136, v232
    v_cvt_pk_bf16_f32 v218, 0, v218
    v_mfma_f32_32x32x16_bf16 v[120:135], a[164:167], a[116:119], v[120:135]
    ds_read_b64_tr_b16 a[160:161], v2 offset:28928
    ds_read_b64_tr_b16 a[162:163], v2 offset:29440
    s_waitcnt lgkmcnt(10)
    buffer_load_dwordx4 v18, s[32:35], s76 offen lds
    v_cvt_pk_bf16_f32 v219, 0, v219
    v_mul_f32 v218, v218, v31
    v_mfma_f32_32x32x16_bf16 v[136:151], a[168:171], a[116:119], v[136:151]
    ds_read_b64_tr_b16 a[164:165], v4 offset:28928
    ds_read_b64_tr_b16 a[166:167], v4 offset:29440
    v_mul_f32 v219, v219, v31
    v_cvt_pk_bf16_f32 v233, v218, v219
    v_accvgpr_write_b32 a137, v233
    v_cvt_pk_bf16_f32 v220, 0, v220
    v_mfma_f32_32x32x16_bf16 v[152:167], a[172:175], a[116:119], v[152:167]
    ds_read_b64_tr_b16 a[168:169], v2 offset:37120
    ds_read_b64_tr_b16 a[170:171], v2 offset:37632
    s_waitcnt lgkmcnt(10)
    buffer_load_dwordx4 v19, s[32:35], s76 offen offset:1024 lds
    s_add_u32 m0, s83, 104704
    v_cvt_pk_bf16_f32 v221, 0, v221
    v_mfma_f32_32x32x16_bf16 v[104:119], a[144:147], a[120:123], v[104:119]
    ds_read_b64_tr_b16 a[172:173], v4 offset:37120
    ds_read_b64_tr_b16 a[174:175], v4 offset:37632
    v_mul_f32 v220, v220, v31
    v_mul_f32 v221, v221, v31
    v_cvt_pk_bf16_f32 v232, v220, v221
    v_accvgpr_write_b32 a138, v232
    v_mfma_f32_32x32x16_bf16 v[120:135], a[148:151], a[120:123], v[120:135]
    s_waitcnt vmcnt(12)
    s_barrier
    ds_read_b64_tr_b16 a[144:145], v8 offset:39168
    ds_read_b64_tr_b16 a[146:147], v8 offset:39424
    s_waitcnt lgkmcnt(10)
    buffer_load_dwordx4 v18, s[32:35], s77 offen lds
    v_mfma_f32_32x32x16_bf16 v[136:151], a[152:155], a[120:123], v[136:151]
    ds_read_b64_tr_b16 a[148:149], v12 offset:39168
    ds_read_b64_tr_b16 a[150:151], v12 offset:39424
    v_cvt_pk_bf16_f32 v222, 0, v222
    v_cvt_pk_bf16_f32 v223, 0, v223
    v_mul_f32 v222, v222, v31
    v_mul_f32 v223, v223, v31
    v_mfma_f32_32x32x16_bf16 v[152:167], a[156:159], a[120:123], v[152:167]
    ds_read_b64_tr_b16 a[152:153], v10 offset:39168
    ds_read_b64_tr_b16 a[154:155], v10 offset:39424
    s_waitcnt lgkmcnt(10)
    buffer_load_dwordx4 v19, s[32:35], s77 offen offset:1024 lds
    s_add_u32 m0, s83, 112896
    v_cvt_pk_bf16_f32 v233, v222, v223
    v_mfma_f32_32x32x16_bf16 v[104:119], a[160:163], a[124:127], v[104:119]
    ds_read_b64_tr_b16 a[156:157], v6 offset:39168
    ds_read_b64_tr_b16 a[158:159], v6 offset:39424
    v_accvgpr_write_b32 a139, v233
    v_cvt_pk_bf16_f32 v224, 0, v224
    v_cvt_pk_bf16_f32 v225, 0, v225
    v_mul_f32 v224, v224, v31
    v_mfma_f32_32x32x16_bf16 v[120:135], a[164:167], a[124:127], v[120:135]
    ds_read_b64_tr_b16 a[160:161], v8 offset:40192
    ds_read_b64_tr_b16 a[162:163], v8 offset:40448
    s_waitcnt lgkmcnt(10)
    buffer_load_dwordx4 v18, s[32:35], s78 offen lds
    v_mul_f32 v225, v225, v31
    v_cvt_pk_bf16_f32 v232, v224, v225
    v_mfma_f32_32x32x16_bf16 v[136:151], a[168:171], a[124:127], v[136:151]
    ds_read_b64_tr_b16 a[164:165], v12 offset:40192
    ds_read_b64_tr_b16 a[166:167], v12 offset:40448
    v_accvgpr_write_b32 a140, v232
    v_cvt_pk_bf16_f32 v226, 0, v226
    v_cvt_pk_bf16_f32 v227, 0, v227
    v_mul_f32 v226, v226, v31
    v_mfma_f32_32x32x16_bf16 v[152:167], a[172:175], a[124:127], v[152:167]
    ds_read_b64_tr_b16 a[168:169], v10 offset:40192
    ds_read_b64_tr_b16 a[170:171], v10 offset:40448
    s_waitcnt lgkmcnt(10)
    v_mul_f32 v227, v227, v31
    v_cvt_pk_bf16_f32 v233, v226, v227
    v_accvgpr_write_b32 a141, v233
    v_mfma_f32_32x32x16_bf16 v[56:71], a[144:147], a[128:131], v[56:71]
    ds_read_b64_tr_b16 a[172:173], v6 offset:40192
    ds_read_b64_tr_b16 a[174:175], v6 offset:40448
    buffer_load_dwordx4 v19, s[32:35], s78 offen offset:1024 lds
    s_add_u32 m0, s83, 121088
    v_cvt_pk_bf16_f32 v228, 0, v228
    v_mfma_f32_32x32x16_bf16 v[88:103], a[148:151], a[128:131], v[88:103]
    ds_read_b64_tr_b16 a[144:145], v8 offset:41216
    ds_read_b64_tr_b16 a[146:147], v8 offset:41472
    s_waitcnt lgkmcnt(10)
    v_cvt_pk_bf16_f32 v229, 0, v229
    v_mul_f32 v228, v228, v31
    v_mul_f32 v229, v229, v31
    v_mfma_f32_32x32x16_bf16 v[72:87], a[152:155], a[128:131], v[72:87]
    ds_read_b64_tr_b16 a[148:149], v12 offset:41216
    ds_read_b64_tr_b16 a[150:151], v12 offset:41472
    buffer_load_dwordx4 v18, s[32:35], s79 offen lds
    v_cvt_pk_bf16_f32 v232, v228, v229
    v_accvgpr_write_b32 a142, v232
    v_mfma_f32_32x32x16_bf16 v[40:55], a[156:159], a[128:131], v[40:55]
    ds_read_b64_tr_b16 a[152:153], v10 offset:41216
    ds_read_b64_tr_b16 a[154:155], v10 offset:41472
    s_waitcnt lgkmcnt(10)
    v_cvt_pk_bf16_f32 v230, 0, v230
    v_cvt_pk_bf16_f32 v231, 0, v231
    v_mul_f32 v230, v230, v31
    v_mfma_f32_32x32x16_bf16 v[56:71], a[160:163], a[132:135], v[56:71]
    ds_read_b64_tr_b16 a[156:157], v6 offset:41216
    ds_read_b64_tr_b16 a[158:159], v6 offset:41472
    buffer_load_dwordx4 v19, s[32:35], s79 offen offset:1024 lds
    s_add_u32 m0, s83, 6400
    v_mul_f32 v231, v231, v31
    v_cvt_pk_bf16_f32 v233, v230, v231
    v_mfma_f32_32x32x16_bf16 v[88:103], a[164:167], a[132:135], v[88:103]
    ds_read_b64_tr_b16 a[160:161], v8 offset:42240
    ds_read_b64_tr_b16 a[162:163], v8 offset:42496
    s_waitcnt lgkmcnt(10)
    v_accvgpr_write_b32 a143, v233
    v_mfma_f32_32x32x16_bf16 v[72:87], a[168:171], a[132:135], v[72:87]
    ds_read_b64_tr_b16 a[164:165], v12 offset:42240
    ds_read_b64_tr_b16 a[166:167], v12 offset:42496
    buffer_load_dwordx4 v18, s[32:35], s80 offen lds
    v_mfma_f32_32x32x16_bf16 v[40:55], a[172:175], a[132:135], v[40:55]
    ds_read_b64_tr_b16 a[168:169], v10 offset:42240
    ds_read_b64_tr_b16 a[170:171], v10 offset:42496
    s_waitcnt lgkmcnt(10)
    v_mfma_f32_32x32x16_bf16 v[56:71], a[144:147], a[136:139], v[56:71]
    ds_read_b64_tr_b16 a[172:173], v6 offset:42240
    ds_read_b64_tr_b16 a[174:175], v6 offset:42496
    buffer_load_dwordx4 v19, s[32:35], s80 offen offset:1024 lds
    s_add_u32 m0, s83, 14592
    v_mfma_f32_32x32x16_bf16 v[88:103], a[148:151], a[136:139], v[88:103]
    s_waitcnt vmcnt(16)
    s_barrier
    ds_read_b64_tr_b16 a[144:145], v2 offset:55552
    ds_read_b64_tr_b16 a[146:147], v2 offset:56064
    s_waitcnt lgkmcnt(10)
    v_mfma_f32_32x32x16_bf16 v[72:87], a[152:155], a[136:139], v[72:87]
    ds_read_b64_tr_b16 a[148:149], v4 offset:55552
    ds_read_b64_tr_b16 a[150:151], v4 offset:56064
    buffer_load_dwordx4 v18, s[32:35], s81 offen lds
    v_mfma_f32_32x32x16_bf16 v[40:55], a[156:159], a[136:139], v[40:55]
    ds_read_b64_tr_b16 a[152:153], v2 offset:63744
    ds_read_b64_tr_b16 a[154:155], v2 offset:64256
    s_waitcnt lgkmcnt(10)
    v_mfma_f32_32x32x16_bf16 v[56:71], a[160:163], a[140:143], v[56:71]
    ds_read_b64_tr_b16 a[156:157], v4 offset:63744
    ds_read_b64_tr_b16 a[158:159], v4 offset:64256
    buffer_load_dwordx4 v19, s[32:35], s81 offen offset:1024 lds
    s_add_u32 s97, s97, s98
    v_mfma_f32_32x32x16_bf16 v[88:103], a[164:167], a[140:143], v[88:103]
    ds_read_b64_tr_b16 a[160:161], v2 offset:57600
    ds_read_b64_tr_b16 a[162:163], v2 offset:58112
    s_waitcnt lgkmcnt(10)
    v_add_u32 v18, s98, v18
    v_add_u32 v19, s98, v19
    v_mfma_f32_32x32x16_bf16 v[72:87], a[168:171], a[140:143], v[72:87]
    ds_read_b64_tr_b16 a[164:165], v4 offset:57600
    ds_read_b64_tr_b16 a[166:167], v4 offset:58112
    v_add_u32 v20, s97, v20
    v_add_u32 v21, s97, v21
    v_mfma_f32_32x32x16_bf16 v[40:55], a[172:175], a[140:143], v[40:55]
    ds_read_b64_tr_b16 a[168:169], v3 offset:1280
    ds_read_b64_tr_b16 a[170:171], v3 offset:1792
    s_waitcnt lgkmcnt(10)
    s_add_u32 m0, s84, 22784
    v_mov_b32 v6, v236
    v_mov_b32 v7, v237
    v_mfma_f32_32x32x16_bf16 v[104:119], a[144:147], a[128:131], v[104:119]
    ds_read_b64_tr_b16 a[172:173], v5 offset:1280
    ds_read_b64_tr_b16 a[174:175], v5 offset:1792
    buffer_load_dwordx4 v18, s[32:35], s73 offen lds
    v_mov_b32 v8, v238
    v_mov_b32 v9, v239
    v_mov_b32 v10, v240
    v_mfma_f32_32x32x16_bf16 v[120:135], a[148:151], a[128:131], v[120:135]
    ds_read_b64_tr_b16 a[144:145], v2 offset:59648
    ds_read_b64_tr_b16 a[146:147], v2 offset:60160
    s_waitcnt lgkmcnt(10)
    v_mov_b32 v11, v241
    v_mov_b32 v12, v242
    v_mov_b32 v13, v243
    v_mfma_f32_32x32x16_bf16 v[136:151], a[152:155], a[128:131], v[136:151]
    ds_read_b64_tr_b16 a[148:149], v4 offset:59648
    ds_read_b64_tr_b16 a[150:151], v4 offset:60160
    buffer_load_dwordx4 v19, s[32:35], s73 offen offset:1024 lds
    v_mov_b32 v14, v244
    v_mov_b32 v15, v245
    v_mov_b32 v16, v246
    v_mfma_f32_32x32x16_bf16 v[152:167], a[156:159], a[128:131], v[152:167]
    ds_read_b64_tr_b16 a[152:153], v3 offset:3328
    ds_read_b64_tr_b16 a[154:155], v3 offset:3840
    s_waitcnt lgkmcnt(10)
    v_mov_b32 v17, v247
    v_mov_b32 v23, v248
    v_mov_b32 v22, v249
    v_mfma_f32_32x32x16_bf16 v[104:119], a[160:163], a[132:135], v[104:119]
    ds_read_b64_tr_b16 a[156:157], v5 offset:3328
    ds_read_b64_tr_b16 a[158:159], v5 offset:3840
    buffer_load_dwordx4 v20, s[32:35], s73 offen offset:2048 lds
    s_mov_b32 s69, s0
    s_mov_b32 s64, s19
    v_cvt_pk_bf16_f32 v232, v56, v57
    v_mfma_f32_32x32x16_bf16 v[120:135], a[164:167], a[132:135], v[120:135]
    ds_read_b64_tr_b16 a[160:161], v2 offset:61696
    ds_read_b64_tr_b16 a[162:163], v2 offset:62208
    s_waitcnt lgkmcnt(10)
    s_mov_b32 s70, s1
    s_mov_b32 s65, s10
    v_cvt_pk_bf16_f32 v233, v58, v59
    v_mfma_f32_32x32x16_bf16 v[136:151], a[168:171], a[132:135], v[136:151]
    ds_read_b64_tr_b16 a[164:165], v4 offset:61696
    ds_read_b64_tr_b16 a[166:167], v4 offset:62208
    buffer_load_dwordx4 v21, s[32:35], s73 offen offset:3072 lds
    s_mov_b32 s71, s3
    s_mov_b32 s66, s11
    v_cvt_pk_bf16_f32 v234, v60, v61
    v_mfma_f32_32x32x16_bf16 v[152:167], a[172:175], a[132:135], v[152:167]
    ds_read_b64_tr_b16 a[168:169], v3 offset:5376
    ds_read_b64_tr_b16 a[170:171], v3 offset:5888
    s_waitcnt lgkmcnt(10)
    s_mov_b32 s72, s9
    s_mov_b32 s67, s16
    v_cvt_pk_bf16_f32 v235, v62, v63
    v_mfma_f32_32x32x16_bf16 v[104:119], a[144:147], a[136:139], v[104:119]
    ds_read_b64_tr_b16 a[172:173], v5 offset:5376
    ds_read_b64_tr_b16 a[174:175], v5 offset:5888
    s_mov_b32 s68, 512
    v_cvt_pk_bf16_f32 v236, v64, v65
    v_cvt_pk_bf16_f32 v237, v66, v67
    v_mfma_f32_32x32x16_bf16 v[120:135], a[148:151], a[136:139], v[120:135]
    s_waitcnt vmcnt(18)
    s_barrier
    ds_read_b64_tr_b16 a[144:145], v3 offset:7424
    ds_read_b64_tr_b16 a[146:147], v3 offset:7936
    s_waitcnt lgkmcnt(10)
    s_add_u32 m0, s84, 39168
    v_mfma_f32_32x32x16_bf16 v[136:151], a[152:155], a[136:139], v[136:151]
    ds_read_b64_tr_b16 a[148:149], v5 offset:7424
    ds_read_b64_tr_b16 a[150:151], v5 offset:7936
    buffer_load_dwordx4 v18, s[32:35], s74 offen lds
    v_cvt_pk_bf16_f32 v238, v68, v69
    v_cvt_pk_bf16_f32 v239, v70, v71
    v_mfma_f32_32x32x16_bf16 v[152:167], a[156:159], a[136:139], v[152:167]
    ds_read_b64_tr_b16 a[152:153], v3 offset:9472
    ds_read_b64_tr_b16 a[154:155], v3 offset:9984
    s_waitcnt lgkmcnt(10)
    v_cvt_pk_bf16_f32 v240, v88, v89
    v_cvt_pk_bf16_f32 v241, v90, v91
    v_cvt_pk_bf16_f32 v242, v92, v93
    v_mfma_f32_32x32x16_bf16 v[104:119], a[160:163], a[140:143], v[104:119]
    ds_read_b64_tr_b16 a[156:157], v5 offset:9472
    ds_read_b64_tr_b16 a[158:159], v5 offset:9984
    buffer_load_dwordx4 v19, s[32:35], s74 offen offset:1024 lds
    v_cvt_pk_bf16_f32 v243, v94, v95
    v_cvt_pk_bf16_f32 v252, v96, v97
    v_mfma_f32_32x32x16_bf16 v[120:135], a[164:167], a[140:143], v[120:135]
    ds_read_b64_tr_b16 a[160:161], v3 offset:11520
    ds_read_b64_tr_b16 a[162:163], v3 offset:12032
    s_waitcnt lgkmcnt(10)
    v_cvt_pk_bf16_f32 v253, v98, v99
    v_mfma_f32_32x32x16_bf16 v[184:199], a[176:179], v[232:235], 0
    buffer_load_dwordx4 v20, s[32:35], s74 offen offset:2048 lds
    v_mfma_f32_32x32x16_bf16 v[200:215], a[192:195], v[232:235], 0
    v_mfma_f32_32x32x16_bf16 v[184:199], a[180:183], v[236:239], v[184:199]
    buffer_load_dwordx4 v21, s[32:35], s74 offen offset:3072 lds
    v_mfma_f32_32x32x16_bf16 v[200:215], a[196:199], v[236:239], v[200:215]
    v_mfma_f32_32x32x16_bf16 v[184:199], a[184:187], v[240:243], v[184:199]
    v_mfma_f32_32x32x16_bf16 v[200:215], a[200:203], v[240:243], v[200:215]
    v_cvt_pk_bf16_f32 v244, v72, v73
    v_cvt_pk_bf16_f32 v245, v74, v75
    v_cvt_pk_bf16_f32 v246, v76, v77
    v_cvt_pk_bf16_f32 v247, v78, v79
    v_cvt_pk_bf16_f32 v248, v80, v81
    v_mfma_f32_32x32x16_bf16 v[136:151], a[168:171], a[140:143], v[136:151]
    ds_read_b64_tr_b16 a[164:165], v5 offset:11520
    ds_read_b64_tr_b16 a[166:167], v5 offset:12032
    v_cvt_pk_bf16_f32 v249, v82, v83
    v_cvt_pk_bf16_f32 v250, v84, v85
    v_cvt_pk_bf16_f32 v251, v86, v87
    v_mfma_f32_32x32x16_bf16 v[152:167], a[172:175], a[140:143], v[152:167]
    ds_read_b64_tr_b16 a[168:169], v3 offset:13568
    ds_read_b64_tr_b16 a[170:171], v3 offset:14080
    s_waitcnt lgkmcnt(10)
    v_cvt_pk_bf16_f32 v104, v104, v105
    v_cvt_pk_bf16_f32 v105, v106, v107
    v_pk_max_i16 v104, v104, 0
    v_mfma_f32_32x32x16_bf16 v[56:71], a[144:147], a[0:3], 0
    ds_read_b64_tr_b16 a[172:173], v5 offset:13568
    ds_read_b64_tr_b16 a[174:175], v5 offset:14080
    v_pk_max_i16 v105, v105, 0
    v_cvt_pk_bf16_f32 v106, v108, v109
    v_cvt_pk_bf16_f32 v107, v110, v111
    v_pk_max_i16 v106, v106, 0
    v_mfma_f32_32x32x16_bf16 v[168:183], a[148:151], a[0:3], 0
    ds_read_b64_tr_b16 a[144:145], v3 offset:15616
    ds_read_b64_tr_b16 a[146:147], v3 offset:16128
    s_waitcnt lgkmcnt(10)
    v_pk_max_i16 v107, v107, 0
    v_cvt_pk_bf16_f32 v108, v112, v113
    v_cvt_pk_bf16_f32 v109, v114, v115
    v_pk_max_i16 v108, v108, 0
    v_mfma_f32_32x32x16_bf16 v[56:71], a[152:155], a[4:7], v[56:71]
    ds_read_b64_tr_b16 a[148:149], v5 offset:15616
    ds_read_b64_tr_b16 a[150:151], v5 offset:16128
    v_pk_max_i16 v109, v109, 0
    v_cvt_pk_bf16_f32 v110, v116, v117
    v_cvt_pk_bf16_f32 v111, v118, v119
    v_pk_max_i16 v110, v110, 0
    v_mfma_f32_32x32x16_bf16 v[168:183], a[156:159], a[4:7], v[168:183]
    ds_read_b64_tr_b16 a[152:153], v3 offset:17664
    ds_read_b64_tr_b16 a[154:155], v3 offset:18176
    s_waitcnt lgkmcnt(10)
    v_pk_max_i16 v111, v111, 0
    v_cvt_pk_bf16_f32 v112, v120, v121
    s_add_u32 s8, s93, 0
    v_cvt_pk_bf16_f32 v113, v122, v123
    v_mfma_f32_32x32x16_bf16 v[56:71], a[160:163], a[8:11], v[56:71]
    ds_read_b64_tr_b16 a[156:157], v5 offset:17664
    ds_read_b64_tr_b16 a[158:159], v5 offset:18176
    buffer_store_dwordx4 v[104:107], v30, s[48:51], s8 offen sc1
    v_pk_max_i16 v112, v112, 0
    v_pk_max_i16 v113, v113, 0
    v_cvt_pk_bf16_f32 v114, v124, v125
    v_mfma_f32_32x32x16_bf16 v[168:183], a[164:167], a[8:11], v[168:183]
    ds_read_b64_tr_b16 a[160:161], v3 offset:19712
    ds_read_b64_tr_b16 a[162:163], v3 offset:20224
    s_waitcnt lgkmcnt(10)
    v_cvt_pk_bf16_f32 v115, v126, v127
    v_pk_max_i16 v114, v114, 0
    v_pk_max_i16 v115, v115, 0
    v_cvt_pk_bf16_f32 v116, v128, v129
    v_mfma_f32_32x32x16_bf16 v[56:71], a[168:171], a[12:15], v[56:71]
    ds_read_b64_tr_b16 a[164:165], v5 offset:19712
    ds_read_b64_tr_b16 a[166:167], v5 offset:20224
    v_cvt_pk_bf16_f32 v117, v130, v131
    v_pk_max_i16 v116, v116, 0
    v_pk_max_i16 v117, v117, 0
    v_cvt_pk_bf16_f32 v118, v132, v133
    v_mfma_f32_32x32x16_bf16 v[168:183], a[172:175], a[12:15], v[168:183]
    ds_read_b64_tr_b16 a[168:169], v3 offset:21760
    ds_read_b64_tr_b16 a[170:171], v3 offset:22272
    s_waitcnt lgkmcnt(10)
    v_cvt_pk_bf16_f32 v119, v134, v135
    v_pk_max_i16 v118, v118, 0
    v_pk_max_i16 v119, v119, 0
    v_cvt_pk_bf16_f32 v136, v136, v137
    v_mfma_f32_32x32x16_bf16 v[56:71], a[144:147], a[16:19], v[56:71]
    ds_read_b64_tr_b16 a[172:173], v5 offset:21760
    ds_read_b64_tr_b16 a[174:175], v5 offset:22272
    v_cmp_gt_u32_e64 s[6:7], 32, v1
    s_nop 1
    v_cndmask_b32_e64 v252, v253, v252, s[6:7]
    v_mov_b32 v253, 0x3f80
    v_cvt_pk_bf16_f32 v137, v138, v139
    v_mfma_f32_32x32x16_bf16 v[168:183], a[148:151], a[16:19], v[168:183]
    s_waitcnt vmcnt(19)
    s_barrier
    ds_read_b64_tr_b16 a[144:145], v3 offset:23808
    ds_read_b64_tr_b16 a[146:147], v3 offset:24320
    s_waitcnt lgkmcnt(10)
    s_add_u32 m0, s84, 55552
    v_pk_max_i16 v136, v136, 0
    v_mfma_f32_32x32x16_bf16 v[56:71], a[152:155], a[20:23], v[56:71]
    ds_read_b64_tr_b16 a[148:149], v5 offset:23808
    ds_read_b64_tr_b16 a[150:151], v5 offset:24320
    buffer_load_dwordx4 v18, s[32:35], s75 offen lds
    ds_write_b64 v26, v[244:245] offset:80
    ds_write_b64 v26, v[246:247] offset:88
    v_pk_max_i16 v137, v137, 0
    v_mfma_f32_32x32x16_bf16 v[168:183], a[156:159], a[20:23], v[168:183]
    ds_read_b64_tr_b16 a[152:153], v3 offset:25856
    ds_read_b64_tr_b16 a[154:155], v3 offset:26368
    s_waitcnt lgkmcnt(12)
    ds_write_b64 v26, v[248:249] offset:96
    ds_write_b64 v26, v[250:251] offset:104
    v_cvt_pk_bf16_f32 v138, v140, v141
    v_cvt_pk_bf16_f32 v139, v142, v143
    v_mfma_f32_32x32x16_bf16 v[56:71], a[160:163], a[24:27], v[56:71]
    ds_read_b64_tr_b16 a[156:157], v5 offset:25856
    ds_read_b64_tr_b16 a[158:159], v5 offset:26368
    buffer_store_dwordx4 v[108:111], v30, s[48:51], s8 offen offset:1024 sc1
    ds_write_b64 v26, v[252:253] offset:112
    s_add_u32 s8, s93, 2048
    v_mov_b32 v232, v200
    v_mov_b32 v233, v201
    v_mfma_f32_32x32x16_bf16 v[168:183], a[164:167], a[24:27], v[168:183]
    ds_read_b64_tr_b16 a[160:161], v3 offset:27904
    ds_read_b64_tr_b16 a[162:163], v3 offset:28416
    s_waitcnt lgkmcnt(15)
    s_waitcnt lgkmcnt(2)
    v_cvt_pk_bf16_f32 v244, v40, v41
    v_cvt_pk_bf16_f32 v245, v42, v43
    v_cvt_pk_bf16_f32 v246, v44, v45
    v_mfma_f32_32x32x16_bf16 v[56:71], a[168:171], a[28:31], v[56:71]
    ds_read_b64_tr_b16 a[164:165], v5 offset:27904
    ds_read_b64_tr_b16 a[166:167], v5 offset:28416
    buffer_load_dwordx4 v19, s[32:35], s75 offen offset:1024 lds
    v_cvt_pk_bf16_f32 v247, v46, v47
    v_cvt_pk_bf16_f32 v248, v48, v49
    v_cvt_pk_bf16_f32 v249, v50, v51
    v_mfma_f32_32x32x16_bf16 v[168:183], a[172:175], a[28:31], v[168:183]
    ds_read_b64_tr_b16 a[168:169], v3 offset:29952
    ds_read_b64_tr_b16 a[170:171], v3 offset:30464
    v_cvt_pk_bf16_f32 v250, v52, v53
    v_cvt_pk_bf16_f32 v251, v54, v55
    v_pk_max_i16 v138, v138, 0
    v_pk_max_i16 v139, v139, 0
    v_mfma_f32_32x32x16_bf16 v[216:231], a[176:179], v[244:247], 0
    buffer_load_dwordx4 v20, s[32:35], s75 offen offset:2048 lds
    v_cvt_pk_bf16_f32 v140, v144, v145
    v_cvt_pk_bf16_f32 v141, v146, v147
    v_pk_max_i16 v140, v140, 0
    v_pk_max_i16 v141, v141, 0
    v_cvt_pk_bf16_f32 v142, v148, v149
    v_mfma_f32_32x32x16_bf16 v[200:215], a[192:195], v[244:247], 0
    v_cvt_pk_bf16_f32 v143, v150, v151
    v_pk_max_i16 v142, v142, 0
    v_pk_max_i16 v143, v143, 0
    v_cvt_pk_bf16_f32 v144, v152, v153
    v_cvt_pk_bf16_f32 v145, v154, v155
    v_pk_max_i16 v144, v144, 0
    v_mfma_f32_32x32x16_bf16 v[216:231], a[180:183], v[248:251], v[216:231]
    buffer_load_dwordx4 v21, s[32:35], s75 offen offset:3072 lds
    v_pk_max_i16 v145, v145, 0
    v_cvt_pk_bf16_f32 v146, v156, v157
    v_cvt_pk_bf16_f32 v147, v158, v159
    v_pk_max_i16 v146, v146, 0
    v_pk_max_i16 v147, v147, 0
    v_mfma_f32_32x32x16_bf16 v[200:215], a[196:199], v[248:251], v[200:215]
    v_cvt_pk_bf16_f32 v148, v160, v161
    v_cvt_pk_bf16_f32 v149, v162, v163
    v_pk_max_i16 v148, v148, 0
    v_pk_max_i16 v149, v149, 0
    v_cvt_pk_bf16_f32 v150, v164, v165
    v_cvt_pk_bf16_f32 v151, v166, v167
    v_mfma_f32_32x32x16_bf16 v[216:231], a[186:189], v[240:243], v[216:231]
    buffer_store_dwordx4 v[112:115], v30, s[48:51], s8 offen sc1
    v_pk_max_i16 v150, v150, 0
    v_pk_max_i16 v151, v151, 0
    v_mfma_f32_32x32x16_bf16 v[200:215], a[202:205], v[240:243], v[200:215]
    v_cvt_pk_bf16_f32 v184, 0, v184
    v_cvt_pk_bf16_f32 v185, 0, v185
    v_cvt_pk_bf16_f32 v186, 0, v186
    v_cvt_pk_bf16_f32 v187, 0, v187
    v_cvt_pk_bf16_f32 v188, 0, v188
    v_cvt_pk_bf16_f32 v189, 0, v189
    v_mfma_f32_32x32x16_bf16 v[56:71], a[144:147], a[32:35], v[56:71]
    ds_read_b64_tr_b16 a[172:173], v5 offset:29952
    ds_read_b64_tr_b16 a[174:175], v5 offset:30464
    v_cvt_pk_bf16_f32 v190, 0, v190
    v_cvt_pk_bf16_f32 v191, 0, v191
    v_cvt_pk_bf16_f32 v192, 0, v192
    v_cvt_pk_bf16_f32 v193, 0, v193
    v_mfma_f32_32x32x16_bf16 v[168:183], a[148:151], a[32:35], v[168:183]
    ds_read_b64_tr_b16 a[144:145], v3 offset:32000
    ds_read_b64_tr_b16 a[146:147], v3 offset:32512
    v_cvt_pk_bf16_f32 v194, 0, v194
    v_cvt_pk_bf16_f32 v195, 0, v195
    v_cvt_pk_bf16_f32 v196, 0, v196
    v_cvt_pk_bf16_f32 v197, 0, v197
    v_mfma_f32_32x32x16_bf16 v[56:71], a[152:155], a[36:39], v[56:71]
    ds_read_b64_tr_b16 a[148:149], v5 offset:32000
    ds_read_b64_tr_b16 a[150:151], v5 offset:32512
    v_cvt_pk_bf16_f32 v198, 0, v198
    v_cvt_pk_bf16_f32 v199, 0, v199
    v_cvt_pk_bf16_f32 v232, 0, v232
    v_cvt_pk_bf16_f32 v233, 0, v233
    v_max_f32 v244, v184, v185
    v_mfma_f32_32x32x16_bf16 v[168:183], a[156:159], a[36:39], v[168:183]
    ds_read_b64_tr_b16 a[152:153], v3 offset:34048
    ds_read_b64_tr_b16 a[154:155], v3 offset:34560
    s_waitcnt lgkmcnt(10)
    v_min_f32 v245, v184, v185
    v_max3_f32 v244, v244, v186, v187
    v_min3_f32 v245, v245, v186, v187
    v_max3_f32 v244, v244, v188, v189
    v_mfma_f32_32x32x16_bf16 v[56:71], a[160:163], a[40:43], v[56:71]
    ds_read_b64_tr_b16 a[156:157], v5 offset:34048
    ds_read_b64_tr_b16 a[158:159], v5 offset:34560
    v_min3_f32 v245, v245, v188, v189
    v_max3_f32 v244, v244, v190, v191
    v_min3_f32 v245, v245, v190, v191
    v_max3_f32 v244, v244, v192, v193
    v_mfma_f32_32x32x16_bf16 v[168:183], a[164:167], a[40:43], v[168:183]
    ds_read_b64_tr_b16 a[160:161], v3 offset:36096
    ds_read_b64_tr_b16 a[162:163], v3 offset:36608
    s_waitcnt lgkmcnt(10)
    v_min3_f32 v245, v245, v192, v193
    v_max3_f32 v244, v244, v194, v195
    v_min3_f32 v245, v245, v194, v195
    v_max3_f32 v244, v244, v196, v197
    v_mfma_f32_32x32x16_bf16 v[56:71], a[168:171], a[44:47], v[56:71]
    ds_read_b64_tr_b16 a[164:165], v5 offset:36096
    ds_read_b64_tr_b16 a[166:167], v5 offset:36608
    buffer_store_dwordx4 v[116:119], v30, s[48:51], s8 offen offset:1024 sc1
    s_add_u32 s8, s93, 4096
    v_mov_b32 v234, v200
    v_mov_b32 v235, v201
    v_min3_f32 v245, v245, v196, v197
    v_mfma_f32_32x32x16_bf16 v[168:183], a[172:175], a[44:47], v[168:183]
    ds_read_b64_tr_b16 a[168:169], v3 offset:38144
    ds_read_b64_tr_b16 a[170:171], v3 offset:38656
    s_waitcnt lgkmcnt(10)
    v_max3_f32 v244, v244, v198, v199
    v_min3_f32 v245, v245, v198, v199
    v_max3_f32 v244, v244, v232, v233
    v_min3_f32 v245, v245, v232, v233
    v_mfma_f32_32x32x16_bf16 v[56:71], a[144:147], a[48:51], v[56:71]
    ds_read_b64_tr_b16 a[172:173], v5 offset:38144
    ds_read_b64_tr_b16 a[174:175], v5 offset:38656
    v_mul_f32 v244, s86, v244
    v_mul_f32 v245, s86, v245
    v_fma_f32 v200, -v184, s86, v245
    v_fma_f32 v184, v184, s86, -v244
    v_fma_f32 v201, -v185, s86, v245
    v_mfma_f32_32x32x16_bf16 v[168:183], a[148:151], a[48:51], v[168:183]
    s_waitcnt vmcnt(22)
    s_barrier
    ds_read_b64_tr_b16 a[144:145], v3 offset:40192
    ds_read_b64_tr_b16 a[146:147], v3 offset:40704
    s_waitcnt lgkmcnt(10)
    s_add_u32 m0, s84, 71936
    v_fma_f32 v185, v185, s86, -v244
    v_mfma_f32_32x32x16_bf16 v[56:71], a[152:155], a[52:55], v[56:71]
    ds_read_b64_tr_b16 a[148:149], v5 offset:40192
    ds_read_b64_tr_b16 a[150:151], v5 offset:40704
    buffer_load_dwordx4 v18, s[32:35], s76 offen lds
    v_fma_f32 v202, -v186, s86, v245
    v_fma_f32 v186, v186, s86, -v244
    v_fma_f32 v203, -v187, s86, v245
    v_mfma_f32_32x32x16_bf16 v[168:183], a[156:159], a[52:55], v[168:183]
    ds_read_b64_tr_b16 a[152:153], v3 offset:42240
    ds_read_b64_tr_b16 a[154:155], v3 offset:42752
    s_waitcnt lgkmcnt(10)
    v_fma_f32 v187, v187, s86, -v244
    v_fma_f32 v204, -v188, s86, v245
    v_fma_f32 v188, v188, s86, -v244
    v_fma_f32 v205, -v189, s86, v245
    v_mfma_f32_32x32x16_bf16 v[56:71], a[160:163], a[56:59], v[56:71]
    ds_read_b64_tr_b16 a[156:157], v5 offset:42240
    ds_read_b64_tr_b16 a[158:159], v5 offset:42752
    buffer_load_dwordx4 v19, s[32:35], s76 offen offset:1024 lds
    v_fma_f32 v189, v189, s86, -v244
    v_fma_f32 v206, -v190, s86, v245
    v_fma_f32 v190, v190, s86, -v244
    v_mfma_f32_32x32x16_bf16 v[168:183], a[164:167], a[56:59], v[168:183]
    ds_read_b64_tr_b16 a[160:161], v3 offset:44288
    ds_read_b64_tr_b16 a[162:163], v3 offset:44800
    s_waitcnt lgkmcnt(10)
    v_fma_f32 v207, -v191, s86, v245
    v_fma_f32 v191, v191, s86, -v244
    v_fma_f32 v208, -v192, s86, v245
    v_fma_f32 v192, v192, s86, -v244
    v_mfma_f32_32x32x16_bf16 v[56:71], a[168:171], a[60:63], v[56:71]
    ds_read_b64_tr_b16 a[164:165], v5 offset:44288
    ds_read_b64_tr_b16 a[166:167], v5 offset:44800
    buffer_store_dwordx4 v[136:139], v30, s[48:51], s8 offen sc1
    v_fma_f32 v209, -v193, s86, v245
    v_fma_f32 v193, v193, s86, -v244
    v_fma_f32 v210, -v194, s86, v245
    v_mfma_f32_32x32x16_bf16 v[168:183], a[172:175], a[60:63], v[168:183]
    ds_read_b64_tr_b16 a[168:169], v3 offset:46336
    ds_read_b64_tr_b16 a[170:171], v3 offset:46848
    s_waitcnt lgkmcnt(10)
    v_fma_f32 v194, v194, s86, -v244
    v_fma_f32 v211, -v195, s86, v245
    v_fma_f32 v195, v195, s86, -v244
    v_fma_f32 v212, -v196, s86, v245
    v_mfma_f32_32x32x16_bf16 v[56:71], a[144:147], a[64:67], v[56:71]
    ds_read_b64_tr_b16 a[172:173], v5 offset:46336
    ds_read_b64_tr_b16 a[174:175], v5 offset:46848
    buffer_load_dwordx4 v20, s[32:35], s76 offen offset:2048 lds
    v_fma_f32 v196, v196, s86, -v244
    v_fma_f32 v213, -v197, s86, v245
    v_fma_f32 v197, v197, s86, -v244
    v_mfma_f32_32x32x16_bf16 v[168:183], a[148:151], a[64:67], v[168:183]
    ds_read_b64_tr_b16 a[144:145], v3 offset:48384
    ds_read_b64_tr_b16 a[146:147], v3 offset:48896
    s_waitcnt lgkmcnt(10)
    v_fma_f32 v214, -v198, s86, v245
    v_fma_f32 v198, v198, s86, -v244
    v_fma_f32 v215, -v199, s86, v245
    v_fma_f32 v199, v199, s86, -v244
    v_mfma_f32_32x32x16_bf16 v[56:71], a[152:155], a[68:71], v[56:71]
    ds_read_b64_tr_b16 a[148:149], v5 offset:48384
    ds_read_b64_tr_b16 a[150:151], v5 offset:48896
    buffer_load_dwordx4 v21, s[32:35], s76 offen offset:3072 lds
    v_fma_f32 v236, -v232, s86, v245
    v_fma_f32 v232, v232, s86, -v244
    v_fma_f32 v237, -v233, s86, v245
    v_mfma_f32_32x32x16_bf16 v[168:183], a[156:159], a[68:71], v[168:183]
    ds_read_b64_tr_b16 a[152:153], v3 offset:50432
    ds_read_b64_tr_b16 a[154:155], v3 offset:50944
    s_waitcnt lgkmcnt(10)
    v_fma_f32 v233, v233, s86, -v244
    v_exp_f32 v200, v200
    v_exp_f32 v184, v184
    v_mfma_f32_32x32x16_bf16 v[56:71], a[160:163], a[72:75], v[56:71]
    ds_read_b64_tr_b16 a[156:157], v5 offset:50432
    ds_read_b64_tr_b16 a[158:159], v5 offset:50944
    v_exp_f32 v201, v201
    v_exp_f32 v185, v185
    v_exp_f32 v202, v202
    v_mfma_f32_32x32x16_bf16 v[168:183], a[164:167], a[72:75], v[168:183]
    ds_read_b64_tr_b16 a[160:161], v3 offset:52480
    ds_read_b64_tr_b16 a[162:163], v3 offset:52992
    s_waitcnt lgkmcnt(10)
    v_exp_f32 v186, v186
    v_exp_f32 v203, v203
    v_mfma_f32_32x32x16_bf16 v[56:71], a[168:171], a[76:79], v[56:71]
    ds_read_b64_tr_b16 a[164:165], v5 offset:52480
    ds_read_b64_tr_b16 a[166:167], v5 offset:52992
    buffer_store_dwordx4 v[140:143], v30, s[48:51], s8 offen offset:1024 sc1
    s_add_u32 s8, s93, 6144
    v_exp_f32 v187, v187
    v_exp_f32 v204, v204
    v_mfma_f32_32x32x16_bf16 v[168:183], a[172:175], a[76:79], v[168:183]
    ds_read_b64_tr_b16 a[168:169], v3 offset:54528
    ds_read_b64_tr_b16 a[170:171], v3 offset:55040
    s_waitcnt lgkmcnt(10)
    v_exp_f32 v188, v188
    v_exp_f32 v205, v205
    v_mfma_f32_32x32x16_bf16 v[56:71], a[144:147], a[80:83], v[56:71]
    ds_read_b64_tr_b16 a[172:173], v5 offset:54528
    ds_read_b64_tr_b16 a[174:175], v5 offset:55040
    v_exp_f32 v189, v189
    v_exp_f32 v206, v206
    v_exp_f32 v190, v190
    v_mfma_f32_32x32x16_bf16 v[168:183], a[148:151], a[80:83], v[168:183]
    s_waitcnt vmcnt(24)
    s_barrier
    ds_read_b64_tr_b16 a[144:145], v3 offset:56576
    ds_read_b64_tr_b16 a[146:147], v3 offset:57088
    s_waitcnt lgkmcnt(10)
    s_add_u32 m0, s84, 88320
    v_exp_f32 v207, v207
    v_mfma_f32_32x32x16_bf16 v[56:71], a[152:155], a[84:87], v[56:71]
    ds_read_b64_tr_b16 a[148:149], v5 offset:56576
    ds_read_b64_tr_b16 a[150:151], v5 offset:57088
    buffer_load_dwordx4 v18, s[32:35], s77 offen lds
    v_exp_f32 v191, v191
    v_exp_f32 v208, v208
    v_mfma_f32_32x32x16_bf16 v[168:183], a[156:159], a[84:87], v[168:183]
    ds_read_b64_tr_b16 a[152:153], v3 offset:58624
    ds_read_b64_tr_b16 a[154:155], v3 offset:59136
    s_waitcnt lgkmcnt(10)
    v_exp_f32 v192, v192
    v_exp_f32 v209, v209
    v_mfma_f32_32x32x16_bf16 v[56:71], a[160:163], a[88:91], v[56:71]
    ds_read_b64_tr_b16 a[156:157], v5 offset:58624
    ds_read_b64_tr_b16 a[158:159], v5 offset:59136
    buffer_load_dwordx4 v19, s[32:35], s77 offen offset:1024 lds
    v_exp_f32 v193, v193
    v_exp_f32 v210, v210
    v_mfma_f32_32x32x16_bf16 v[168:183], a[164:167], a[88:91], v[168:183]
    ds_read_b64_tr_b16 a[160:161], v3 offset:60672
    ds_read_b64_tr_b16 a[162:163], v3 offset:61184
    s_waitcnt lgkmcnt(10)
    v_exp_f32 v194, v194
    v_exp_f32 v211, v211
    v_mfma_f32_32x32x16_bf16 v[56:71], a[168:171], a[92:95], v[56:71]
    ds_read_b64_tr_b16 a[164:165], v5 offset:60672
    ds_read_b64_tr_b16 a[166:167], v5 offset:61184
    buffer_store_dwordx4 v[144:147], v30, s[48:51], s8 offen sc1
    v_exp_f32 v195, v195
    v_exp_f32 v212, v212
    v_mfma_f32_32x32x16_bf16 v[168:183], a[172:175], a[92:95], v[168:183]
    ds_read_b64_tr_b16 a[168:169], v3 offset:62720
    ds_read_b64_tr_b16 a[170:171], v3 offset:63232
    s_waitcnt lgkmcnt(10)
    v_exp_f32 v196, v196
    v_exp_f32 v213, v213
    v_mfma_f32_32x32x16_bf16 v[56:71], a[144:147], a[96:99], v[56:71]
    ds_read_b64_tr_b16 a[172:173], v5 offset:62720
    ds_read_b64_tr_b16 a[174:175], v5 offset:63232
    buffer_load_dwordx4 v20, s[32:35], s77 offen offset:2048 lds
    v_exp_f32 v197, v197
    v_exp_f32 v214, v214
    v_mfma_f32_32x32x16_bf16 v[168:183], a[148:151], a[96:99], v[168:183]
    ds_read_b64_tr_b16 a[144:145], v2 offset:6400
    ds_read_b64_tr_b16 a[146:147], v2 offset:6912
    s_waitcnt lgkmcnt(10)
    v_exp_f32 v198, v198
    v_exp_f32 v215, v215
    v_mfma_f32_32x32x16_bf16 v[56:71], a[152:155], a[100:103], v[56:71]
    ds_read_b64_tr_b16 a[148:149], v4 offset:6400
    ds_read_b64_tr_b16 a[150:151], v4 offset:6912
    buffer_load_dwordx4 v21, s[32:35], s77 offen offset:3072 lds
    v_exp_f32 v199, v199
    v_exp_f32 v236, v236
    v_mfma_f32_32x32x16_bf16 v[168:183], a[156:159], a[100:103], v[168:183]
    ds_read_b64_tr_b16 a[152:153], v2 offset:8448
    ds_read_b64_tr_b16 a[154:155], v2 offset:8960
    s_waitcnt lgkmcnt(10)
    v_exp_f32 v232, v232
    v_exp_f32 v237, v237
    v_mfma_f32_32x32x16_bf16 v[56:71], a[160:163], a[104:107], v[56:71]
    ds_read_b64_tr_b16 a[156:157], v4 offset:8448
    ds_read_b64_tr_b16 a[158:159], v4 offset:8960
    v_exp_f32 v233, v233
    v_add_f32 v239, v200, v201
    v_add_f32 v238, v184, v185
    v_add_f32 v239, v239, v202
    v_mfma_f32_32x32x16_bf16 v[168:183], a[164:167], a[104:107], v[168:183]
    ds_read_b64_tr_b16 a[160:161], v2 offset:10496
    ds_read_b64_tr_b16 a[162:163], v2 offset:11008
    s_waitcnt lgkmcnt(10)
    v_add_f32 v238, v238, v186
    v_add_f32 v239, v239, v203
    v_add_f32 v238, v238, v187
    v_add_f32 v239, v239, v204
    v_mfma_f32_32x32x16_bf16 v[56:71], a[168:171], a[108:111], v[56:71]
    ds_read_b64_tr_b16 a[164:165], v4 offset:10496
    ds_read_b64_tr_b16 a[166:167], v4 offset:11008
    buffer_store_dwordx4 v[148:151], v30, s[48:51], s8 offen offset:1024 sc1
    v_add_f32 v238, v238, v188
    v_add_f32 v239, v239, v205
    v_add_f32 v238, v238, v189
    v_add_f32 v239, v239, v206
    v_mfma_f32_32x32x16_bf16 v[168:183], a[172:175], a[108:111], v[168:183]
    ds_read_b64_tr_b16 a[168:169], v2 offset:12544
    ds_read_b64_tr_b16 a[170:171], v2 offset:13056
    s_waitcnt lgkmcnt(10)
    v_add_f32 v238, v238, v190
    v_add_f32 v239, v239, v207
    v_add_f32 v238, v238, v191
    v_add_f32 v239, v239, v208
    v_mfma_f32_32x32x16_bf16 v[56:71], a[144:147], a[112:115], v[56:71]
    ds_read_b64_tr_b16 a[172:173], v4 offset:12544
    ds_read_b64_tr_b16 a[174:175], v4 offset:13056
    v_add_f32 v238, v238, v192
    v_add_f32 v239, v239, v209
    v_add_f32 v238, v238, v193
    v_add_f32 v239, v239, v210
    v_add_f32 v238, v238, v194
    v_mfma_f32_32x32x16_bf16 v[168:183], a[148:151], a[112:115], v[168:183]
    s_waitcnt vmcnt(28)
    s_barrier
    ds_read_b64_tr_b16 a[144:145], v2 offset:14592
    ds_read_b64_tr_b16 a[146:147], v2 offset:15104
    s_waitcnt lgkmcnt(10)
    s_add_u32 m0, s84, 104704
    v_add_f32 v239, v239, v211
    v_mfma_f32_32x32x16_bf16 v[56:71], a[152:155], a[116:119], v[56:71]
    ds_read_b64_tr_b16 a[148:149], v4 offset:14592
    ds_read_b64_tr_b16 a[150:151], v4 offset:15104
    buffer_load_dwordx4 v18, s[32:35], s78 offen lds
    v_add_f32 v238, v238, v195
    v_add_f32 v239, v239, v212
    v_add_f32 v238, v238, v196
    v_add_f32 v239, v239, v213
    v_mfma_f32_32x32x16_bf16 v[168:183], a[156:159], a[116:119], v[168:183]
    ds_read_b64_tr_b16 a[152:153], v2 offset:16640
    ds_read_b64_tr_b16 a[154:155], v2 offset:17152
    s_waitcnt lgkmcnt(10)
    v_add_f32 v238, v238, v197
    v_add_f32 v239, v239, v214
    v_add_f32 v238, v238, v198
    v_add_f32 v239, v239, v215
    v_mfma_f32_32x32x16_bf16 v[56:71], a[160:163], a[120:123], v[56:71]
    ds_read_b64_tr_b16 a[156:157], v4 offset:16640
    ds_read_b64_tr_b16 a[158:159], v4 offset:17152
    buffer_load_dwordx4 v19, s[32:35], s78 offen offset:1024 lds
    v_add_f32 v238, v238, v199
    v_add_f32 v239, v239, v236
    v_add_f32 v238, v238, v232
    v_add_f32 v239, v239, v237
    v_mfma_f32_32x32x16_bf16 v[168:183], a[164:167], a[120:123], v[168:183]
    ds_read_b64_tr_b16 a[160:161], v2 offset:18688
    ds_read_b64_tr_b16 a[162:163], v2 offset:19200
    s_waitcnt lgkmcnt(10)
    v_add_f32 v238, v238, v233
    v_rcp_f32 v239, v239
    v_mfma_f32_32x32x16_bf16 v[56:71], a[168:171], a[124:127], v[56:71]
    ds_read_b64_tr_b16 a[164:165], v4 offset:18688
    ds_read_b64_tr_b16 a[166:167], v4 offset:19200
    buffer_load_dwordx4 v20, s[32:35], s78 offen offset:2048 lds
    v_rcp_f32 v238, v238
    v_mul_f32 v200, v200, v239
    v_mul_f32 v201, v201, v239
    v_mfma_f32_32x32x16_bf16 v[168:183], a[172:175], a[124:127], v[168:183]
    ds_read_b64_tr_b16 a[168:169], v2 offset:20736
    ds_read_b64_tr_b16 a[170:171], v2 offset:21248
    s_waitcnt lgkmcnt(10)
    v_mul_f32 v202, v202, v239
    v_mul_f32 v203, v203, v239
    v_mul_f32 v204, v204, v239
    v_mul_f32 v205, v205, v239
    v_mfma_f32_32x32x16_bf16 v[56:71], a[144:147], a[128:131], v[56:71]
    ds_read_b64_tr_b16 a[172:173], v4 offset:20736
    ds_read_b64_tr_b16 a[174:175], v4 offset:21248
    buffer_load_dwordx4 v21, s[32:35], s78 offen offset:3072 lds
    v_mul_f32 v206, v206, v239
    v_mul_f32 v207, v207, v239
    v_mul_f32 v208, v208, v239
    v_mul_f32 v209, v209, v239
    v_mfma_f32_32x32x16_bf16 v[168:183], a[148:151], a[128:131], v[168:183]
    s_waitcnt vmcnt(28)
    s_barrier
    ds_read_b64_tr_b16 a[144:145], v2 offset:22784
    ds_read_b64_tr_b16 a[146:147], v2 offset:23296
    s_waitcnt lgkmcnt(10)
    v_mul_f32 v210, v210, v239
    v_mul_f32 v211, v211, v239
    v_mfma_f32_32x32x16_bf16 v[56:71], a[152:155], a[132:135], v[56:71]
    ds_read_b64_tr_b16 a[148:149], v4 offset:22784
    ds_read_b64_tr_b16 a[150:151], v4 offset:23296
    v_mul_f32 v212, v212, v239
    v_mul_f32 v213, v213, v239
    v_mul_f32 v214, v214, v239
    v_mul_f32 v215, v215, v239
    v_mul_f32 v236, v236, v239
    v_mfma_f32_32x32x16_bf16 v[168:183], a[156:159], a[132:135], v[168:183]
    ds_read_b64_tr_b16 a[152:153], v2 offset:30976
    ds_read_b64_tr_b16 a[154:155], v2 offset:31488
    s_waitcnt lgkmcnt(10)
    v_mul_f32 v237, v237, v239
    v_mul_f32 v184, v184, v238
    v_mul_f32 v185, v185, v238
    v_mul_f32 v186, v186, v238
    v_mfma_f32_32x32x16_bf16 v[56:71], a[160:163], a[136:139], v[56:71]
    ds_read_b64_tr_b16 a[156:157], v2 offset:24832
    ds_read_b64_tr_b16 a[158:159], v2 offset:25344
    v_mul_f32 v187, v187, v238
    v_mul_f32 v188, v188, v238
    v_mul_f32 v189, v189, v238
    v_mul_f32 v190, v190, v238
    v_mul_f32 v191, v191, v238
    v_mfma_f32_32x32x16_bf16 v[168:183], a[164:167], a[136:139], v[168:183]
    ds_read_b64_tr_b16 a[160:161], v4 offset:24832
    ds_read_b64_tr_b16 a[162:163], v4 offset:25344
    s_waitcnt lgkmcnt(10)
    v_mul_f32 v192, v192, v238
    v_mul_f32 v193, v193, v238
    v_mul_f32 v194, v194, v238
    v_mul_f32 v195, v195, v238
    v_mfma_f32_32x32x16_bf16 v[56:71], a[168:171], a[140:143], v[56:71]
    ds_read_b64_tr_b16 a[164:165], v2 offset:33024
    ds_read_b64_tr_b16 a[166:167], v2 offset:33536
    v_mul_f32 v196, v196, v238
    v_mul_f32 v197, v197, v238
    v_mul_f32 v198, v198, v238
    v_mul_f32 v199, v199, v238
    v_mul_f32 v232, v232, v238
    v_mfma_f32_32x32x16_bf16 v[168:183], a[172:175], a[140:143], v[168:183]
    ds_read_b64_tr_b16 a[168:169], v2 offset:26880
    ds_read_b64_tr_b16 a[170:171], v2 offset:27392
    s_waitcnt lgkmcnt(10)
    v_mul_f32 v233, v233, v238
    v_cvt_pk_bf16_f32 v184, v184, v185
    v_cvt_pk_bf16_f32 v185, v186, v187
    v_cvt_pk_bf16_f32 v186, v188, v189
    v_mfma_f32_32x32x16_bf16 v[72:87], a[144:147], a[0:3], 0
    ds_read_b64_tr_b16 a[172:173], v4 offset:26880
    ds_read_b64_tr_b16 a[174:175], v4 offset:27392
    v_cvt_pk_bf16_f32 v187, v190, v191
    v_cvt_pk_bf16_f32 v188, v192, v193
    v_cvt_pk_bf16_f32 v189, v194, v195
    v_cvt_pk_bf16_f32 v190, v196, v197
    v_mfma_f32_32x32x16_bf16 v[40:55], a[148:151], a[0:3], 0
    ds_read_b64_tr_b16 a[144:145], v2 offset:35072
    ds_read_b64_tr_b16 a[146:147], v2 offset:35584
    s_waitcnt lgkmcnt(10)
    v_cvt_pk_bf16_f32 v191, v198, v199
    v_cvt_pk_bf16_f32 v192, v232, v233
    v_cvt_pk_bf16_f32 v200, v200, v201
    v_cvt_pk_bf16_f32 v201, v202, v203
    v_mfma_f32_32x32x16_bf16 v[120:135], a[152:155], a[0:3], 0
    ds_read_b64_tr_b16 a[148:149], v2 offset:28928
    ds_read_b64_tr_b16 a[150:151], v2 offset:29440
    v_cvt_pk_bf16_f32 v202, v204, v205
    v_cvt_pk_bf16_f32 v203, v206, v207
    v_cvt_pk_bf16_f32 v204, v208, v209
    v_cvt_pk_bf16_f32 v205, v210, v211
    v_mfma_f32_32x32x16_bf16 v[72:87], a[156:159], a[4:7], v[72:87]
    ds_read_b64_tr_b16 a[152:153], v4 offset:28928
    ds_read_b64_tr_b16 a[154:155], v4 offset:29440
    s_waitcnt lgkmcnt(10)
    v_cvt_pk_bf16_f32 v206, v212, v213
    v_cvt_pk_bf16_f32 v207, v214, v215
    v_cvt_pk_bf16_f32 v208, v236, v237
    v_mov_b32 v193, 0
    v_mfma_f32_32x32x16_bf16 v[40:55], a[160:163], a[4:7], v[40:55]
    ds_read_b64_tr_b16 a[156:157], v2 offset:37120
    ds_read_b64_tr_b16 a[158:159], v2 offset:37632
    v_mov_b32 v209, 0
    v_cvt_pk_bf16_f32 v56, v56, v57
    v_cvt_pk_bf16_f32 v57, v58, v59
    v_pk_max_i16 v56, v56, 0
    v_pk_max_i16 v57, v57, 0
    v_mfma_f32_32x32x16_bf16 v[120:135], a[164:167], a[4:7], v[120:135]
    s_waitcnt vmcnt(24)
    s_barrier
    ds_read_b64_tr_b16 a[160:161], v2 offset:39168
    ds_read_b64_tr_b16 a[162:163], v2 offset:39680
    s_waitcnt lgkmcnt(10)
    s_add_u32 m0, s84, 6400
    v_cvt_pk_bf16_f32 v58, v60, v61
    v_mfma_f32_32x32x16_bf16 v[72:87], a[168:171], a[8:11], v[72:87]
    ds_read_b64_tr_b16 a[164:165], v4 offset:39168
    ds_read_b64_tr_b16 a[166:167], v4 offset:39680
    buffer_load_dwordx4 v18, s[32:35], s79 offen lds
    ds_write_b64 v26, v[184:185]
    ds_write_b64 v26, v[200:201] offset:40
    v_cvt_pk_bf16_f32 v59, v62, v63
    v_mfma_f32_32x32x16_bf16 v[40:55], a[172:175], a[8:11], v[40:55]
    ds_read_b64_tr_b16 a[168:169], v2 offset:47360
    ds_read_b64_tr_b16 a[170:171], v2 offset:47872
    s_waitcnt lgkmcnt(12)
    ds_write_b64 v26, v[186:187] offset:8
    ds_write_b64 v26, v[202:203] offset:48
    v_pk_max_i16 v58, v58, 0
    v_pk_max_i16 v59, v59, 0
    v_mfma_f32_32x32x16_bf16 v[120:135], a[144:147], a[8:11], v[120:135]
    ds_read_b64_tr_b16 a[172:173], v2 offset:41216
    ds_read_b64_tr_b16 a[174:175], v2 offset:41728
    buffer_load_dwordx4 v19, s[32:35], s79 offen offset:1024 lds
    ds_write_b64 v26, v[188:189] offset:16
    ds_write_b64 v26, v[204:205] offset:56
    v_cvt_pk_bf16_f32 v60, v64, v65
    v_mfma_f32_32x32x16_bf16 v[72:87], a[148:151], a[12:15], v[72:87]
    ds_read_b64_tr_b16 a[144:145], v4 offset:41216
    ds_read_b64_tr_b16 a[146:147], v4 offset:41728
    s_waitcnt lgkmcnt(15)
    ds_write_b64 v26, v[190:191] offset:24
    ds_write_b64 v26, v[206:207] offset:64
    v_cvt_pk_bf16_f32 v61, v66, v67
    v_pk_max_i16 v60, v60, 0
    v_mfma_f32_32x32x16_bf16 v[40:55], a[152:155], a[12:15], v[40:55]
    ds_read_b64_tr_b16 a[148:149], v2 offset:49408
    ds_read_b64_tr_b16 a[150:151], v2 offset:49920
    buffer_load_dwordx4 v20, s[32:35], s79 offen offset:2048 lds
    ds_write_b64 v26, v[192:193] offset:32
    ds_write_b64 v26, v[208:209] offset:72
    v_accvgpr_read_b32 v88, a248
    v_mfma_f32_32x32x16_bf16 v[120:135], a[156:159], a[12:15], v[120:135]
    ds_read_b64_tr_b16 a[152:153], v2 offset:43264
    ds_read_b64_tr_b16 a[154:155], v2 offset:43776
    s_waitcnt lgkmcnt(15)
    v_accvgpr_read_b32 v89, a249
    v_accvgpr_read_b32 v90, a250
    v_pk_max_i16 v61, v61, 0
    v_cvt_pk_bf16_f32 v62, v68, v69
    v_mfma_f32_32x32x16_bf16 v[72:87], a[160:163], a[16:19], v[72:87]
    ds_read_b64_tr_b16 a[156:157], v4 offset:43264
    ds_read_b64_tr_b16 a[158:159], v4 offset:43776
    buffer_load_dwordx4 v21, s[32:35], s79 offen offset:3072 lds
    s_waitcnt vmcnt(8)
    v_cvt_pk_bf16_f32 v63, v70, v71
    v_pk_max_i16 v62, v62, 0
    v_pk_max_i16 v63, v63, 0
    v_mfma_f32_32x32x16_bf16 v[40:55], a[164:167], a[16:19], v[40:55]
    ds_read_b64_tr_b16 a[160:161], v2 offset:51456
    ds_read_b64_tr_b16 a[162:163], v2 offset:51968
    s_waitcnt lgkmcnt(15)
    s_mov_b64 exec, 1
    buffer_store_dword v254, v255, s[48:51], s95 offen offset:4 sc1
    s_mov_b64 exec, -1
    v_cvt_pk_bf16_f32 v64, v168, v169
    v_mfma_f32_32x32x16_bf16 v[120:135], a[168:171], a[16:19], v[120:135]
    ds_read_b64_tr_b16 a[164:165], v2 offset:45312
    ds_read_b64_tr_b16 a[166:167], v2 offset:45824
    s_add_u32 s8, s93, 8192
    s_waitcnt lgkmcnt(8)
    s_barrier
    v_cvt_pk_bf16_f32 v65, v170, v171
    v_pk_max_i16 v64, v64, 0
    v_mfma_f32_32x32x16_bf16 v[72:87], a[172:175], a[20:23], v[72:87]
    ds_read_b64_tr_b16 a[168:169], v4 offset:45312
    ds_read_b64_tr_b16 a[170:171], v4 offset:45824
    buffer_store_dwordx4 v[56:59], v30, s[48:51], s8 offen sc1
    ds_read_b64_tr_b16 a[176:177], v27
    ds_read_b64_tr_b16 a[178:179], v27 offset:1080
    v_pk_max_i16 v65, v65, 0
    v_mfma_f32_32x32x16_bf16 v[40:55], a[144:147], a[20:23], v[40:55]
    ds_read_b64_tr_b16 a[172:173], v2 offset:53504
    ds_read_b64_tr_b16 a[174:175], v2 offset:54016
    ds_read_b64_tr_b16 a[180:181], v28
    ds_read_b64_tr_b16 a[182:183], v28 offset:1080
    v_cvt_pk_bf16_f32 v66, v172, v173
    v_cvt_pk_bf16_f32 v67, v174, v175
    v_mfma_f32_32x32x16_bf16 v[120:135], a[148:151], a[20:23], v[120:135]
    s_barrier
    ds_read_b64_tr_b16 a[144:145], v2 offset:55552
    ds_read_b64_tr_b16 a[146:147], v2 offset:56064
    s_waitcnt lgkmcnt(14)
    s_add_u32 m0, s84, 22784
    ds_read_b64_tr_b16 a[184:185], v27 offset:4320
    buffer_load_dwordx4 v18, s[32:35], s80 offen lds
    v_mfma_f32_32x32x16_bf16 v[72:87], a[152:155], a[24:27], v[72:87]
    ds_read_b64_tr_b16 a[148:149], v4 offset:55552
    ds_read_b64_tr_b16 a[150:151], v4 offset:56064
    ds_read_b64_tr_b16 a[186:187], v27 offset:5400
    ds_read_b64_tr_b16 a[188:189], v28 offset:4320
    v_pk_max_i16 v66, v66, 0
    v_pk_max_i16 v67, v67, 0
    v_mfma_f32_32x32x16_bf16 v[40:55], a[156:159], a[24:27], v[40:55]
    ds_read_b64_tr_b16 a[152:153], v2 offset:63744
    ds_read_b64_tr_b16 a[154:155], v2 offset:64256
    s_waitcnt lgkmcnt(15)
    buffer_load_dwordx4 v19, s[32:35], s80 offen offset:1024 lds
    ds_read_b64_tr_b16 a[190:191], v28 offset:5400
    ds_read_b64_tr_b16 a[192:193], v27 offset:8640
    v_cvt_pk_bf16_f32 v68, v176, v177
    v_mfma_f32_32x32x16_bf16 v[120:135], a[160:163], a[24:27], v[120:135]
    ds_read_b64_tr_b16 a[156:157], v2 offset:57600
    ds_read_b64_tr_b16 a[158:159], v2 offset:58112
    ds_read_b64_tr_b16 a[194:195], v27 offset:9720
    ds_read_b64_tr_b16 a[196:197], v28 offset:8640
    v_cvt_pk_bf16_f32 v69, v178, v179
    v_pk_max_i16 v68, v68, 0
    v_mfma_f32_32x32x16_bf16 v[72:87], a[164:167], a[28:31], v[72:87]
    ds_read_b64_tr_b16 a[160:161], v4 offset:57600
    ds_read_b64_tr_b16 a[162:163], v4 offset:58112
    s_waitcnt lgkmcnt(15)
    buffer_load_dwordx4 v20, s[32:35], s80 offen offset:2048 lds
    ds_read_b64_tr_b16 a[198:199], v28 offset:9720
    ds_read_b64_tr_b16 a[200:201], v27 offset:12960
    v_pk_max_i16 v69, v69, 0
    v_mfma_f32_32x32x16_bf16 v[40:55], a[168:171], a[28:31], v[40:55]
    ds_read_b64_tr_b16 a[164:165], v3 offset:1280
    ds_read_b64_tr_b16 a[166:167], v3 offset:1792
    ds_read_b64_tr_b16 a[202:203], v27 offset:14040
    ds_read_b64_tr_b16 a[204:205], v28 offset:12960
    v_cvt_pk_bf16_f32 v70, v180, v181
    v_cvt_pk_bf16_f32 v71, v182, v183
    v_mfma_f32_32x32x16_bf16 v[120:135], a[172:175], a[28:31], v[120:135]
    ds_read_b64_tr_b16 a[168:169], v2 offset:59648
    ds_read_b64_tr_b16 a[170:171], v2 offset:60160
    s_waitcnt lgkmcnt(15)
    buffer_store_dwordx4 v[60:63], v30, s[48:51], s8 offen offset:1024 sc1
    ds_read_b64_tr_b16 a[206:207], v28 offset:14040
    v_pk_max_i16 v70, v70, 0
    v_pk_max_i16 v71, v71, 0
    v_mfma_f32_32x32x16_bf16 v[184:199], a[176:179], a[180:183], 0
    ds_read_b64_tr_b16 a[176:177], v27 offset:17280
    ds_read_b64_tr_b16 a[178:179], v27 offset:18360
    s_add_u32 s8, s93, 10240
    v_mfma_f32_32x32x16_bf16 v[72:87], a[144:147], a[32:35], v[72:87]
    ds_read_b64_tr_b16 a[172:173], v4 offset:59648
    ds_read_b64_tr_b16 a[174:175], v4 offset:60160
    buffer_load_dwordx4 v21, s[32:35], s80 offen offset:3072 lds
    ds_read_b64_tr_b16 a[180:181], v28 offset:17280
    ds_read_b64_tr_b16 a[182:183], v28 offset:18360
    v_mfma_f32_32x32x16_bf16 v[184:199], a[184:187], a[188:191], v[184:199]
    ds_read_b64_tr_b16 a[184:185], v27 offset:21600
    ds_read_b64_tr_b16 a[186:187], v27 offset:22680
    v_mfma_f32_32x32x16_bf16 v[40:55], a[148:151], a[32:35], v[40:55]
    ds_read_b64_tr_b16 a[144:145], v3 offset:3328
    ds_read_b64_tr_b16 a[146:147], v3 offset:3840
    s_waitcnt lgkmcnt(15)
    ds_read_b64_tr_b16 a[188:189], v28 offset:21600
    ds_read_b64_tr_b16 a[190:191], v28 offset:22680
    v_mfma_f32_32x32x16_bf16 v[184:199], a[192:195], a[196:199], v[184:199]
    ds_read_b64_tr_b16 a[192:193], v27 offset:25920
    ds_read_b64_tr_b16 a[194:195], v27 offset:27000
    v_mfma_f32_32x32x16_bf16 v[120:135], a[152:155], a[32:35], v[120:135]
    ds_read_b64_tr_b16 a[148:149], v2 offset:61696
    ds_read_b64_tr_b16 a[150:151], v2 offset:62208
    ds_read_b64_tr_b16 a[196:197], v28 offset:25920
    ds_read_b64_tr_b16 a[198:199], v28 offset:27000
    s_waitcnt lgkmcnt(15)
    v_mfma_f32_32x32x16_bf16 v[184:199], a[200:203], a[204:207], v[184:199]
    ds_read_b64_tr_b16 a[200:201], v27 offset:30240
    ds_read_b64_tr_b16 a[202:203], v27 offset:31320
    v_mfma_f32_32x32x16_bf16 v[72:87], a[156:159], a[36:39], v[72:87]
    ds_read_b64_tr_b16 a[152:153], v4 offset:61696
    ds_read_b64_tr_b16 a[154:155], v4 offset:62208
    buffer_store_dwordx4 v[64:67], v30, s[48:51], s8 offen sc1
    ds_read_b64_tr_b16 a[204:205], v28 offset:30240
    ds_read_b64_tr_b16 a[206:207], v28 offset:31320
    s_waitcnt lgkmcnt(15)
    v_mfma_f32_32x32x16_bf16 v[184:199], a[176:179], a[180:183], v[184:199]
    v_mfma_f32_32x32x16_bf16 v[40:55], a[160:163], a[36:39], v[40:55]
    ds_read_b64_tr_b16 a[156:157], v3 offset:5376
    ds_read_b64_tr_b16 a[158:159], v3 offset:5888
    s_waitcnt lgkmcnt(14)
    v_mfma_f32_32x32x16_bf16 v[184:199], a[184:187], a[188:191], v[184:199]
    v_mfma_f32_32x32x16_bf16 v[120:135], a[164:167], a[36:39], v[120:135]
    s_barrier
    ds_read_b64_tr_b16 a[160:161], v3 offset:7424
    ds_read_b64_tr_b16 a[162:163], v3 offset:7936
    s_add_u32 m0, s84, 39168
    s_waitcnt lgkmcnt(10)
    buffer_load_dwordx4 v18, s[32:35], s81 offen lds
    v_mfma_f32_32x32x16_bf16 v[184:199], a[192:195], a[196:199], v[184:199]
    v_mfma_f32_32x32x16_bf16 v[72:87], a[168:171], a[40:43], v[72:87]
    ds_read_b64_tr_b16 a[164:165], v5 offset:7424
    ds_read_b64_tr_b16 a[166:167], v5 offset:7936
    buffer_load_dwordx4 v19, s[32:35], s81 offen offset:1024 lds
    s_waitcnt lgkmcnt(6)
    v_mfma_f32_32x32x16_bf16 v[184:199], a[200:203], a[204:207], v[184:199]
    v_cvt_pk_bf16_f32 v216, 0, v216
    v_cvt_pk_bf16_f32 v217, 0, v217
    v_cvt_pk_bf16_f32 v218, 0, v218
    v_cvt_pk_bf16_f32 v219, 0, v219
    v_mfma_f32_32x32x16_bf16 v[40:55], a[172:175], a[40:43], v[40:55]
    ds_read_b64_tr_b16 a[168:169], v3 offset:15616
    ds_read_b64_tr_b16 a[170:171], v3 offset:16128
    buffer_store_dwordx4 v[68:71], v30, s[48:51], s8 offen offset:1024 sc1
    v_cvt_pk_bf16_f32 v220, 0, v220
    v_mfma_f32_32x32x16_bf16 v[120:135], a[144:147], a[40:43], v[120:135]
    ds_read_b64_tr_b16 a[172:173], v3 offset:9472
    ds_read_b64_tr_b16 a[174:175], v3 offset:9984
    v_cvt_pk_bf16_f32 v221, 0, v221
    v_cvt_pk_bf16_f32 v222, 0, v222
    v_mfma_f32_32x32x16_bf16 v[72:87], a[148:151], a[44:47], v[72:87]
    ds_read_b64_tr_b16 a[144:145], v5 offset:9472
    ds_read_b64_tr_b16 a[146:147], v5 offset:9984
    s_waitcnt lgkmcnt(10)
    buffer_load_dwordx4 v20, s[32:35], s81 offen offset:2048 lds
    v_cvt_pk_bf16_f32 v223, 0, v223
    v_mfma_f32_32x32x16_bf16 v[40:55], a[152:155], a[44:47], v[40:55]
    ds_read_b64_tr_b16 a[148:149], v3 offset:17664
    ds_read_b64_tr_b16 a[150:151], v3 offset:18176
    v_cvt_pk_bf16_f32 v224, 0, v224
    v_cvt_pk_bf16_f32 v225, 0, v225
    v_mfma_f32_32x32x16_bf16 v[120:135], a[156:159], a[44:47], v[120:135]
    ds_read_b64_tr_b16 a[152:153], v3 offset:11520
    ds_read_b64_tr_b16 a[154:155], v3 offset:12032
    s_waitcnt lgkmcnt(10)
    buffer_load_dwordx4 v21, s[32:35], s81 offen offset:3072 lds
    v_cvt_pk_bf16_f32 v226, 0, v226
    v_mfma_f32_32x32x16_bf16 v[72:87], a[160:163], a[48:51], v[72:87]
    ds_read_b64_tr_b16 a[156:157], v5 offset:11520
    ds_read_b64_tr_b16 a[158:159], v5 offset:12032
    v_cvt_pk_bf16_f32 v227, 0, v227
    v_cvt_pk_bf16_f32 v228, 0, v228
    v_mfma_f32_32x32x16_bf16 v[40:55], a[164:167], a[48:51], v[40:55]
    ds_read_b64_tr_b16 a[160:161], v3 offset:19712
    ds_read_b64_tr_b16 a[162:163], v3 offset:20224
    s_waitcnt lgkmcnt(10)
    v_cvt_pk_bf16_f32 v229, 0, v229
    v_cvt_pk_bf16_f32 v230, 0, v230
    v_mfma_f32_32x32x16_bf16 v[120:135], a[168:171], a[48:51], v[120:135]
    ds_read_b64_tr_b16 a[164:165], v3 offset:13568
    ds_read_b64_tr_b16 a[166:167], v3 offset:14080
    s_mov_b64 exec, 0x3ffff
    buffer_store_dwordx4 v[192:195], v90, s[48:51], s4 offen sc1
    s_mov_b32 exec_hi, 0x3ffff
    buffer_store_dwordx4 v[184:187], v88, s[48:51], s4 offen sc1
    buffer_store_dwordx4 v[188:191], v89, s[48:51], s4 offen sc1
    s_mov_b64 exec, -1
    v_mfma_f32_32x32x16_bf16 v[72:87], a[172:175], a[52:55], v[72:87]
    ds_read_b64_tr_b16 a[168:169], v5 offset:13568
    ds_read_b64_tr_b16 a[170:171], v5 offset:14080
    s_waitcnt lgkmcnt(10)
    v_accvgpr_read_b32 v91, a251
    v_accvgpr_read_b32 v92, a252
    v_accvgpr_read_b32 v93, a253
    v_accvgpr_read_b32 v94, a254
    v_mfma_f32_32x32x16_bf16 v[40:55], a[144:147], a[52:55], v[40:55]
    ds_read_b64_tr_b16 a[172:173], v3 offset:21760
    ds_read_b64_tr_b16 a[174:175], v3 offset:22272
    s_min_u32 s4, s60, 14
    s_lshl_b32 s4, s4, 11
    s_add_u32 s4, s4, s5
    s_min_u32 s5, s60, 14
    v_mfma_f32_32x32x16_bf16 v[120:135], a[148:151], a[52:55], v[120:135]
    s_barrier
    ds_read_b64_tr_b16 a[144:145], v3 offset:23808
    ds_read_b64_tr_b16 a[146:147], v3 offset:24320
    s_waitcnt lgkmcnt(10)
    s_add_u32 m0, s84, 55552
    s_add_u32 s96, s64, s69
    v_mfma_f32_32x32x16_bf16 v[72:87], a[152:155], a[56:59], v[72:87]
    ds_read_b64_tr_b16 a[148:149], v5 offset:23808
    ds_read_b64_tr_b16 a[150:151], v5 offset:24320
    s_mul_i32 s5, s5, 48
    v_cvt_pk_bf16_f32 v231, 0, v231
    v_cvt_pk_bf16_f32 v234, 0, v234
    v_mfma_f32_32x32x16_bf16 v[40:55], a[156:159], a[56:59], v[40:55]
    ds_read_b64_tr_b16 a[152:153], v3 offset:32000
    ds_read_b64_tr_b16 a[154:155], v3 offset:32512
    s_waitcnt lgkmcnt(10)
    v_cvt_pk_bf16_f32 v235, 0, v235
    v_max_f32 v244, v216, v217
    v_mfma_f32_32x32x16_bf16 v[120:135], a[160:163], a[56:59], v[120:135]
    ds_read_b64_tr_b16 a[156:157], v3 offset:25856
    ds_read_b64_tr_b16 a[158:159], v3 offset:26368
    buffer_load_dwordx4 v10, s[36:39], s96 offen lds
    v_min_f32 v245, v216, v217
    v_max3_f32 v244, v244, v218, v219
    v_mfma_f32_32x32x16_bf16 v[72:87], a[164:167], a[60:63], v[72:87]
    ds_read_b64_tr_b16 a[160:161], v5 offset:25856
    ds_read_b64_tr_b16 a[162:163], v5 offset:26368
    s_waitcnt lgkmcnt(10)
    v_min3_f32 v245, v245, v218, v219
    v_max3_f32 v244, v244, v220, v221
    v_mfma_f32_32x32x16_bf16 v[40:55], a[168:171], a[60:63], v[40:55]
    ds_read_b64_tr_b16 a[164:165], v3 offset:34048
    ds_read_b64_tr_b16 a[166:167], v3 offset:34560
    buffer_load_dwordx4 v11, s[36:39], s96 offen offset:1024 lds
    s_add_u32 m0, s84, 57600
    v_mfma_f32_32x32x16_bf16 v[120:135], a[172:175], a[60:63], v[120:135]
    ds_read_b64_tr_b16 a[168:169], v3 offset:27904
    ds_read_b64_tr_b16 a[170:171], v3 offset:28416
    s_waitcnt lgkmcnt(10)
    v_min3_f32 v245, v245, v220, v221
    v_max3_f32 v244, v244, v222, v223
    v_mfma_f32_32x32x16_bf16 v[72:87], a[144:147], a[64:67], v[72:87]
    ds_read_b64_tr_b16 a[172:173], v5 offset:27904
    ds_read_b64_tr_b16 a[174:175], v5 offset:28416
    buffer_load_dwordx4 v12, s[36:39], s96 offen lds
    v_min3_f32 v245, v245, v222, v223
    v_mfma_f32_32x32x16_bf16 v[40:55], a[148:151], a[64:67], v[40:55]
    ds_read_b64_tr_b16 a[144:145], v3 offset:36096
    ds_read_b64_tr_b16 a[146:147], v3 offset:36608
    s_waitcnt lgkmcnt(10)
    v_max3_f32 v244, v244, v224, v225
    v_min3_f32 v245, v245, v224, v225
    v_mfma_f32_32x32x16_bf16 v[120:135], a[152:155], a[64:67], v[120:135]
    ds_read_b64_tr_b16 a[148:149], v3 offset:29952
    ds_read_b64_tr_b16 a[150:151], v3 offset:30464
    buffer_load_dwordx4 v13, s[36:39], s96 offen offset:1024 lds
    buffer_load_dword v250, v255, s[48:51], s101 offen offset:4 sc1
    v_mfma_f32_32x32x16_bf16 v[72:87], a[156:159], a[68:71], v[72:87]
    ds_read_b64_tr_b16 a[152:153], v5 offset:29952
    ds_read_b64_tr_b16 a[154:155], v5 offset:30464
    s_waitcnt lgkmcnt(10)
    v_max3_f32 v244, v244, v226, v227
    v_min3_f32 v245, v245, v226, v227
    v_mfma_f32_32x32x16_bf16 v[40:55], a[160:163], a[68:71], v[40:55]
    ds_read_b64_tr_b16 a[156:157], v3 offset:38144
    ds_read_b64_tr_b16 a[158:159], v3 offset:38656
    v_max3_f32 v244, v244, v228, v229
    v_min3_f32 v245, v245, v228, v229
    v_mfma_f32_32x32x16_bf16 v[120:135], a[164:167], a[68:71], v[120:135]
    s_waitcnt vmcnt(25)
    s_barrier
    ds_read_b64_tr_b16 a[160:161], v3 offset:40192
    ds_read_b64_tr_b16 a[162:163], v3 offset:40704
    s_waitcnt lgkmcnt(10)
    s_add_u32 m0, s83, 129280
    s_nop 0
    buffer_load_dwordx4 v23, s[40:43], s13 offen lds
    buffer_load_dwordx4 v23, s[40:43], s12 offen offset:1024 lds
    s_add_u32 m0, s84, 71936
    v_mfma_f32_32x32x16_bf16 v[72:87], a[168:171], a[72:75], v[72:87]
    ds_read_b64_tr_b16 a[164:165], v5 offset:40192
    ds_read_b64_tr_b16 a[166:167], v5 offset:40704
    s_add_u32 s96, s65, s69
    v_max3_f32 v244, v244, v230, v231
    v_min3_f32 v245, v245, v230, v231
    v_mfma_f32_32x32x16_bf16 v[40:55], a[172:175], a[72:75], v[40:55]
    ds_read_b64_tr_b16 a[168:169], v3 offset:48384
    ds_read_b64_tr_b16 a[170:171], v3 offset:48896
    s_waitcnt lgkmcnt(10)
    v_max3_f32 v244, v244, v234, v235
    v_min3_f32 v245, v245, v234, v235
    v_mfma_f32_32x32x16_bf16 v[120:135], a[144:147], a[72:75], v[120:135]
    ds_read_b64_tr_b16 a[172:173], v3 offset:42240
    ds_read_b64_tr_b16 a[174:175], v3 offset:42752
    v_mul_f32 v244, s86, v244
    v_mul_f32 v245, s86, v245
    v_fma_f32 v200, -v216, s86, v245
    v_mfma_f32_32x32x16_bf16 v[72:87], a[148:151], a[76:79], v[72:87]
    ds_read_b64_tr_b16 a[144:145], v5 offset:42240
    ds_read_b64_tr_b16 a[146:147], v5 offset:42752
    s_waitcnt lgkmcnt(10)
    buffer_load_dwordx4 v10, s[36:39], s96 offen lds
    v_fma_f32 v216, v216, s86, -v244
    v_mfma_f32_32x32x16_bf16 v[40:55], a[152:155], a[76:79], v[40:55]
    ds_read_b64_tr_b16 a[148:149], v3 offset:50432
    ds_read_b64_tr_b16 a[150:151], v3 offset:50944
    v_fma_f32 v201, -v217, s86, v245
    v_fma_f32 v217, v217, s86, -v244
    v_mfma_f32_32x32x16_bf16 v[120:135], a[156:159], a[76:79], v[120:135]
    ds_read_b64_tr_b16 a[152:153], v3 offset:44288
    ds_read_b64_tr_b16 a[154:155], v3 offset:44800
    s_waitcnt lgkmcnt(10)
    buffer_load_dwordx4 v11, s[36:39], s96 offen offset:1024 lds
    s_add_u32 m0, s84, 73984
    v_mfma_f32_32x32x16_bf16 v[72:87], a[160:163], a[80:83], v[72:87]
    ds_read_b64_tr_b16 a[156:157], v5 offset:44288
    ds_read_b64_tr_b16 a[158:159], v5 offset:44800
    v_fma_f32 v202, -v218, s86, v245
    v_fma_f32 v218, v218, s86, -v244
    v_mfma_f32_32x32x16_bf16 v[40:55], a[164:167], a[80:83], v[40:55]
    ds_read_b64_tr_b16 a[160:161], v3 offset:52480
    ds_read_b64_tr_b16 a[162:163], v3 offset:52992
    s_waitcnt lgkmcnt(10)
    buffer_load_dwordx4 v12, s[36:39], s96 offen lds
    s_waitcnt vmcnt(15)
    v_mfma_f32_32x32x16_bf16 v[120:135], a[168:171], a[80:83], v[120:135]
    ds_read_b64_tr_b16 a[164:165], v3 offset:46336
    ds_read_b64_tr_b16 a[166:167], v3 offset:46848
    s_mov_b64 exec, 1
    buffer_store_dword v254, v255, s[48:51], s95 offen offset:8 sc1
    s_mov_b64 exec, -1
    v_mfma_f32_32x32x16_bf16 v[72:87], a[172:175], a[84:87], v[72:87]
    ds_read_b64_tr_b16 a[168:169], v5 offset:46336
    ds_read_b64_tr_b16 a[170:171], v5 offset:46848
    s_waitcnt lgkmcnt(10)
    v_fma_f32 v203, -v219, s86, v245
    v_fma_f32 v219, v219, s86, -v244
    v_mfma_f32_32x32x16_bf16 v[40:55], a[144:147], a[84:87], v[40:55]
    ds_read_b64_tr_b16 a[172:173], v3 offset:54528
    ds_read_b64_tr_b16 a[174:175], v3 offset:55040
    buffer_load_dwordx4 v13, s[36:39], s96 offen offset:1024 lds
    v_fma_f32 v204, -v220, s86, v245
    v_mfma_f32_32x32x16_bf16 v[120:135], a[148:151], a[84:87], v[120:135]
    s_barrier
    ds_read_b64_tr_b16 a[144:145], v2 offset:6400
    ds_read_b64_tr_b16 a[146:147], v2 offset:6912
    s_waitcnt lgkmcnt(10)
    s_add_u32 m0, s84, 88320
    s_add_u32 s96, s66, s69
    v_mfma_f32_32x32x16_bf16 v[72:87], a[152:155], a[88:91], v[72:87]
    ds_read_b64_tr_b16 a[148:149], v4 offset:6400
    ds_read_b64_tr_b16 a[150:151], v4 offset:6912
    buffer_load_dwordx4 v10, s[36:39], s96 offen lds
    v_fma_f32 v220, v220, s86, -v244
    v_mfma_f32_32x32x16_bf16 v[40:55], a[156:159], a[88:91], v[40:55]
    ds_read_b64_tr_b16 a[152:153], v2 offset:14592
    ds_read_b64_tr_b16 a[154:155], v2 offset:15104
    s_waitcnt lgkmcnt(10)
    v_fma_f32 v205, -v221, s86, v245
    v_fma_f32 v221, v221, s86, -v244
    v_mfma_f32_32x32x16_bf16 v[120:135], a[160:163], a[88:91], v[120:135]
    ds_read_b64_tr_b16 a[156:157], v2 offset:8448
    ds_read_b64_tr_b16 a[158:159], v2 offset:8960
    buffer_load_dwordx4 v11, s[36:39], s96 offen offset:1024 lds
    s_add_u32 m0, s84, 90368
    v_mfma_f32_32x32x16_bf16 v[72:87], a[164:167], a[92:95], v[72:87]
    ds_read_b64_tr_b16 a[160:161], v4 offset:8448
    ds_read_b64_tr_b16 a[162:163], v4 offset:8960
    s_waitcnt lgkmcnt(10)
    v_fma_f32 v206, -v222, s86, v245
    v_fma_f32 v222, v222, s86, -v244
    v_mfma_f32_32x32x16_bf16 v[40:55], a[168:171], a[92:95], v[40:55]
    ds_read_b64_tr_b16 a[164:165], v2 offset:16640
    ds_read_b64_tr_b16 a[166:167], v2 offset:17152
    buffer_load_dwordx4 v12, s[36:39], s96 offen lds
    v_fma_f32 v207, -v223, s86, v245
    v_mfma_f32_32x32x16_bf16 v[120:135], a[172:175], a[92:95], v[120:135]
    ds_read_b64_tr_b16 a[168:169], v2 offset:10496
    ds_read_b64_tr_b16 a[170:171], v2 offset:11008
    s_waitcnt lgkmcnt(10)
    v_fma_f32 v223, v223, s86, -v244
    v_fma_f32 v208, -v224, s86, v245
    v_mfma_f32_32x32x16_bf16 v[72:87], a[144:147], a[96:99], v[72:87]
    ds_read_b64_tr_b16 a[172:173], v4 offset:10496
    ds_read_b64_tr_b16 a[174:175], v4 offset:11008
    buffer_load_dwordx4 v13, s[36:39], s96 offen offset:1024 lds
    v_fma_f32 v224, v224, s86, -v244
    v_mfma_f32_32x32x16_bf16 v[40:55], a[148:151], a[96:99], v[40:55]
    ds_read_b64_tr_b16 a[144:145], v2 offset:18688
    ds_read_b64_tr_b16 a[146:147], v2 offset:19200
    s_waitcnt lgkmcnt(10)
    v_fma_f32 v209, -v225, s86, v245
    v_fma_f32 v225, v225, s86, -v244
    v_mfma_f32_32x32x16_bf16 v[120:135], a[152:155], a[96:99], v[120:135]
    ds_read_b64_tr_b16 a[148:149], v2 offset:12544
    ds_read_b64_tr_b16 a[150:151], v2 offset:13056
    v_fma_f32 v210, -v226, s86, v245
    v_fma_f32 v226, v226, s86, -v244
    v_mfma_f32_32x32x16_bf16 v[72:87], a[156:159], a[100:103], v[72:87]
    ds_read_b64_tr_b16 a[152:153], v4 offset:12544
    ds_read_b64_tr_b16 a[154:155], v4 offset:13056
    s_waitcnt lgkmcnt(10)
    v_fma_f32 v211, -v227, s86, v245
    v_fma_f32 v227, v227, s86, -v244
    v_mfma_f32_32x32x16_bf16 v[40:55], a[160:163], a[100:103], v[40:55]
    ds_read_b64_tr_b16 a[156:157], v2 offset:20736
    ds_read_b64_tr_b16 a[158:159], v2 offset:21248
    v_fma_f32 v212, -v228, s86, v245
    v_fma_f32 v228, v228, s86, -v244
    v_mfma_f32_32x32x16_bf16 v[120:135], a[164:167], a[100:103], v[120:135]
    s_barrier
    ds_read_b64_tr_b16 a[160:161], v2 offset:22784
    ds_read_b64_tr_b16 a[162:163], v2 offset:23296
    s_waitcnt lgkmcnt(10)
    s_add_u32 m0, s84, 104704
    s_add_u32 s96, s67, s69
    v_mfma_f32_32x32x16_bf16 v[72:87], a[168:171], a[104:107], v[72:87]
    ds_read_b64_tr_b16 a[164:165], v4 offset:22784
    ds_read_b64_tr_b16 a[166:167], v4 offset:23296
    buffer_load_dwordx4 v10, s[36:39], s96 offen lds
    s_waitcnt vmcnt(12)
    v_cmp_ne_u32_e64 s[10:11], 1, v250
    v_mfma_f32_32x32x16_bf16 v[40:55], a[172:175], a[104:107], v[40:55]
    ds_read_b64_tr_b16 a[168:169], v2 offset:30976
    ds_read_b64_tr_b16 a[170:171], v2 offset:31488
    s_waitcnt lgkmcnt(10)
    s_cmp_lg_u64 s[10:11], 0
    s_cbranch_scc1 L_slow_14
L_back_15:
    s_add_u32 s9, s94, 0
    v_mfma_f32_32x32x16_bf16 v[120:135], a[144:147], a[104:107], v[120:135]
    ds_read_b64_tr_b16 a[172:173], v2 offset:24832
    ds_read_b64_tr_b16 a[174:175], v2 offset:25344
    buffer_load_dwordx4 a[208:211], v30, s[48:51], s9 offen
    v_fma_f32 v213, -v229, s86, v245
    v_mfma_f32_32x32x16_bf16 v[72:87], a[148:151], a[108:111], v[72:87]
    ds_read_b64_tr_b16 a[144:145], v4 offset:24832
    ds_read_b64_tr_b16 a[146:147], v4 offset:25344
    s_waitcnt lgkmcnt(10)
    v_fma_f32 v229, v229, s86, -v244
    v_fma_f32 v214, -v230, s86, v245
    v_mfma_f32_32x32x16_bf16 v[40:55], a[152:155], a[108:111], v[40:55]
    ds_read_b64_tr_b16 a[148:149], v2 offset:33024
    ds_read_b64_tr_b16 a[150:151], v2 offset:33536
    buffer_load_dwordx4 a[212:215], v30, s[48:51], s9 offen offset:1024
    s_add_u32 s9, s94, 2048
    v_mfma_f32_32x32x16_bf16 v[120:135], a[156:159], a[108:111], v[120:135]
    ds_read_b64_tr_b16 a[152:153], v2 offset:26880
    ds_read_b64_tr_b16 a[154:155], v2 offset:27392
    s_waitcnt lgkmcnt(10)
    v_fma_f32 v230, v230, s86, -v244
    v_fma_f32 v215, -v231, s86, v245
    v_mfma_f32_32x32x16_bf16 v[72:87], a[160:163], a[112:115], v[72:87]
    ds_read_b64_tr_b16 a[156:157], v4 offset:26880
    ds_read_b64_tr_b16 a[158:159], v4 offset:27392
    buffer_load_dwordx4 v[96:99], v91, s[48:51], s4 offen sc1
    v_fma_f32 v231, v231, s86, -v244
    v_mfma_f32_32x32x16_bf16 v[40:55], a[164:167], a[112:115], v[40:55]
    ds_read_b64_tr_b16 a[160:161], v2 offset:35072
    ds_read_b64_tr_b16 a[162:163], v2 offset:35584
    s_waitcnt lgkmcnt(10)
    v_fma_f32 v236, -v234, s86, v245
    v_fma_f32 v234, v234, s86, -v244
    v_mfma_f32_32x32x16_bf16 v[120:135], a[168:171], a[112:115], v[120:135]
    ds_read_b64_tr_b16 a[164:165], v2 offset:28928
    ds_read_b64_tr_b16 a[166:167], v2 offset:29440
    buffer_load_dwordx2 v[100:101], v92, s[48:51], s4 offen offset:64 sc1
    v_fma_f32 v237, -v235, s86, v245
    v_mfma_f32_32x32x16_bf16 v[72:87], a[172:175], a[116:119], v[72:87]
    ds_read_b64_tr_b16 a[168:169], v4 offset:28928
    ds_read_b64_tr_b16 a[170:171], v4 offset:29440
    s_waitcnt lgkmcnt(10)
    buffer_load_dwordx4 a[216:219], v30, s[48:51], s9 offen
    v_fma_f32 v235, v235, s86, -v244
    v_mfma_f32_32x32x16_bf16 v[40:55], a[144:147], a[116:119], v[40:55]
    ds_read_b64_tr_b16 a[172:173], v2 offset:37120
    ds_read_b64_tr_b16 a[174:175], v2 offset:37632
    v_exp_f32 v200, v200
    v_exp_f32 v216, v216
    v_mfma_f32_32x32x16_bf16 v[120:135], a[148:151], a[116:119], v[120:135]
    s_barrier
    ds_read_b64_tr_b16 a[144:145], v2 offset:39168
    ds_read_b64_tr_b16 a[146:147], v2 offset:39680
    s_waitcnt lgkmcnt(10)
    buffer_load_dwordx4 a[220:223], v30, s[48:51], s9 offen offset:1024
    s_add_u32 s9, s94, 4096
    v_mfma_f32_32x32x16_bf16 v[72:87], a[152:155], a[120:123], v[72:87]
    ds_read_b64_tr_b16 a[148:149], v4 offset:39168
    ds_read_b64_tr_b16 a[150:151], v4 offset:39680
    v_exp_f32 v201, v201
    v_exp_f32 v217, v217
    v_mfma_f32_32x32x16_bf16 v[40:55], a[156:159], a[120:123], v[40:55]
    ds_read_b64_tr_b16 a[152:153], v2 offset:47360
    ds_read_b64_tr_b16 a[154:155], v2 offset:47872
    s_waitcnt lgkmcnt(10)
    buffer_load_dwordx4 a[224:227], v30, s[48:51], s9 offen
    v_exp_f32 v202, v202
    v_mfma_f32_32x32x16_bf16 v[120:135], a[160:163], a[120:123], v[120:135]
    ds_read_b64_tr_b16 a[156:157], v2 offset:41216
    ds_read_b64_tr_b16 a[158:159], v2 offset:41728
    v_exp_f32 v218, v218
    v_exp_f32 v203, v203
    v_mfma_f32_32x32x16_bf16 v[72:87], a[164:167], a[124:127], v[72:87]
    ds_read_b64_tr_b16 a[160:161], v4 offset:41216
    ds_read_b64_tr_b16 a[162:163], v4 offset:41728
    s_waitcnt lgkmcnt(10)
    buffer_load_dwordx4 a[228:231], v30, s[48:51], s9 offen offset:1024
    s_waitcnt vmcnt(18)
    s_add_u32 s9, s94, 6144
    v_mfma_f32_32x32x16_bf16 v[40:55], a[168:171], a[124:127], v[40:55]
    ds_read_b64_tr_b16 a[164:165], v2 offset:49408
    ds_read_b64_tr_b16 a[166:167], v2 offset:49920
    v_exp_f32 v219, v219
    v_exp_f32 v204, v204
    v_mfma_f32_32x32x16_bf16 v[120:135], a[172:175], a[124:127], v[120:135]
    ds_read_b64_tr_b16 a[168:169], v2 offset:43264
    ds_read_b64_tr_b16 a[170:171], v2 offset:43776
    s_waitcnt lgkmcnt(10)
    buffer_load_dwordx4 a[232:235], v30, s[48:51], s9 offen
    v_exp_f32 v220, v220
    v_mfma_f32_32x32x16_bf16 v[72:87], a[144:147], a[128:131], v[72:87]
    ds_read_b64_tr_b16 a[172:173], v4 offset:43264
    ds_read_b64_tr_b16 a[174:175], v4 offset:43776
    v_exp_f32 v205, v205
    v_exp_f32 v221, v221
    v_mfma_f32_32x32x16_bf16 v[40:55], a[148:151], a[128:131], v[40:55]
    ds_read_b64_tr_b16 a[144:145], v2 offset:51456
    ds_read_b64_tr_b16 a[146:147], v2 offset:51968
    s_waitcnt lgkmcnt(10)
    buffer_load_dwordx4 a[236:239], v30, s[48:51], s9 offen offset:1024
    v_exp_f32 v206, v206
    v_mfma_f32_32x32x16_bf16 v[120:135], a[152:155], a[128:131], v[120:135]
    ds_read_b64_tr_b16 a[148:149], v2 offset:45312
    ds_read_b64_tr_b16 a[150:151], v2 offset:45824
    v_exp_f32 v222, v222
    v_exp_f32 v207, v207
    v_mfma_f32_32x32x16_bf16 v[72:87], a[156:159], a[132:135], v[72:87]
    ds_read_b64_tr_b16 a[152:153], v4 offset:45312
    ds_read_b64_tr_b16 a[154:155], v4 offset:45824
    s_waitcnt lgkmcnt(10)
    v_exp_f32 v223, v223
    v_mfma_f32_32x32x16_bf16 v[40:55], a[160:163], a[132:135], v[40:55]
    ds_read_b64_tr_b16 a[156:157], v2 offset:53504
    ds_read_b64_tr_b16 a[158:159], v2 offset:54016
    buffer_load_dwordx4 v11, s[36:39], s96 offen offset:1024 lds
    s_add_u32 m0, s84, 106752
    v_exp_f32 v208, v208
    v_mfma_f32_32x32x16_bf16 v[120:135], a[164:167], a[132:135], v[120:135]
    s_barrier
    ds_read_b64_tr_b16 a[160:161], v6 offset:55552
    ds_read_b64_tr_b16 a[162:163], v6 offset:56576
    s_waitcnt lgkmcnt(10)
    v_exp_f32 v224, v224
    v_mfma_f32_32x32x16_bf16 v[72:87], a[168:171], a[136:139], v[72:87]
    ds_read_b64_tr_b16 a[164:165], v8 offset:55552
    ds_read_b64_tr_b16 a[166:167], v8 offset:56576
    buffer_load_dwordx4 v12, s[36:39], s96 offen lds
    v_exp_f32 v209, v209
    v_mfma_f32_32x32x16_bf16 v[40:55], a[172:175], a[136:139], v[40:55]
    ds_read_b64_tr_b16 a[168:169], v6 offset:57600
    ds_read_b64_tr_b16 a[170:171], v6 offset:58624
    s_waitcnt lgkmcnt(10)
    v_exp_f32 v225, v225
    v_mfma_f32_32x32x16_bf16 v[120:135], a[144:147], a[136:139], v[120:135]
    ds_read_b64_tr_b16 a[172:173], v8 offset:57600
    ds_read_b64_tr_b16 a[174:175], v8 offset:58624
    buffer_load_dwordx4 v13, s[36:39], s96 offen offset:1024 lds
    s_add_u32 m0, s84, 6400
    v_exp_f32 v210, v210
    v_mfma_f32_32x32x16_bf16 v[72:87], a[148:151], a[140:143], v[72:87]
    ds_read_b64_tr_b16 a[144:145], v6 offset:59648
    ds_read_b64_tr_b16 a[146:147], v6 offset:60672
    s_waitcnt lgkmcnt(10)
    s_add_u32 s96, s64, s70
    v_exp_f32 v226, v226
    v_mfma_f32_32x32x16_bf16 v[40:55], a[152:155], a[140:143], v[40:55]
    ds_read_b64_tr_b16 a[148:149], v8 offset:59648
    ds_read_b64_tr_b16 a[150:151], v8 offset:60672
    buffer_load_dwordx4 v10, s[36:39], s96 offen lds
    v_exp_f32 v211, v211
    v_mfma_f32_32x32x16_bf16 v[120:135], a[156:159], a[140:143], v[120:135]
    ds_read_b64_tr_b16 a[152:153], v6 offset:61696
    ds_read_b64_tr_b16 a[154:155], v6 offset:62720
    s_waitcnt lgkmcnt(10)
    buffer_load_dword v251, v255, s[48:51], s101 offen offset:8 sc1
    v_cvt_pk_bf16_f32 v72, v72, v73
    v_cvt_pk_bf16_f32 v73, v74, v75
    v_pk_max_i16 v72, v72, 0
    v_mfma_f32_32x32x16_bf16 a[0:15], a[160:163], v[104:107], 0
    ds_read_b64_tr_b16 a[156:157], v8 offset:61696
    ds_read_b64_tr_b16 a[158:159], v8 offset:62720
    buffer_load_dwordx4 v11, s[36:39], s96 offen offset:1024 lds
    s_add_u32 m0, s84, 8448
    v_pk_max_i16 v73, v73, 0
    v_mfma_f32_32x32x16_bf16 a[16:31], a[164:167], v[104:107], 0
    ds_read_b64_tr_b16 a[160:161], v6 offset:63744
    ds_read_b64_tr_b16 a[162:163], v6 offset:64768
    s_waitcnt lgkmcnt(10)
    v_cvt_pk_bf16_f32 v74, v76, v77
    v_cvt_pk_bf16_f32 v75, v78, v79
    v_pk_max_i16 v74, v74, 0
    v_mfma_f32_32x32x16_bf16 a[0:15], a[168:171], v[112:115], a[0:15]
    ds_read_b64_tr_b16 a[164:165], v8 offset:63744
    ds_read_b64_tr_b16 a[166:167], v8 offset:64768
    v_pk_max_i16 v75, v75, 0
    v_cvt_pk_bf16_f32 v76, v80, v81
    v_cvt_pk_bf16_f32 v77, v82, v83
    v_mfma_f32_32x32x16_bf16 a[16:31], a[172:175], v[112:115], a[16:31]
    ds_read_b64_tr_b16 a[168:169], v7 offset:1280
    ds_read_b64_tr_b16 a[170:171], v7 offset:2304
    s_waitcnt lgkmcnt(10)
    buffer_load_dwordx4 v12, s[36:39], s96 offen lds
    v_pk_max_i16 v76, v76, 0
    v_pk_max_i16 v77, v77, 0
    v_mfma_f32_32x32x16_bf16 a[0:15], a[144:147], v[108:111], a[0:15]
    ds_read_b64_tr_b16 a[172:173], v9 offset:1280
    ds_read_b64_tr_b16 a[174:175], v9 offset:2304
    v_cvt_pk_bf16_f32 v78, v84, v85
    v_cvt_pk_bf16_f32 v79, v86, v87
    v_pk_max_i16 v78, v78, 0
    v_mfma_f32_32x32x16_bf16 a[16:31], a[148:151], v[108:111], a[16:31]
    ds_read_b64_tr_b16 a[144:145], v7 offset:3328
    ds_read_b64_tr_b16 a[146:147], v7 offset:4352
    s_waitcnt lgkmcnt(10)
    buffer_load_dwordx4 v13, s[36:39], s96 offen offset:1024 lds
    s_add_u32 m0, s84, 22784
    v_pk_max_i16 v79, v79, 0
    v_mfma_f32_32x32x16_bf16 a[0:15], a[152:155], v[116:119], a[0:15]
    ds_read_b64_tr_b16 a[148:149], v9 offset:3328
    ds_read_b64_tr_b16 a[150:151], v9 offset:4352
    s_add_u32 s96, s65, s70
    v_cvt_pk_bf16_f32 v80, v40, v41
    v_cvt_pk_bf16_f32 v81, v42, v43
    v_pk_max_i16 v80, v80, 0
    v_mfma_f32_32x32x16_bf16 a[16:31], a[156:159], v[116:119], a[16:31]
    ds_read_b64_tr_b16 a[152:153], v7 offset:5376
    ds_read_b64_tr_b16 a[154:155], v7 offset:6400
    s_waitcnt lgkmcnt(10)
    buffer_load_dwordx4 v10, s[36:39], s96 offen lds
    v_pk_max_i16 v81, v81, 0
    v_cvt_pk_bf16_f32 v82, v44, v45
    v_mfma_f32_32x32x16_bf16 a[0:15], a[160:163], v[136:139], a[0:15]
    ds_read_b64_tr_b16 a[156:157], v9 offset:5376
    ds_read_b64_tr_b16 a[158:159], v9 offset:6400
    v_cvt_pk_bf16_f32 v83, v46, v47
    v_pk_max_i16 v82, v82, 0
    v_pk_max_i16 v83, v83, 0
    v_mfma_f32_32x32x16_bf16 a[16:31], a[164:167], v[136:139], a[16:31]
    s_waitcnt vmcnt(24)
    s_barrier
    ds_read_b64_tr_b16 a[160:161], v7 offset:7424
    ds_read_b64_tr_b16 a[162:163], v7 offset:8448
    s_waitcnt lgkmcnt(10)
    buffer_load_dwordx4 v11, s[36:39], s96 offen offset:1024 lds
    s_add_u32 m0, s84, 24832
    v_mfma_f32_32x32x16_bf16 a[0:15], a[168:171], v[144:147], a[0:15]
    ds_read_b64_tr_b16 a[164:165], v9 offset:7424
    ds_read_b64_tr_b16 a[166:167], v9 offset:8448
    v_cvt_pk_bf16_f32 v84, v48, v49
    v_cvt_pk_bf16_f32 v85, v50, v51
    v_pk_max_i16 v84, v84, 0
    v_mfma_f32_32x32x16_bf16 a[16:31], a[172:175], v[144:147], a[16:31]
    ds_read_b64_tr_b16 a[168:169], v7 offset:9472
    ds_read_b64_tr_b16 a[170:171], v7 offset:10496
    s_waitcnt lgkmcnt(10)
    buffer_load_dwordx4 v12, s[36:39], s96 offen lds
    v_pk_max_i16 v85, v85, 0
    v_cvt_pk_bf16_f32 v86, v52, v53
    v_mfma_f32_32x32x16_bf16 a[0:15], a[144:147], v[140:143], a[0:15]
    ds_read_b64_tr_b16 a[172:173], v9 offset:9472
    ds_read_b64_tr_b16 a[174:175], v9 offset:10496
    v_cvt_pk_bf16_f32 v87, v54, v55
    v_pk_max_i16 v86, v86, 0
    v_pk_max_i16 v87, v87, 0
    v_mfma_f32_32x32x16_bf16 a[16:31], a[148:151], v[140:143], a[16:31]
    ds_read_b64_tr_b16 a[144:145], v7 offset:11520
    ds_read_b64_tr_b16 a[146:147], v7 offset:12544
    s_waitcnt lgkmcnt(10)
    buffer_load_dwordx4 v13, s[36:39], s96 offen offset:1024 lds
    s_add_u32 m0, s84, 39168
    v_cvt_pk_bf16_f32 v120, v120, v121
    v_mfma_f32_32x32x16_bf16 a[0:15], a[152:155], v[148:151], a[0:15]
    ds_read_b64_tr_b16 a[148:149], v9 offset:11520
    ds_read_b64_tr_b16 a[150:151], v9 offset:12544
    s_add_u32 s96, s66, s70
    v_cvt_pk_bf16_f32 v121, v122, v123
    v_pk_max_i16 v120, v120, 0
    v_pk_max_i16 v121, v121, 0
    v_mfma_f32_32x32x16_bf16 a[16:31], a[156:159], v[148:151], a[16:31]
    ds_read_b64_tr_b16 a[152:153], v7 offset:13568
    ds_read_b64_tr_b16 a[154:155], v7 offset:14592
    s_waitcnt lgkmcnt(10)
    buffer_load_dwordx4 v10, s[36:39], s96 offen lds
    v_cvt_pk_bf16_f32 v122, v124, v125
    v_cvt_pk_bf16_f32 v123, v126, v127
    v_mfma_f32_32x32x16_bf16 a[32:47], a[160:163], v[104:107], 0
    ds_read_b64_tr_b16 a[156:157], v9 offset:13568
    ds_read_b64_tr_b16 a[158:159], v9 offset:14592
    v_pk_max_i16 v122, v122, 0
    v_pk_max_i16 v123, v123, 0
    v_cvt_pk_bf16_f32 v124, v128, v129
    v_mfma_f32_32x32x16_bf16 a[48:63], a[164:167], v[104:107], 0
    ds_read_b64_tr_b16 a[160:161], v7 offset:15616
    ds_read_b64_tr_b16 a[162:163], v7 offset:16640
    s_waitcnt lgkmcnt(10)
    buffer_load_dwordx4 v11, s[36:39], s96 offen offset:1024 lds
    s_add_u32 m0, s84, 41216
    v_cvt_pk_bf16_f32 v125, v130, v131
    v_mfma_f32_32x32x16_bf16 a[32:47], a[168:171], v[112:115], a[32:47]
    ds_read_b64_tr_b16 a[164:165], v9 offset:15616
    ds_read_b64_tr_b16 a[166:167], v9 offset:16640
    v_pk_max_i16 v124, v124, 0
    v_pk_max_i16 v125, v125, 0
    v_cvt_pk_bf16_f32 v126, v132, v133
    v_mfma_f32_32x32x16_bf16 a[48:63], a[172:175], v[112:115], a[48:63]
    ds_read_b64_tr_b16 a[168:169], v7 offset:17664
    ds_read_b64_tr_b16 a[170:171], v7 offset:18688
    s_waitcnt lgkmcnt(10)
    buffer_load_dwordx4 v12, s[36:39], s96 offen lds
    v_cvt_pk_bf16_f32 v127, v134, v135
    v_pk_max_i16 v126, v126, 0
    v_mfma_f32_32x32x16_bf16 a[32:47], a[144:147], v[108:111], a[32:47]
    ds_read_b64_tr_b16 a[172:173], v9 offset:17664
    ds_read_b64_tr_b16 a[174:175], v9 offset:18688
    v_pk_max_i16 v127, v127, 0
    s_add_u32 s8, s93, 12288
    s_waitcnt vmcnt(21)
    v_mfma_f32_32x32x16_bf16 a[48:63], a[148:151], v[108:111], a[48:63]
    ds_read_b64_tr_b16 a[144:145], v7 offset:19712
    ds_read_b64_tr_b16 a[146:147], v7 offset:20736
    s_waitcnt lgkmcnt(10)
    buffer_store_dwordx4 v[72:75], v30, s[48:51], s8 offen sc1
    s_mov_b32 s6, 0xf0f0f0f0
    v_mfma_f32_32x32x16_bf16 a[32:47], a[152:155], v[116:119], a[32:47]
    ds_read_b64_tr_b16 a[148:149], v9 offset:19712
    ds_read_b64_tr_b16 a[150:151], v9 offset:20736
    s_mov_b32 s7, 0xf0f0f0f0
    v_permlane16_swap_b32 v96, v97
    v_mfma_f32_32x32x16_bf16 a[48:63], a[156:159], v[116:119], a[48:63]
    ds_read_b64_tr_b16 a[152:153], v7 offset:21760
    ds_read_b64_tr_b16 a[154:155], v7 offset:22784
    s_waitcnt lgkmcnt(10)
    v_permlane16_swap_b32 v98, v99
    v_mfma_f32_32x32x16_bf16 a[32:47], a[160:163], v[136:139], a[32:47]
    ds_read_b64_tr_b16 a[156:157], v9 offset:21760
    ds_read_b64_tr_b16 a[158:159], v9 offset:22784
    buffer_load_dwordx4 v13, s[36:39], s96 offen offset:1024 lds
    v_permlane16_swap_b32 v100, v101
    v_add_f32 v100, v100, v101
    v_mfma_f32_32x32x16_bf16 a[48:63], a[164:167], v[136:139], a[48:63]
    s_barrier
    ds_read_b64_tr_b16 a[160:161], v7 offset:23808
    ds_read_b64_tr_b16 a[162:163], v7 offset:24832
    s_waitcnt lgkmcnt(10)
    s_add_u32 m0, s84, 55552
    s_add_u32 s96, s67, s70
    v_mfma_f32_32x32x16_bf16 a[32:47], a[168:171], v[144:147], a[32:47]
    ds_read_b64_tr_b16 a[164:165], v9 offset:23808
    ds_read_b64_tr_b16 a[166:167], v9 offset:24832
    buffer_store_dwordx4 v[76:79], v30, s[48:51], s8 offen offset:1024 sc1
    s_add_u32 s8, s93, 14336
    v_add_f32 v96, v96, v97
    v_add_f32 v98, v98, v99
    v_mfma_f32_32x32x16_bf16 a[48:63], a[172:175], v[144:147], a[48:63]
    ds_read_b64_tr_b16 a[168:169], v7 offset:25856
    ds_read_b64_tr_b16 a[170:171], v7 offset:26880
    s_waitcnt lgkmcnt(10)
    s_waitcnt vmcnt(13)
    v_cmp_ne_u32_e64 s[16:17], 1, v251
    v_mov_b32 v101, v100
    v_mfma_f32_32x32x16_bf16 a[32:47], a[144:147], v[140:143], a[32:47]
    ds_read_b64_tr_b16 a[172:173], v9 offset:25856
    ds_read_b64_tr_b16 a[174:175], v9 offset:26880
    buffer_load_dwordx4 v10, s[36:39], s96 offen lds
    s_cmp_lg_u64 s[16:17], 0
    s_cbranch_scc1 L_slow_17
L_back_18:
    v_mfma_f32_32x32x16_bf16 a[48:63], a[148:151], v[140:143], a[48:63]
    ds_read_b64_tr_b16 a[144:145], v7 offset:27904
    ds_read_b64_tr_b16 a[146:147], v7 offset:28928
    s_waitcnt lgkmcnt(10)
    s_add_u32 s19, s94, 8192
    v_permlane32_swap_b32 v96, v98
    v_mfma_f32_32x32x16_bf16 a[32:47], a[152:155], v[148:151], a[32:47]
    ds_read_b64_tr_b16 a[148:149], v9 offset:27904
    ds_read_b64_tr_b16 a[150:151], v9 offset:28928
    buffer_store_dwordx4 v[80:83], v30, s[48:51], s8 offen sc1
    v_permlane32_swap_b32 v100, v101
    v_add_f32 v96, v96, v98
    v_mfma_f32_32x32x16_bf16 a[48:63], a[156:159], v[148:151], a[48:63]
    ds_read_b64_tr_b16 a[152:153], v7 offset:29952
    ds_read_b64_tr_b16 a[154:155], v7 offset:30976
    s_waitcnt lgkmcnt(10)
    v_add_f32 v100, v100, v101
    v_cndmask_b32_e64 v98, v100, v96, s[6:7]
    v_cndmask_b32_e64 v97, v96, v100, s[6:7]
    v_mfma_f32_32x32x16_bf16 a[64:79], a[160:163], v[104:107], 0
    ds_read_b64_tr_b16 a[156:157], v9 offset:29952
    ds_read_b64_tr_b16 a[158:159], v9 offset:30976
    buffer_load_dwordx4 a[240:243], v30, s[48:51], s19 offen
    v_add_f32_dpp v97, v98, v97 row_ror:4 row_mask:0xf bank_mask:0xf
    v_exp_f32 v227, v227
    v_mfma_f32_32x32x16_bf16 a[80:95], a[164:167], v[104:107], 0
    ds_read_b64_tr_b16 a[160:161], v7 offset:32000
    ds_read_b64_tr_b16 a[162:163], v7 offset:33024
    s_waitcnt lgkmcnt(10)
    v_add_f32_dpp v97, v97, v97 row_ror:8 row_mask:0xf bank_mask:0xf
    v_cmp_u_f32_e64 s[6:7], v97, v97
    v_mfma_f32_32x32x16_bf16 a[64:79], a[168:171], v[112:115], a[64:79]
    ds_read_b64_tr_b16 a[164:165], v9 offset:32000
    ds_read_b64_tr_b16 a[166:167], v9 offset:33024
    buffer_store_dwordx4 v[84:87], v30, s[48:51], s8 offen offset:1024 sc1
    s_add_u32 s8, s93, 16384
    v_exp_f32 v212, v212
    v_mfma_f32_32x32x16_bf16 a[80:95], a[172:175], v[112:115], a[80:95]
    ds_read_b64_tr_b16 a[168:169], v7 offset:34048
    ds_read_b64_tr_b16 a[170:171], v7 offset:35072
    s_waitcnt lgkmcnt(10)
    s_cmp_lg_u64 s[6:7], 0
    s_cbranch_scc1 L_slow_19
L_back_20:
    v_cvt_pk_bf16_f32 v97, v97, v97
    v_mfma_f32_32x32x16_bf16 a[64:79], a[144:147], v[108:111], a[64:79]
    ds_read_b64_tr_b16 a[172:173], v9 offset:34048
    ds_read_b64_tr_b16 a[174:175], v9 offset:35072
    buffer_load_dwordx4 a[244:247], v30, s[48:51], s19 offen offset:1024
    buffer_store_short v97, v93, s[48:51], s5 offen sc1
    s_add_u32 s19, s94, 10240
    v_mfma_f32_32x32x16_bf16 a[80:95], a[148:151], v[108:111], a[80:95]
    ds_read_b64_tr_b16 a[144:145], v7 offset:36096
    ds_read_b64_tr_b16 a[146:147], v7 offset:37120
    s_waitcnt lgkmcnt(10)
    s_lshl_b32 s4, s61, 12
    s_add_u32 s4, s4, 3145728
    v_mfma_f32_32x32x16_bf16 a[64:79], a[152:155], v[116:119], a[64:79]
    ds_read_b64_tr_b16 a[148:149], v9 offset:36096
    ds_read_b64_tr_b16 a[150:151], v9 offset:37120
    v_exp_f32 v228, v228
    v_exp_f32 v213, v213
    v_mfma_f32_32x32x16_bf16 a[80:95], a[156:159], v[116:119], a[80:95]
    ds_read_b64_tr_b16 a[152:153], v7 offset:38144
    ds_read_b64_tr_b16 a[154:155], v7 offset:39168
    s_waitcnt lgkmcnt(10)
    buffer_store_dwordx4 v[120:123], v30, s[48:51], s8 offen sc1
    v_exp_f32 v229, v229
    v_mfma_f32_32x32x16_bf16 a[64:79], a[160:163], v[136:139], a[64:79]
    ds_read_b64_tr_b16 a[156:157], v9 offset:38144
    ds_read_b64_tr_b16 a[158:159], v9 offset:39168
    v_exp_f32 v214, v214
    v_exp_f32 v230, v230
    v_mfma_f32_32x32x16_bf16 a[80:95], a[164:167], v[136:139], a[80:95]
    s_barrier
    ds_read_b64_tr_b16 a[160:161], v7 offset:40192
    ds_read_b64_tr_b16 a[162:163], v7 offset:41216
    s_waitcnt lgkmcnt(10)
    buffer_load_dwordx4 a[248:251], v30, s[48:51], s19 offen
    v_mfma_f32_32x32x16_bf16 a[64:79], a[168:171], v[144:147], a[64:79]
    ds_read_b64_tr_b16 a[164:165], v9 offset:40192
    ds_read_b64_tr_b16 a[166:167], v9 offset:41216
    v_exp_f32 v215, v215
    v_exp_f32 v231, v231
    v_mfma_f32_32x32x16_bf16 a[80:95], a[172:175], v[144:147], a[80:95]
    ds_read_b64_tr_b16 a[168:169], v7 offset:42240
    ds_read_b64_tr_b16 a[170:171], v7 offset:43264
    s_waitcnt lgkmcnt(10)
    buffer_store_dwordx4 v[124:127], v30, s[48:51], s8 offen offset:1024 sc1
    v_exp_f32 v236, v236
    v_mfma_f32_32x32x16_bf16 a[64:79], a[144:147], v[140:143], a[64:79]
    ds_read_b64_tr_b16 a[172:173], v9 offset:42240
    ds_read_b64_tr_b16 a[174:175], v9 offset:43264
    v_exp_f32 v234, v234
    v_exp_f32 v237, v237
    v_mfma_f32_32x32x16_bf16 a[80:95], a[148:151], v[140:143], a[80:95]
    ds_read_b64_tr_b16 a[144:145], v7 offset:44288
    ds_read_b64_tr_b16 a[146:147], v7 offset:45312
    s_waitcnt lgkmcnt(10)
    buffer_load_dwordx4 a[252:255], v30, s[48:51], s19 offen offset:1024
    v_exp_f32 v235, v235
    v_mfma_f32_32x32x16_bf16 a[64:79], a[152:155], v[148:151], a[64:79]
    ds_read_b64_tr_b16 a[148:149], v9 offset:44288
    ds_read_b64_tr_b16 a[150:151], v9 offset:45312
    v_add_f32 v239, v200, v201
    v_add_f32 v238, v216, v217
    v_add_f32 v239, v239, v202
    v_mfma_f32_32x32x16_bf16 a[80:95], a[156:159], v[148:151], a[80:95]
    ds_read_b64_tr_b16 a[152:153], v7 offset:46336
    ds_read_b64_tr_b16 a[154:155], v7 offset:47360
    s_waitcnt lgkmcnt(10)
    buffer_load_dwordx4 v11, s[36:39], s96 offen offset:1024 lds
    s_add_u32 m0, s84, 57600
    v_mfma_f32_32x32x16_bf16 a[96:111], a[160:163], v[104:107], 0
    ds_read_b64_tr_b16 a[156:157], v9 offset:46336
    ds_read_b64_tr_b16 a[158:159], v9 offset:47360
    v_add_f32 v238, v238, v218
    v_add_f32 v239, v239, v203
    v_add_f32 v238, v238, v219
    v_mfma_f32_32x32x16_bf16 a[112:127], a[164:167], v[104:107], 0
    ds_read_b64_tr_b16 a[160:161], v7 offset:48384
    ds_read_b64_tr_b16 a[162:163], v7 offset:49408
    s_waitcnt lgkmcnt(10)
    buffer_load_dwordx4 v12, s[36:39], s96 offen lds
    v_add_f32 v239, v239, v204
    v_mfma_f32_32x32x16_bf16 a[96:111], a[168:171], v[112:115], a[96:111]
    ds_read_b64_tr_b16 a[164:165], v9 offset:48384
    ds_read_b64_tr_b16 a[166:167], v9 offset:49408
    v_add_f32 v238, v238, v220
    v_add_f32 v239, v239, v205
    v_add_f32 v238, v238, v221
    v_mfma_f32_32x32x16_bf16 a[112:127], a[172:175], v[112:115], a[112:127]
    ds_read_b64_tr_b16 a[168:169], v7 offset:50432
    ds_read_b64_tr_b16 a[170:171], v7 offset:51456
    s_waitcnt lgkmcnt(10)
    buffer_load_dwordx4 v13, s[36:39], s96 offen offset:1024 lds
    s_add_u32 m0, s84, 71936
    v_mfma_f32_32x32x16_bf16 a[96:111], a[144:147], v[108:111], a[96:111]
    ds_read_b64_tr_b16 a[172:173], v9 offset:50432
    ds_read_b64_tr_b16 a[174:175], v9 offset:51456
    s_add_u32 s96, s64, s71
    v_add_f32 v239, v239, v206
    v_add_f32 v238, v238, v222
    v_mfma_f32_32x32x16_bf16 a[112:127], a[148:151], v[108:111], a[112:127]
    ds_read_b64_tr_b16 a[144:145], v7 offset:52480
    ds_read_b64_tr_b16 a[146:147], v7 offset:53504
    s_waitcnt lgkmcnt(10)
    buffer_load_dwordx4 v10, s[36:39], s96 offen lds
    v_add_f32 v239, v239, v207
    v_mfma_f32_32x32x16_bf16 a[96:111], a[152:155], v[116:119], a[96:111]
    ds_read_b64_tr_b16 a[148:149], v9 offset:52480
    ds_read_b64_tr_b16 a[150:151], v9 offset:53504
    v_add_f32 v238, v238, v223
    v_add_f32 v239, v239, v208
    v_add_f32 v238, v238, v224
    v_mfma_f32_32x32x16_bf16 a[112:127], a[156:159], v[116:119], a[112:127]
    ds_read_b64_tr_b16 a[152:153], v7 offset:54528
    ds_read_b64_tr_b16 a[154:155], v7 offset:55552
    s_waitcnt lgkmcnt(10)
    v_add_f32 v239, v239, v209
    v_add_f32 v238, v238, v225
    v_mfma_f32_32x32x16_bf16 a[96:111], a[160:163], v[136:139], a[96:111]
    ds_read_b64_tr_b16 a[156:157], v9 offset:54528
    ds_read_b64_tr_b16 a[158:159], v9 offset:55552
    buffer_load_dwordx4 v11, s[36:39], s96 offen offset:1024 lds
    s_add_u32 m0, s84, 73984
    v_add_f32 v239, v239, v210
    v_mfma_f32_32x32x16_bf16 a[112:127], a[164:167], v[136:139], a[112:127]
    s_waitcnt vmcnt(25)
    s_barrier
    ds_read_b64_tr_b16 a[160:161], v6 offset:6400
    ds_read_b64_tr_b16 a[162:163], v6 offset:7424
    s_waitcnt lgkmcnt(10)
    v_mfma_f32_32x32x16_bf16 a[96:111], a[168:171], v[144:147], a[96:111]
    ds_read_b64_tr_b16 a[164:165], v8 offset:6400
    ds_read_b64_tr_b16 a[166:167], v8 offset:7424
    buffer_load_dwordx4 v12, s[36:39], s96 offen lds
    v_add_f32 v238, v238, v226
    v_add_f32 v239, v239, v211
    v_mfma_f32_32x32x16_bf16 a[112:127], a[172:175], v[144:147], a[112:127]
    ds_read_b64_tr_b16 a[168:169], v6 offset:8448
    ds_read_b64_tr_b16 a[170:171], v6 offset:9472
    s_waitcnt lgkmcnt(10)
    v_add_f32 v238, v238, v227
    v_add_f32 v239, v239, v212
    v_mfma_f32_32x32x16_bf16 a[96:111], a[144:147], v[140:143], a[96:111]
    ds_read_b64_tr_b16 a[172:173], v8 offset:8448
    ds_read_b64_tr_b16 a[174:175], v8 offset:9472
    buffer_load_dwordx4 v13, s[36:39], s96 offen offset:1024 lds
    s_add_u32 m0, s84, 88320
    v_add_f32 v238, v238, v228
    v_mfma_f32_32x32x16_bf16 a[112:127], a[148:151], v[140:143], a[112:127]
    ds_read_b64_tr_b16 a[144:145], v6 offset:10496
    ds_read_b64_tr_b16 a[146:147], v6 offset:11520
    s_waitcnt lgkmcnt(10)
    s_add_u32 s96, s65, s71
    v_add_f32 v239, v239, v213
    v_mfma_f32_32x32x16_bf16 a[96:111], a[152:155], v[148:151], a[96:111]
    ds_read_b64_tr_b16 a[148:149], v8 offset:10496
    ds_read_b64_tr_b16 a[150:151], v8 offset:11520
    buffer_load_dwordx4 v10, s[36:39], s96 offen lds
    v_add_f32 v238, v238, v229
    v_add_f32 v239, v239, v214
    v_mfma_f32_32x32x16_bf16 a[112:127], a[156:159], v[148:151], a[112:127]
    ds_read_b64_tr_b16 a[152:153], v6 offset:12544
    ds_read_b64_tr_b16 a[154:155], v6 offset:13568
    s_waitcnt lgkmcnt(10)
    v_add_f32 v238, v238, v230
    v_add_f32 v239, v239, v215
    v_mfma_f32_32x32x16_bf16 a[0:15], a[160:163], v[56:59], a[0:15]
    ds_read_b64_tr_b16 a[156:157], v8 offset:12544
    ds_read_b64_tr_b16 a[158:159], v8 offset:13568
    buffer_load_dwordx4 v11, s[36:39], s96 offen offset:1024 lds
    s_add_u32 m0, s84, 90368
    v_add_f32 v238, v238, v231
    v_mfma_f32_32x32x16_bf16 a[16:31], a[164:167], v[56:59], a[16:31]
    ds_read_b64_tr_b16 a[160:161], v6 offset:14592
    ds_read_b64_tr_b16 a[162:163], v6 offset:15616
    s_waitcnt lgkmcnt(10)
    v_add_f32 v239, v239, v236
    v_add_f32 v238, v238, v234
    v_mfma_f32_32x32x16_bf16 a[0:15], a[168:171], v[64:67], a[0:15]
    ds_read_b64_tr_b16 a[164:165], v8 offset:14592
    ds_read_b64_tr_b16 a[166:167], v8 offset:15616
    buffer_load_dwordx4 v12, s[36:39], s96 offen lds
    v_add_f32 v239, v239, v237
    v_add_f32 v238, v238, v235
    v_mfma_f32_32x32x16_bf16 a[16:31], a[172:175], v[64:67], a[16:31]
    ds_read_b64_tr_b16 a[168:169], v6 offset:16640
    ds_read_b64_tr_b16 a[170:171], v6 offset:17664
    s_waitcnt lgkmcnt(10)
    v_rcp_f32 v239, v239
    v_mfma_f32_32x32x16_bf16 a[0:15], a[144:147], v[60:63], a[0:15]
    ds_read_b64_tr_b16 a[172:173], v8 offset:16640
    ds_read_b64_tr_b16 a[174:175], v8 offset:17664
    buffer_load_dwordx4 v13, s[36:39], s96 offen offset:1024 lds
    v_rcp_f32 v238, v238
    v_mfma_f32_32x32x16_bf16 a[16:31], a[148:151], v[60:63], a[16:31]
    ds_read_b64_tr_b16 a[144:145], v6 offset:18688
    ds_read_b64_tr_b16 a[146:147], v6 offset:19712
    s_waitcnt lgkmcnt(10)
    v_mul_f32 v200, v200, v239
    v_mul_f32 v201, v201, v239
    v_mfma_f32_32x32x16_bf16 a[0:15], a[152:155], v[68:71], a[0:15]
    ds_read_b64_tr_b16 a[148:149], v8 offset:18688
    ds_read_b64_tr_b16 a[150:151], v8 offset:19712
    v_mul_f32 v202, v202, v239
    v_mul_f32 v203, v203, v239
    v_mul_f32 v204, v204, v239
    v_mfma_f32_32x32x16_bf16 a[16:31], a[156:159], v[68:71], a[16:31]
    ds_read_b64_tr_b16 a[152:153], v6 offset:20736
    ds_read_b64_tr_b16 a[154:155], v6 offset:21760
    s_waitcnt lgkmcnt(10)
    v_mul_f32 v205, v205, v239
    v_mul_f32 v206, v206, v239
    v_mfma_f32_32x32x16_bf16 a[0:15], a[160:163], v[72:75], a[0:15]
    ds_read_b64_tr_b16 a[156:157], v8 offset:20736
    ds_read_b64_tr_b16 a[158:159], v8 offset:21760
    v_mul_f32 v207, v207, v239
    v_mul_f32 v208, v208, v239
    v_mul_f32 v209, v209, v239
    v_mfma_f32_32x32x16_bf16 a[16:31], a[164:167], v[72:75], a[16:31]
    s_waitcnt vmcnt(27)
    s_barrier
    ds_read_b64_tr_b16 a[160:161], v6 offset:22784
    ds_read_b64_tr_b16 a[162:163], v6 offset:23808
    s_waitcnt lgkmcnt(10)
    s_add_u32 m0, s84, 104704
    s_add_u32 s96, s66, s71
    v_mfma_f32_32x32x16_bf16 a[0:15], a[168:171], v[80:83], a[0:15]
    ds_read_b64_tr_b16 a[164:165], v8 offset:22784
    ds_read_b64_tr_b16 a[166:167], v8 offset:23808
    buffer_load_dwordx4 v10, s[36:39], s96 offen lds
    s_waitcnt vmcnt(13)
    v_mul_f32 v210, v210, v239
    v_mfma_f32_32x32x16_bf16 a[16:31], a[172:175], v[80:83], a[16:31]
    ds_read_b64_tr_b16 a[168:169], v6 offset:24832
    ds_read_b64_tr_b16 a[170:171], v6 offset:25856
    s_waitcnt lgkmcnt(10)
    v_mul_f32 v211, v211, v239
    v_mul_f32 v212, v212, v239
    v_mfma_f32_32x32x16_bf16 a[0:15], a[144:147], v[76:79], a[0:15]
    ds_read_b64_tr_b16 a[172:173], v8 offset:24832
    ds_read_b64_tr_b16 a[174:175], v8 offset:25856
    buffer_load_dwordx4 v11, s[36:39], s96 offen offset:1024 lds
    s_add_u32 m0, s84, 106752
    v_mul_f32 v213, v213, v239
    v_mfma_f32_32x32x16_bf16 a[16:31], a[148:151], v[76:79], a[16:31]
    ds_read_b64_tr_b16 a[144:145], v6 offset:26880
    ds_read_b64_tr_b16 a[146:147], v6 offset:27904
    s_waitcnt lgkmcnt(10)
    v_mul_f32 v214, v214, v239
    v_mul_f32 v215, v215, v239
    v_mfma_f32_32x32x16_bf16 a[0:15], a[152:155], v[84:87], a[0:15]
    ds_read_b64_tr_b16 a[148:149], v8 offset:26880
    ds_read_b64_tr_b16 a[150:151], v8 offset:27904
    buffer_load_dwordx4 v12, s[36:39], s96 offen lds
    v_mul_f32 v236, v236, v239
    v_mul_f32 v237, v237, v239
    v_mfma_f32_32x32x16_bf16 a[16:31], a[156:159], v[84:87], a[16:31]
    ds_read_b64_tr_b16 a[152:153], v6 offset:28928
    ds_read_b64_tr_b16 a[154:155], v6 offset:29952
    s_waitcnt lgkmcnt(10)
    v_mul_f32 v216, v216, v238
    v_mul_f32 v217, v217, v238
    v_mfma_f32_32x32x16_bf16 a[32:47], a[160:163], v[56:59], a[32:47]
    ds_read_b64_tr_b16 a[156:157], v8 offset:28928
    ds_read_b64_tr_b16 a[158:159], v8 offset:29952
    buffer_load_dwordx4 v13, s[36:39], s96 offen offset:1024 lds
    v_mul_f32 v218, v218, v238
    v_mul_f32 v219, v219, v238
    v_mfma_f32_32x32x16_bf16 a[48:63], a[164:167], v[56:59], a[48:63]
    ds_read_b64_tr_b16 a[160:161], v6 offset:30976
    ds_read_b64_tr_b16 a[162:163], v6 offset:32000
    s_waitcnt lgkmcnt(10)
    v_mul_f32 v220, v220, v238
    v_mul_f32 v221, v221, v238
    v_mfma_f32_32x32x16_bf16 a[32:47], a[168:171], v[64:67], a[32:47]
    ds_read_b64_tr_b16 a[164:165], v8 offset:30976
    ds_read_b64_tr_b16 a[166:167], v8 offset:32000
    buffer_load_dwordx4 v[184:187], v94, s[48:51], s4 offen sc1
    v_mul_f32 v222, v222, v238
    v_mul_f32 v223, v223, v238
    v_mfma_f32_32x32x16_bf16 a[48:63], a[172:175], v[64:67], a[48:63]
    ds_read_b64_tr_b16 a[168:169], v6 offset:33024
    ds_read_b64_tr_b16 a[170:171], v6 offset:34048
    s_waitcnt lgkmcnt(10)
    v_mul_f32 v224, v224, v238
    v_mul_f32 v225, v225, v238
    v_mfma_f32_32x32x16_bf16 a[32:47], a[144:147], v[60:63], a[32:47]
    ds_read_b64_tr_b16 a[172:173], v8 offset:33024
    ds_read_b64_tr_b16 a[174:175], v8 offset:34048
    s_mov_b64 exec, 1
    buffer_store_dword v254, v255, s[48:51], s95 offen offset:12 sc1
    s_mov_b64 exec, -1
    v_mfma_f32_32x32x16_bf16 a[48:63], a[148:151], v[60:63], a[48:63]
    ds_read_b64_tr_b16 a[144:145], v6 offset:35072
    ds_read_b64_tr_b16 a[146:147], v6 offset:36096
    s_waitcnt lgkmcnt(10)
    v_mul_f32 v226, v226, v238
    v_mul_f32 v227, v227, v238
    v_mfma_f32_32x32x16_bf16 a[32:47], a[152:155], v[68:71], a[32:47]
    ds_read_b64_tr_b16 a[148:149], v8 offset:35072
    ds_read_b64_tr_b16 a[150:151], v8 offset:36096
    v_mul_f32 v228, v228, v238
    v_mul_f32 v229, v229, v238
    v_mul_f32 v230, v230, v238
    v_mfma_f32_32x32x16_bf16 a[48:63], a[156:159], v[68:71], a[48:63]
    ds_read_b64_tr_b16 a[152:153], v6 offset:37120
    ds_read_b64_tr_b16 a[154:155], v6 offset:38144
    s_waitcnt lgkmcnt(10)
    v_mul_f32 v231, v231, v238
    v_mul_f32 v234, v234, v238
    v_mfma_f32_32x32x16_bf16 a[32:47], a[160:163], v[72:75], a[32:47]
    ds_read_b64_tr_b16 a[156:157], v8 offset:37120
    ds_read_b64_tr_b16 a[158:159], v8 offset:38144
    v_mul_f32 v235, v235, v238
    v_cvt_pk_bf16_f32 v216, v216, v217
    v_cvt_pk_bf16_f32 v217, v218, v219
    v_mfma_f32_32x32x16_bf16 a[48:63], a[164:167], v[72:75], a[48:63]
    s_barrier
    ds_read_b64_tr_b16 a[160:161], v6 offset:39168
    ds_read_b64_tr_b16 a[162:163], v6 offset:40192
    s_waitcnt lgkmcnt(10)
    s_add_u32 m0, s84, 6400
    s_add_u32 s96, s67, s71
    v_mfma_f32_32x32x16_bf16 a[32:47], a[168:171], v[80:83], a[32:47]
    ds_read_b64_tr_b16 a[164:165], v8 offset:39168
    ds_read_b64_tr_b16 a[166:167], v8 offset:40192
    buffer_load_dwordx4 v10, s[36:39], s96 offen lds
    v_cvt_pk_bf16_f32 v218, v220, v221
    v_mfma_f32_32x32x16_bf16 a[48:63], a[172:175], v[80:83], a[48:63]
    ds_read_b64_tr_b16 a[168:169], v6 offset:41216
    ds_read_b64_tr_b16 a[170:171], v6 offset:42240
    s_waitcnt lgkmcnt(10)
    v_cvt_pk_bf16_f32 v219, v222, v223
    v_cvt_pk_bf16_f32 v220, v224, v225
    v_mfma_f32_32x32x16_bf16 a[32:47], a[144:147], v[76:79], a[32:47]
    ds_read_b64_tr_b16 a[172:173], v8 offset:41216
    ds_read_b64_tr_b16 a[174:175], v8 offset:42240
    buffer_load_dwordx4 v11, s[36:39], s96 offen offset:1024 lds
    s_add_u32 m0, s84, 8448
    v_mfma_f32_32x32x16_bf16 a[48:63], a[148:151], v[76:79], a[48:63]
    ds_read_b64_tr_b16 a[144:145], v6 offset:43264
    ds_read_b64_tr_b16 a[146:147], v6 offset:44288
    s_waitcnt lgkmcnt(10)
    v_cvt_pk_bf16_f32 v221, v226, v227
    v_cvt_pk_bf16_f32 v222, v228, v229
    v_mfma_f32_32x32x16_bf16 a[32:47], a[152:155], v[84:87], a[32:47]
    ds_read_b64_tr_b16 a[148:149], v8 offset:43264
    ds_read_b64_tr_b16 a[150:151], v8 offset:44288
    buffer_load_dwordx4 v12, s[36:39], s96 offen lds
    v_cvt_pk_bf16_f32 v223, v230, v231
    v_mfma_f32_32x32x16_bf16 a[48:63], a[156:159], v[84:87], a[48:63]
    ds_read_b64_tr_b16 a[152:153], v6 offset:45312
    ds_read_b64_tr_b16 a[154:155], v6 offset:46336
    s_waitcnt lgkmcnt(10)
    v_cvt_pk_bf16_f32 v224, v234, v235
    v_cvt_pk_bf16_f32 v225, v200, v201
    v_mfma_f32_32x32x16_bf16 a[64:79], a[160:163], v[56:59], a[64:79]
    ds_read_b64_tr_b16 a[156:157], v8 offset:45312
    ds_read_b64_tr_b16 a[158:159], v8 offset:46336
    buffer_load_dwordx4 v13, s[36:39], s96 offen offset:1024 lds
    v_cvt_pk_bf16_f32 v226, v202, v203
    v_mfma_f32_32x32x16_bf16 a[80:95], a[164:167], v[56:59], a[80:95]
    ds_read_b64_tr_b16 a[160:161], v6 offset:47360
    ds_read_b64_tr_b16 a[162:163], v6 offset:48384
    s_waitcnt lgkmcnt(10)
    v_cvt_pk_bf16_f32 v227, v204, v205
    v_cvt_pk_bf16_f32 v228, v206, v207
    v_mfma_f32_32x32x16_bf16 a[64:79], a[168:171], v[64:67], a[64:79]
    ds_read_b64_tr_b16 a[164:165], v8 offset:47360
    ds_read_b64_tr_b16 a[166:167], v8 offset:48384
    v_cvt_pk_bf16_f32 v229, v208, v209
    v_cvt_pk_bf16_f32 v230, v210, v211
    v_mfma_f32_32x32x16_bf16 a[80:95], a[172:175], v[64:67], a[80:95]
    ds_read_b64_tr_b16 a[168:169], v6 offset:49408
    ds_read_b64_tr_b16 a[170:171], v6 offset:50432
    s_waitcnt lgkmcnt(10)
    v_cvt_pk_bf16_f32 v231, v212, v213
    v_cvt_pk_bf16_f32 v232, v214, v215
    v_mfma_f32_32x32x16_bf16 a[64:79], a[144:147], v[60:63], a[64:79]
    ds_read_b64_tr_b16 a[172:173], v8 offset:49408
    ds_read_b64_tr_b16 a[174:175], v8 offset:50432
    v_cvt_pk_bf16_f32 v233, v236, v237
    v_mov_b32 v234, 0
    v_mov_b32 v235, 0
    v_mfma_f32_32x32x16_bf16 a[80:95], a[148:151], v[60:63], a[80:95]
    ds_read_b64_tr_b16 a[144:145], v6 offset:51456
    ds_read_b64_tr_b16 a[146:147], v6 offset:52480
    s_waitcnt lgkmcnt(10)
    v_mfma_f32_32x32x16_bf16 a[64:79], a[152:155], v[68:71], a[64:79]
    ds_read_b64_tr_b16 a[148:149], v8 offset:51456
    ds_read_b64_tr_b16 a[150:151], v8 offset:52480
    v_mfma_f32_32x32x16_bf16 a[80:95], a[156:159], v[68:71], a[80:95]
    ds_read_b64_tr_b16 a[152:153], v6 offset:53504
    ds_read_b64_tr_b16 a[154:155], v6 offset:54528
    s_waitcnt lgkmcnt(10)
    v_mfma_f32_32x32x16_bf16 a[64:79], a[160:163], v[72:75], a[64:79]
    ds_read_b64_tr_b16 a[156:157], v8 offset:53504
    ds_read_b64_tr_b16 a[158:159], v8 offset:54528
    v_mfma_f32_32x32x16_bf16 a[80:95], a[164:167], v[72:75], a[80:95]
    s_waitcnt vmcnt(18)
    s_barrier
    ds_read_b64_tr_b16 a[160:161], v6 offset:55552
    ds_read_b64_tr_b16 a[162:163], v6 offset:56576
    s_waitcnt lgkmcnt(10)
    s_add_u32 m0, s84, 22784
    s_add_u32 s96, s64, s72
    v_mfma_f32_32x32x16_bf16 a[64:79], a[168:171], v[80:83], a[64:79]
    ds_read_b64_tr_b16 a[164:165], v8 offset:55552
    ds_read_b64_tr_b16 a[166:167], v8 offset:56576
    buffer_load_dwordx4 v10, s[36:39], s96 offen lds
    v_mfma_f32_32x32x16_bf16 a[80:95], a[172:175], v[80:83], a[80:95]
    ds_read_b64_tr_b16 a[168:169], v6 offset:57600
    ds_read_b64_tr_b16 a[170:171], v6 offset:58624
    s_waitcnt lgkmcnt(10)
    v_mfma_f32_32x32x16_bf16 a[64:79], a[144:147], v[76:79], a[64:79]
    ds_read_b64_tr_b16 a[172:173], v8 offset:57600
    ds_read_b64_tr_b16 a[174:175], v8 offset:58624
    buffer_load_dwordx4 v11, s[36:39], s96 offen offset:1024 lds
    s_add_u32 m0, s84, 24832
    v_mfma_f32_32x32x16_bf16 a[80:95], a[148:151], v[76:79], a[80:95]
    ds_read_b64_tr_b16 a[144:145], v6 offset:59648
    ds_read_b64_tr_b16 a[146:147], v6 offset:60672
    s_waitcnt lgkmcnt(10)
    v_mfma_f32_32x32x16_bf16 a[64:79], a[152:155], v[84:87], a[64:79]
    ds_read_b64_tr_b16 a[148:149], v8 offset:59648
    ds_read_b64_tr_b16 a[150:151], v8 offset:60672
    buffer_load_dwordx4 v12, s[36:39], s96 offen lds
    v_mfma_f32_32x32x16_bf16 a[80:95], a[156:159], v[84:87], a[80:95]
    ds_read_b64_tr_b16 a[152:153], v6 offset:61696
    ds_read_b64_tr_b16 a[154:155], v6 offset:62720
    s_waitcnt lgkmcnt(10)
    v_mfma_f32_32x32x16_bf16 a[96:111], a[160:163], v[56:59], a[96:111]
    ds_read_b64_tr_b16 a[156:157], v8 offset:61696
    ds_read_b64_tr_b16 a[158:159], v8 offset:62720
    buffer_load_dwordx4 v13, s[36:39], s96 offen offset:1024 lds
    v_mfma_f32_32x32x16_bf16 a[112:127], a[164:167], v[56:59], a[112:127]
    ds_read_b64_tr_b16 a[160:161], v6 offset:63744
    ds_read_b64_tr_b16 a[162:163], v6 offset:64768
    s_waitcnt lgkmcnt(10)
    v_mfma_f32_32x32x16_bf16 a[96:111], a[168:171], v[64:67], a[96:111]
    ds_read_b64_tr_b16 a[164:165], v8 offset:63744
    ds_read_b64_tr_b16 a[166:167], v8 offset:64768
    v_mfma_f32_32x32x16_bf16 a[112:127], a[172:175], v[64:67], a[112:127]
    ds_read_b64_tr_b16 a[168:169], v7 offset:1280
    ds_read_b64_tr_b16 a[170:171], v7 offset:2304
    s_waitcnt lgkmcnt(10)
    v_mfma_f32_32x32x16_bf16 a[96:111], a[144:147], v[60:63], a[96:111]
    ds_read_b64_tr_b16 a[172:173], v9 offset:1280
    ds_read_b64_tr_b16 a[174:175], v9 offset:2304
    v_mfma_f32_32x32x16_bf16 a[112:127], a[148:151], v[60:63], a[112:127]
    ds_read_b64_tr_b16 a[144:145], v7 offset:3328
    ds_read_b64_tr_b16 a[146:147], v7 offset:4352
    s_waitcnt lgkmcnt(10)
    v_mfma_f32_32x32x16_bf16 a[96:111], a[152:155], v[68:71], a[96:111]
    ds_read_b64_tr_b16 a[148:149], v9 offset:3328
    ds_read_b64_tr_b16 a[150:151], v9 offset:4352
    s_waitcnt vmcnt(9)
    v_pk_max_u16 v100, v184, v185
    v_pk_max_u16 v101, v186, v187
    v_pk_max_u16 v100, v100, v101
    v_mfma_f32_32x32x16_bf16 a[112:127], a[156:159], v[68:71], a[112:127]
    ds_read_b64_tr_b16 a[152:153], v7 offset:5376
    ds_read_b64_tr_b16 a[154:155], v7 offset:6400
    s_waitcnt lgkmcnt(10)
    v_lshlrev_b32 v101, 16, v100
    v_max_u32 v100, v100, v101
    v_cmp_le_u32_e64 s[6:7], s85, v100
    v_mfma_f32_32x32x16_bf16 a[96:111], a[160:163], v[72:75], a[96:111]
    ds_read_b64_tr_b16 a[156:157], v9 offset:5376
    ds_read_b64_tr_b16 a[158:159], v9 offset:6400
    s_cmp_lg_u64 s[6:7], 0
    s_cbranch_scc1 L_slow_21
L_back_22:
    v_mfma_f32_32x32x16_bf16 a[112:127], a[164:167], v[72:75], a[112:127]
    s_barrier
    ds_read_b64_tr_b16 a[160:161], v7 offset:7424
    ds_read_b64_tr_b16 a[162:163], v7 offset:8448
    s_waitcnt lgkmcnt(10)
    s_add_u32 m0, s83, 39168
    s_add_u32 s96, s64, s99
    v_mfma_f32_32x32x16_bf16 a[96:111], a[168:171], v[80:83], a[96:111]
    ds_read_b64_tr_b16 a[164:165], v9 offset:7424
    ds_read_b64_tr_b16 a[166:167], v9 offset:8448
    buffer_load_dwordx4 v10, s[36:39], s96 offen lds
    ds_write_b128 v94, v[184:187] offset:1600
    v_mfma_f32_32x32x16_bf16 a[112:127], a[172:175], v[80:83], a[112:127]
    ds_read_b64_tr_b16 a[168:169], v7 offset:9472
    ds_read_b64_tr_b16 a[170:171], v7 offset:10496
    s_waitcnt lgkmcnt(11)
    v_mfma_f32_32x32x16_bf16 a[96:111], a[144:147], v[76:79], a[96:111]
    ds_read_b64_tr_b16 a[172:173], v9 offset:9472
    ds_read_b64_tr_b16 a[174:175], v9 offset:10496
    buffer_load_dwordx4 v11, s[36:39], s96 offen offset:1024 lds
    s_add_u32 m0, s83, 47360
    v_mfma_f32_32x32x16_bf16 a[112:127], a[148:151], v[76:79], a[112:127]
    ds_read_b64_tr_b16 a[144:145], v7 offset:11520
    ds_read_b64_tr_b16 a[146:147], v7 offset:12544
    s_waitcnt lgkmcnt(11)
    s_waitcnt lgkmcnt(6)
    s_barrier
    v_mfma_f32_32x32x16_bf16 a[96:111], a[152:155], v[84:87], a[96:111]
    ds_read_b64_tr_b16 a[148:149], v9 offset:11520
    ds_read_b64_tr_b16 a[150:151], v9 offset:12544
    buffer_load_dwordx4 v14, s[40:43], s64 offen lds
    ds_read_b64_tr_b16 v[88:89], v24
    ds_read_b64_tr_b16 v[90:91], v24 offset:160
    v_mfma_f32_32x32x16_bf16 a[112:127], a[156:159], v[84:87], a[112:127]
    ds_read_b64_tr_b16 a[152:153], v7 offset:13568
    ds_read_b64_tr_b16 a[154:155], v7 offset:14592
    ds_read_b64_tr_b16 v[92:93], v25
    ds_read_b64_tr_b16 v[94:95], v25 offset:160
    v_mfma_f32_32x32x16_bf16 a[0:15], a[160:163], a[216:219], a[0:15]
    ds_read_b64_tr_b16 a[156:157], v9 offset:13568
    ds_read_b64_tr_b16 a[158:159], v9 offset:14592
    buffer_load_dwordx4 v15, s[40:43], s64 offen offset:1024 lds
    ds_read_b64_tr_b16 v[96:97], v24 offset:320
    ds_read_b64_tr_b16 v[98:99], v24 offset:480
    v_mfma_f32_32x32x16_bf16 a[16:31], a[164:167], a[216:219], a[16:31]
    ds_read_b64_tr_b16 a[160:161], v7 offset:15616
    ds_read_b64_tr_b16 a[162:163], v7 offset:16640
    s_waitcnt lgkmcnt(15)
    buffer_load_dword v252, v255, s[48:51], s101 offen offset:12 sc1
    ds_read_b64_tr_b16 v[100:101], v25 offset:320
    v_mfma_f32_32x32x16_bf16 a[0:15], a[168:171], a[208:211], a[0:15]
    ds_read_b64_tr_b16 a[164:165], v9 offset:15616
    ds_read_b64_tr_b16 a[166:167], v9 offset:16640
    ds_read_b64_tr_b16 v[102:103], v25 offset:480
    ds_read_b64_tr_b16 v[168:169], v24 offset:640
    v_mfma_f32_32x32x16_bf16 a[16:31], a[172:175], a[208:211], a[16:31]
    ds_read_b64_tr_b16 a[168:169], v7 offset:17664
    ds_read_b64_tr_b16 a[170:171], v7 offset:18688
    s_waitcnt lgkmcnt(15)
    ds_read_b64_tr_b16 v[170:171], v24 offset:800
    ds_read_b64_tr_b16 v[172:173], v25 offset:640
    v_mfma_f32_32x32x16_bf16 a[0:15], a[144:147], a[220:223], a[0:15]
    ds_read_b64_tr_b16 a[172:173], v9 offset:17664
    ds_read_b64_tr_b16 a[174:175], v9 offset:18688
    ds_read_b64_tr_b16 v[174:175], v25 offset:800
    ds_read_b64_tr_b16 v[176:177], v24 offset:960
    v_mfma_f32_32x32x16_bf16 a[16:31], a[148:151], a[220:223], a[16:31]
    ds_read_b64_tr_b16 a[144:145], v7 offset:19712
    ds_read_b64_tr_b16 a[146:147], v7 offset:20736
    s_waitcnt lgkmcnt(15)
    ds_read_b64_tr_b16 v[178:179], v24 offset:1120
    ds_read_b64_tr_b16 v[180:181], v25 offset:960
    v_mfma_f32_32x32x16_bf16 a[0:15], a[152:155], a[212:215], a[0:15]
    ds_read_b64_tr_b16 a[148:149], v9 offset:19712
    ds_read_b64_tr_b16 a[150:151], v9 offset:20736
    ds_read_b64_tr_b16 v[182:183], v25 offset:1120
    ds_read_b64_tr_b16 v[128:129], v24 offset:1280
    v_mfma_f32_32x32x16_bf16 a[16:31], a[156:159], a[212:215], a[16:31]
    ds_read_b64_tr_b16 a[152:153], v7 offset:21760
    ds_read_b64_tr_b16 a[154:155], v7 offset:22784
    s_waitcnt lgkmcnt(15)
    ds_read_b64_tr_b16 v[130:131], v24 offset:1440
    ds_read_b64_tr_b16 v[132:133], v25 offset:1280
    v_mfma_f32_32x32x16_bf16 a[0:15], a[160:163], a[232:235], a[0:15]
    ds_read_b64_tr_b16 a[156:157], v9 offset:21760
    ds_read_b64_tr_b16 a[158:159], v9 offset:22784
    ds_read_b64_tr_b16 v[134:135], v25 offset:1440
    v_mfma_f32_32x32x16_bf16 a[16:31], a[164:167], a[232:235], a[16:31]
    s_barrier
    ds_read_b64_tr_b16 a[160:161], v7 offset:23808
    ds_read_b64_tr_b16 a[162:163], v7 offset:24832
    s_waitcnt lgkmcnt(15)
    s_add_u32 m0, s84, 55552
    s_add_u32 s96, s65, s72
    v_mfma_f32_32x32x16_bf16 v[200:215], v[92:95], v[216:219], 0
    buffer_load_dwordx4 v10, s[36:39], s96 offen lds
    v_mfma_f32_32x32x16_bf16 v[184:199], v[88:91], v[216:219], 0
    v_mfma_f32_32x32x16_bf16 v[200:215], v[100:103], v[220:223], v[200:215]
    buffer_load_dwordx4 v11, s[36:39], s96 offen offset:1024 lds
    s_add_u32 m0, s84, 57600
    v_mfma_f32_32x32x16_bf16 v[184:199], v[96:99], v[220:223], v[184:199]
    v_mfma_f32_32x32x16_bf16 v[200:215], v[172:175], v[224:227], v[200:215]
    buffer_load_dwordx4 v12, s[36:39], s96 offen lds
    v_mfma_f32_32x32x16_bf16 v[184:199], v[168:171], v[224:227], v[184:199]
    s_waitcnt lgkmcnt(10)
    v_mfma_f32_32x32x16_bf16 v[200:215], v[180:183], v[228:231], v[200:215]
    buffer_load_dwordx4 v13, s[36:39], s96 offen offset:1024 lds
    v_mfma_f32_32x32x16_bf16 v[184:199], v[176:179], v[228:231], v[184:199]
    s_waitcnt lgkmcnt(2)
    v_mfma_f32_32x32x16_bf16 v[200:215], v[132:135], v[232:235], v[200:215]
    v_mfma_f32_32x32x16_bf16 v[184:199], v[128:131], v[232:235], v[184:199]
    v_mfma_f32_32x32x16_bf16 a[0:15], a[168:171], a[224:227], a[0:15]
    ds_read_b64_tr_b16 a[164:165], v9 offset:23808
    ds_read_b64_tr_b16 a[166:167], v9 offset:24832
    v_mfma_f32_32x32x16_bf16 a[16:31], a[172:175], a[224:227], a[16:31]
    ds_read_b64_tr_b16 a[168:169], v7 offset:25856
    ds_read_b64_tr_b16 a[170:171], v7 offset:26880
    v_mfma_f32_32x32x16_bf16 a[0:15], a[144:147], a[236:239], a[0:15]
    ds_read_b64_tr_b16 a[172:173], v9 offset:25856
    ds_read_b64_tr_b16 a[174:175], v9 offset:26880
    v_mfma_f32_32x32x16_bf16 a[16:31], a[148:151], a[236:239], a[16:31]
    ds_read_b64_tr_b16 a[144:145], v7 offset:27904
    ds_read_b64_tr_b16 a[146:147], v7 offset:28928
    v_cvt_pk_bf16_f32 v204, 0, v202
    v_add_f32 v204, 0x358637bd, v204
    v_cvt_pk_bf16_f32 v204, 0, v204
    v_mfma_f32_32x32x16_bf16 a[0:15], a[152:155], a[228:231], a[0:15]
    ds_read_b64_tr_b16 a[148:149], v9 offset:27904
    ds_read_b64_tr_b16 a[150:151], v9 offset:28928
    v_rcp_f32 v205, v204
    v_mov_b32 v50, 0
    v_fma_f32 v204, -v204, v205, 1.0
    v_mfma_f32_32x32x16_bf16 a[16:31], a[156:159], a[228:231], a[16:31]
    ds_read_b64_tr_b16 a[152:153], v7 offset:29952
    ds_read_b64_tr_b16 a[154:155], v7 offset:30976
    s_waitcnt lgkmcnt(10)
    v_fma_f32 v205, v204, v205, v205
    v_mov_b32 v51, 0
    v_cvt_pk_bf16_f32 v200, 0, v200
    v_mfma_f32_32x32x16_bf16 a[32:47], a[160:163], a[216:219], a[32:47]
    ds_read_b64_tr_b16 a[156:157], v9 offset:29952
    ds_read_b64_tr_b16 a[158:159], v9 offset:30976
    v_cvt_pk_bf16_f32 v201, 0, v201
    v_mul_f32 v200, v200, v205
    v_mul_f32 v201, v201, v205
    v_cvt_pk_bf16_f32 v48, v200, v201
    v_mfma_f32_32x32x16_bf16 a[48:63], a[164:167], a[216:219], a[48:63]
    ds_read_b64_tr_b16 a[160:161], v7 offset:32000
    ds_read_b64_tr_b16 a[162:163], v7 offset:33024
    s_waitcnt lgkmcnt(10)
    v_cvt_pk_bf16_f32 v184, 0, v184
    v_cvt_pk_bf16_f32 v185, 0, v185
    v_mul_f32 v184, v184, v205
    v_mfma_f32_32x32x16_bf16 a[32:47], a[168:171], a[208:211], a[32:47]
    ds_read_b64_tr_b16 a[164:165], v9 offset:32000
    ds_read_b64_tr_b16 a[166:167], v9 offset:33024
    v_mul_f32 v185, v185, v205
    v_cvt_pk_bf16_f32 v40, v184, v185
    v_cvt_pk_bf16_f32 v186, 0, v186
    v_cvt_pk_bf16_f32 v187, 0, v187
    v_mfma_f32_32x32x16_bf16 a[48:63], a[172:175], a[208:211], a[48:63]
    ds_read_b64_tr_b16 a[168:169], v7 offset:34048
    ds_read_b64_tr_b16 a[170:171], v7 offset:35072
    s_waitcnt lgkmcnt(10)
    s_waitcnt vmcnt(4)
    v_cmp_ne_u32_e64 s[22:23], 1, v252
    v_mul_f32 v186, v186, v205
    v_mfma_f32_32x32x16_bf16 a[32:47], a[144:147], a[220:223], a[32:47]
    ds_read_b64_tr_b16 a[172:173], v9 offset:34048
    ds_read_b64_tr_b16 a[174:175], v9 offset:35072
    s_cmp_lg_u64 s[22:23], 0
    s_cbranch_scc1 L_slow_24
L_back_25:
    s_add_u32 s3, s94, 12288
    v_mul_f32 v187, v187, v205
    v_mfma_f32_32x32x16_bf16 a[48:63], a[148:151], a[220:223], a[48:63]
    ds_read_b64_tr_b16 a[144:145], v7 offset:36096
    ds_read_b64_tr_b16 a[146:147], v7 offset:37120
    s_waitcnt lgkmcnt(10)
    buffer_load_dwordx4 a[176:179], v30, s[48:51], s3 offen
    v_cvt_pk_bf16_f32 v41, v186, v187
    v_cvt_pk_bf16_f32 v188, 0, v188
    v_mfma_f32_32x32x16_bf16 a[32:47], a[152:155], a[212:215], a[32:47]
    ds_read_b64_tr_b16 a[148:149], v9 offset:36096
    ds_read_b64_tr_b16 a[150:151], v9 offset:37120
    v_cvt_pk_bf16_f32 v189, 0, v189
    v_mul_f32 v188, v188, v205
    v_mul_f32 v189, v189, v205
    v_cvt_pk_bf16_f32 v42, v188, v189
    v_mfma_f32_32x32x16_bf16 a[48:63], a[156:159], a[212:215], a[48:63]
    ds_read_b64_tr_b16 a[152:153], v7 offset:38144
    ds_read_b64_tr_b16 a[154:155], v7 offset:39168
    s_waitcnt lgkmcnt(10)
    buffer_load_dwordx4 a[180:183], v30, s[48:51], s3 offen offset:1024
    s_add_u32 s3, s94, 14336
    v_cvt_pk_bf16_f32 v190, 0, v190
    v_mfma_f32_32x32x16_bf16 a[32:47], a[160:163], a[232:235], a[32:47]
    ds_read_b64_tr_b16 a[156:157], v9 offset:38144
    ds_read_b64_tr_b16 a[158:159], v9 offset:39168
    v_cvt_pk_bf16_f32 v191, 0, v191
    v_mul_f32 v190, v190, v205
    v_mul_f32 v191, v191, v205
    v_cvt_pk_bf16_f32 v43, v190, v191
    v_mfma_f32_32x32x16_bf16 a[48:63], a[164:167], a[232:235], a[48:63]
    s_barrier
    ds_read_b64_tr_b16 a[160:161], v7 offset:40192
    ds_read_b64_tr_b16 a[162:163], v7 offset:41216
    s_waitcnt lgkmcnt(10)
    s_add_u32 m0, s83, 71936
    s_add_u32 s96, s65, s99
    v_mfma_f32_32x32x16_bf16 a[32:47], a[168:171], a[224:227], a[32:47]
    ds_read_b64_tr_b16 a[164:165], v9 offset:40192
    ds_read_b64_tr_b16 a[166:167], v9 offset:41216
    buffer_load_dwordx4 a[184:187], v30, s[48:51], s3 offen
    v_cvt_pk_bf16_f32 v192, 0, v192
    v_cvt_pk_bf16_f32 v193, 0, v193
    v_mul_f32 v192, v192, v205
    v_mfma_f32_32x32x16_bf16 a[48:63], a[172:175], a[224:227], a[48:63]
    ds_read_b64_tr_b16 a[168:169], v7 offset:42240
    ds_read_b64_tr_b16 a[170:171], v7 offset:43264
    s_waitcnt lgkmcnt(10)
    v_mul_f32 v193, v193, v205
    v_cvt_pk_bf16_f32 v44, v192, v193
    v_cvt_pk_bf16_f32 v194, 0, v194
    v_mfma_f32_32x32x16_bf16 a[32:47], a[144:147], a[236:239], a[32:47]
    ds_read_b64_tr_b16 a[172:173], v9 offset:42240
    ds_read_b64_tr_b16 a[174:175], v9 offset:43264
    buffer_load_dwordx4 a[188:191], v30, s[48:51], s3 offen offset:1024
    s_add_u32 s3, s94, 16384
    v_cvt_pk_bf16_f32 v195, 0, v195
    v_mul_f32 v194, v194, v205
    v_mfma_f32_32x32x16_bf16 a[48:63], a[148:151], a[236:239], a[48:63]
    ds_read_b64_tr_b16 a[144:145], v7 offset:44288
    ds_read_b64_tr_b16 a[146:147], v7 offset:45312
    s_waitcnt lgkmcnt(10)
    v_mul_f32 v195, v195, v205
    v_cvt_pk_bf16_f32 v45, v194, v195
    v_cvt_pk_bf16_f32 v196, 0, v196
    v_mfma_f32_32x32x16_bf16 a[32:47], a[152:155], a[228:231], a[32:47]
    ds_read_b64_tr_b16 a[148:149], v9 offset:44288
    ds_read_b64_tr_b16 a[150:151], v9 offset:45312
    buffer_load_dwordx4 a[192:195], v30, s[48:51], s3 offen
    v_cvt_pk_bf16_f32 v197, 0, v197
    v_mul_f32 v196, v196, v205
    v_mul_f32 v197, v197, v205
    v_mfma_f32_32x32x16_bf16 a[48:63], a[156:159], a[228:231], a[48:63]
    ds_read_b64_tr_b16 a[152:153], v7 offset:46336
    ds_read_b64_tr_b16 a[154:155], v7 offset:47360
    s_waitcnt lgkmcnt(10)
    v_cvt_pk_bf16_f32 v46, v196, v197
    v_cvt_pk_bf16_f32 v198, 0, v198
    v_cvt_pk_bf16_f32 v199, 0, v199
    v_mfma_f32_32x32x16_bf16 a[64:79], a[160:163], a[216:219], a[64:79]
    ds_read_b64_tr_b16 a[156:157], v9 offset:46336
    ds_read_b64_tr_b16 a[158:159], v9 offset:47360
    buffer_load_dwordx4 a[196:199], v30, s[48:51], s3 offen offset:1024
    v_mul_f32 v198, v198, v205
    v_mul_f32 v199, v199, v205
    v_cvt_pk_bf16_f32 v47, v198, v199
    v_mfma_f32_32x32x16_bf16 a[80:95], a[164:167], a[216:219], a[80:95]
    ds_read_b64_tr_b16 a[160:161], v7 offset:48384
    ds_read_b64_tr_b16 a[162:163], v7 offset:49408
    s_waitcnt lgkmcnt(10)
    s_add_u32 s4, s93, 18432
    v_lshlrev_b32 v208, 2, v1
    v_mfma_f32_32x32x16_bf16 a[64:79], a[168:171], a[208:211], a[64:79]
    ds_read_b64_tr_b16 a[164:165], v9 offset:48384
    ds_read_b64_tr_b16 a[166:167], v9 offset:49408
    buffer_store_dwordx4 v[40:43], v30, s[48:51], s4 offen sc1
    s_lshr_b32 s12, s63, 1
    s_mul_i32 s12, s12, 18432
    v_mfma_f32_32x32x16_bf16 a[80:95], a[172:175], a[208:211], a[80:95]
    ds_read_b64_tr_b16 a[168:169], v7 offset:50432
    ds_read_b64_tr_b16 a[170:171], v7 offset:51456
    s_waitcnt lgkmcnt(10)
    s_cmp_lt_u32 s62, 2
    s_cselect_b32 s74, s64, s65
    v_mfma_f32_32x32x16_bf16 a[64:79], a[144:147], a[220:223], a[64:79]
    ds_read_b64_tr_b16 a[172:173], v9 offset:50432
    ds_read_b64_tr_b16 a[174:175], v9 offset:51456
    buffer_store_dwordx4 v[44:47], v30, s[48:51], s4 offen offset:1024 sc1
    buffer_store_dword v48, v208, s[48:51], s4 offen offset:2048 sc1
    s_add_u32 s4, s94, 18432
    v_mfma_f32_32x32x16_bf16 a[80:95], a[148:151], a[220:223], a[80:95]
    ds_read_b64_tr_b16 a[144:145], v7 offset:52480
    ds_read_b64_tr_b16 a[146:147], v7 offset:53504
    s_waitcnt lgkmcnt(10)
    s_add_u32 s12, s12, s74
    s_xor_b32 s74, s62, s89
    v_mfma_f32_32x32x16_bf16 a[64:79], a[152:155], a[212:215], a[64:79]
    ds_read_b64_tr_b16 a[148:149], v9 offset:52480
    ds_read_b64_tr_b16 a[150:151], v9 offset:53504
    s_and_b32 s74, s74, 1
    s_lshl_b32 s74, s74, 6
    s_add_u32 s12, s12, s74
    v_mfma_f32_32x32x16_bf16 a[80:95], a[156:159], a[212:215], a[80:95]
    ds_read_b64_tr_b16 a[152:153], v7 offset:54528
    ds_read_b64_tr_b16 a[154:155], v7 offset:55552
    s_waitcnt lgkmcnt(10)
    buffer_load_dwordx4 a[128:131], v17, s[24:27], s12 offen
    s_lshl_b32 s73, s60, 1
    v_mfma_f32_32x32x16_bf16 a[64:79], a[160:163], a[232:235], a[64:79]
    ds_read_b64_tr_b16 a[156:157], v9 offset:54528
    ds_read_b64_tr_b16 a[158:159], v9 offset:55552
    s_add_u32 s73, s73, s89
    s_lshl_b32 s73, s73, 3
    s_lshr_b32 s74, s61, 1
    v_mfma_f32_32x32x16_bf16 a[80:95], a[164:167], a[232:235], a[80:95]
    s_barrier
    ds_read_b64_tr_b16 a[160:161], v6 offset:6400
    ds_read_b64_tr_b16 a[162:163], v6 offset:7424
    s_waitcnt lgkmcnt(10)
    buffer_load_dwordx4 v10, s[36:39], s96 offen lds
    v_mfma_f32_32x32x16_bf16 a[64:79], a[168:171], a[224:227], a[64:79]
    ds_read_b64_tr_b16 a[164:165], v8 offset:6400
    ds_read_b64_tr_b16 a[166:167], v8 offset:7424
    s_add_u32 s73, s73, s74
    s_mul_i32 s73, s73, 73728
    s_add_u32 s73, s73, 33554432
    v_mfma_f32_32x32x16_bf16 a[80:95], a[172:175], a[224:227], a[80:95]
    ds_read_b64_tr_b16 a[168:169], v6 offset:8448
    ds_read_b64_tr_b16 a[170:171], v6 offset:9472
    s_waitcnt lgkmcnt(10)
    buffer_load_dwordx4 v11, s[36:39], s96 offen offset:1024 lds
    s_add_u32 m0, s83, 80128
    v_mfma_f32_32x32x16_bf16 a[64:79], a[144:147], a[236:239], a[64:79]
    ds_read_b64_tr_b16 a[172:173], v8 offset:8448
    ds_read_b64_tr_b16 a[174:175], v8 offset:9472
    s_lshr_b32 s13, s63, 1
    s_mul_i32 s13, s13, 18432
    v_mfma_f32_32x32x16_bf16 a[80:95], a[148:151], a[236:239], a[80:95]
    ds_read_b64_tr_b16 a[144:145], v6 offset:10496
    ds_read_b64_tr_b16 a[146:147], v6 offset:11520
    s_waitcnt lgkmcnt(10)
    buffer_load_dwordx4 v14, s[40:43], s65 offen lds
    v_mfma_f32_32x32x16_bf16 a[64:79], a[152:155], a[228:231], a[64:79]
    ds_read_b64_tr_b16 a[148:149], v8 offset:10496
    ds_read_b64_tr_b16 a[150:151], v8 offset:11520
    s_cmp_lt_u32 s62, 2
    s_cselect_b32 s76, s66, s67
    s_add_u32 s13, s13, s76
    v_mfma_f32_32x32x16_bf16 a[80:95], a[156:159], a[228:231], a[80:95]
    ds_read_b64_tr_b16 a[152:153], v6 offset:12544
    ds_read_b64_tr_b16 a[154:155], v6 offset:13568
    s_waitcnt lgkmcnt(10)
    buffer_load_dwordx4 v15, s[40:43], s65 offen offset:1024 lds
    s_add_u32 m0, s84, 88320
    v_mfma_f32_32x32x16_bf16 a[96:111], a[160:163], a[216:219], a[96:111]
    ds_read_b64_tr_b16 a[156:157], v8 offset:12544
    ds_read_b64_tr_b16 a[158:159], v8 offset:13568
    s_add_u32 s96, s66, s72
    s_xor_b32 s76, s62, s89
    s_and_b32 s76, s76, 1
    v_mfma_f32_32x32x16_bf16 a[112:127], a[164:167], a[216:219], a[112:127]
    ds_read_b64_tr_b16 a[160:161], v6 offset:14592
    ds_read_b64_tr_b16 a[162:163], v6 offset:15616
    s_waitcnt lgkmcnt(10)
    buffer_load_dwordx4 v10, s[36:39], s96 offen lds
    s_lshl_b32 s76, s76, 6
    v_mfma_f32_32x32x16_bf16 a[96:111], a[168:171], a[208:211], a[96:111]
    ds_read_b64_tr_b16 a[164:165], v8 offset:14592
    ds_read_b64_tr_b16 a[166:167], v8 offset:15616
    s_add_u32 s13, s13, s76
    v_mfma_f32_32x32x16_bf16 a[112:127], a[172:175], a[208:211], a[112:127]
    ds_read_b64_tr_b16 a[168:169], v6 offset:16640
    ds_read_b64_tr_b16 a[170:171], v6 offset:17664
    s_waitcnt lgkmcnt(10)
    buffer_load_dwordx4 a[132:135], v17, s[24:27], s13 offen
    s_add_u32 s80, s73, 4096
    v_mfma_f32_32x32x16_bf16 a[96:111], a[144:147], a[220:223], a[96:111]
    ds_read_b64_tr_b16 a[172:173], v8 offset:16640
    ds_read_b64_tr_b16 a[174:175], v8 offset:17664
    s_lshr_b32 s8, s63, 1
    s_mul_i32 s8, s8, 18432
    v_and_b32 v249, 15, v1
    v_mfma_f32_32x32x16_bf16 a[112:127], a[148:151], a[220:223], a[112:127]
    ds_read_b64_tr_b16 a[144:145], v6 offset:18688
    ds_read_b64_tr_b16 a[146:147], v6 offset:19712
    s_waitcnt lgkmcnt(10)
    buffer_load_dwordx4 v11, s[36:39], s96 offen offset:1024 lds
    s_add_u32 m0, s84, 90368
    v_mfma_f32_32x32x16_bf16 a[96:111], a[152:155], a[212:215], a[96:111]
    ds_read_b64_tr_b16 a[148:149], v8 offset:18688
    ds_read_b64_tr_b16 a[150:151], v8 offset:19712
    s_lshl_b32 s78, s62, 8
    v_lshl_add_u32 v248, v249, 4, s78
    v_mul_u32_u24 v249, 1152, v249
    v_mfma_f32_32x32x16_bf16 a[112:127], a[156:159], a[212:215], a[112:127]
    ds_read_b64_tr_b16 a[152:153], v6 offset:20736
    ds_read_b64_tr_b16 a[154:155], v6 offset:21760
    s_waitcnt lgkmcnt(10)
    buffer_load_dwordx4 v12, s[36:39], s96 offen lds
    s_lshl_b32 s78, s62, 4
    v_mfma_f32_32x32x16_bf16 a[96:111], a[160:163], a[232:235], a[96:111]
    ds_read_b64_tr_b16 a[156:157], v8 offset:20736
    ds_read_b64_tr_b16 a[158:159], v8 offset:21760
    s_add_u32 s8, s8, s78
    s_add_u32 s8, s8, 512
    s_mov_b32 s78, s89
    v_mfma_f32_32x32x16_bf16 a[112:127], a[164:167], a[232:235], a[112:127]
    s_barrier
    ds_read_b64_tr_b16 a[160:161], v6 offset:22784
    ds_read_b64_tr_b16 a[162:163], v6 offset:23808
    s_waitcnt lgkmcnt(10)
    s_lshl_b32 s78, s78, 6
    v_mfma_f32_32x32x16_bf16 a[96:111], a[168:171], a[224:227], a[96:111]
    ds_read_b64_tr_b16 a[164:165], v8 offset:22784
    ds_read_b64_tr_b16 a[166:167], v8 offset:23808
    buffer_load_dwordx4 v13, s[36:39], s96 offen offset:1024 lds
    s_add_u32 m0, s83, 104704
    s_add_u32 s8, s8, s78
    v_mfma_f32_32x32x16_bf16 a[112:127], a[172:175], a[224:227], a[112:127]
    ds_read_b64_tr_b16 a[168:169], v6 offset:24832
    ds_read_b64_tr_b16 a[170:171], v6 offset:25856
    s_waitcnt lgkmcnt(10)
    s_add_u32 s96, s66, s99
    v_mfma_f32_32x32x16_bf16 a[96:111], a[144:147], a[236:239], a[96:111]
    ds_read_b64_tr_b16 a[172:173], v8 offset:24832
    ds_read_b64_tr_b16 a[174:175], v8 offset:25856
    buffer_load_dwordx4 a[136:139], v249, s[24:27], s8 offen
    s_add_u32 s81, s73, 8192
    s_lshl_b32 s14, s60, 4
    v_mfma_f32_32x32x16_bf16 a[112:127], a[148:151], a[236:239], a[112:127]
    ds_read_b64_tr_b16 a[144:145], v6 offset:26880
    ds_read_b64_tr_b16 a[146:147], v6 offset:27904
    s_waitcnt lgkmcnt(10)
    s_add_u32 s14, s14, s89
    s_lshl_b32 s14, s14, 2
    v_mfma_f32_32x32x16_bf16 a[96:111], a[152:155], a[228:231], a[96:111]
    ds_read_b64_tr_b16 a[148:149], v8 offset:26880
    ds_read_b64_tr_b16 a[150:151], v8 offset:27904
    buffer_load_dwordx4 v10, s[36:39], s96 offen lds
    s_lshr_b32 s15, s61, 2
    s_add_u32 s14, s14, s15
    v_mfma_f32_32x32x16_bf16 a[112:127], a[156:159], a[228:231], a[112:127]
    ds_read_b64_tr_b16 a[152:153], v6 offset:28928
    ds_read_b64_tr_b16 a[154:155], v6 offset:29952
    s_waitcnt lgkmcnt(10)
    s_lshl_b32 s14, s14, 6
    v_and_b32 v246, 7, v1
    v_lshl_add_u32 v246, v246, 9, s14
    v_mfma_f32_32x32x16_bf16 a[0:15], a[160:163], a[248:251], a[0:15]
    ds_read_b64_tr_b16 a[156:157], v8 offset:28928
    ds_read_b64_tr_b16 a[158:159], v8 offset:29952
    buffer_load_dwordx4 v11, s[36:39], s96 offen offset:1024 lds
    s_add_u32 m0, s83, 112896
    s_lshr_b32 s76, s61, 1
    v_and_b32 v247, 7, v1
    v_mfma_f32_32x32x16_bf16 a[16:31], a[164:167], a[248:251], a[16:31]
    ds_read_b64_tr_b16 a[160:161], v6 offset:30976
    ds_read_b64_tr_b16 a[162:163], v6 offset:32000
    s_waitcnt lgkmcnt(10)
    v_cmp_eq_u32_e64 s[14:15], s76, v247
    v_subrev_u32 v247, 20, v246
    v_mfma_f32_32x32x16_bf16 a[0:15], a[168:171], a[240:243], a[0:15]
    ds_read_b64_tr_b16 a[164:165], v8 offset:30976
    ds_read_b64_tr_b16 a[166:167], v8 offset:32000
    buffer_load_dwordx4 v14, s[40:43], s66 offen lds
    v_cndmask_b32_e64 v246, v246, v247, s[14:15]
    v_mfma_f32_32x32x16_bf16 a[16:31], a[172:175], a[240:243], a[16:31]
    ds_read_b64_tr_b16 a[168:169], v6 offset:33024
    ds_read_b64_tr_b16 a[170:171], v6 offset:34048
    s_waitcnt lgkmcnt(10)
    v_mfma_f32_32x32x16_bf16 a[0:15], a[144:147], a[252:255], a[0:15]
    ds_read_b64_tr_b16 a[172:173], v8 offset:33024
    ds_read_b64_tr_b16 a[174:175], v8 offset:34048
    buffer_load_dwordx4 v15, s[40:43], s66 offen offset:1024 lds
    v_mfma_f32_32x32x16_bf16 a[16:31], a[148:151], a[252:255], a[16:31]
    ds_read_b64_tr_b16 a[144:145], v6 offset:35072
    ds_read_b64_tr_b16 a[146:147], v6 offset:36096
    s_waitcnt lgkmcnt(10)
    v_mfma_f32_32x32x16_bf16 a[0:15], a[152:155], a[244:247], a[0:15]
    ds_read_b64_tr_b16 a[148:149], v8 offset:35072
    ds_read_b64_tr_b16 a[150:151], v8 offset:36096
    v_mfma_f32_32x32x16_bf16 a[16:31], a[156:159], a[244:247], a[16:31]
    ds_read_b64_tr_b16 a[152:153], v6 offset:37120
    ds_read_b64_tr_b16 a[154:155], v6 offset:38144
    s_waitcnt lgkmcnt(10)
    s_waitcnt vmcnt(18)
    v_mfma_f32_32x32x16_bf16 a[0:15], a[160:163], a[184:187], a[0:15]
    ds_read_b64_tr_b16 a[156:157], v8 offset:37120
    ds_read_b64_tr_b16 a[158:159], v8 offset:38144
    v_mfma_f32_32x32x16_bf16 a[16:31], a[164:167], a[184:187], a[16:31]
    s_barrier
    ds_read_b64_tr_b16 a[160:161], v6 offset:39168
    ds_read_b64_tr_b16 a[162:163], v6 offset:40192
    s_waitcnt lgkmcnt(10)
    s_add_u32 m0, s84, 6400
    s_add_u32 s96, s67, s72
    v_mfma_f32_32x32x16_bf16 a[0:15], a[168:171], a[176:179], a[0:15]
    ds_read_b64_tr_b16 a[164:165], v8 offset:39168
    ds_read_b64_tr_b16 a[166:167], v8 offset:40192
    buffer_load_dwordx4 v10, s[36:39], s96 offen lds
    v_mfma_f32_32x32x16_bf16 a[16:31], a[172:175], a[176:179], a[16:31]
    ds_read_b64_tr_b16 a[168:169], v6 offset:41216
    ds_read_b64_tr_b16 a[170:171], v6 offset:42240
    s_waitcnt lgkmcnt(10)
    v_mfma_f32_32x32x16_bf16 a[0:15], a[144:147], a[188:191], a[0:15]
    ds_read_b64_tr_b16 a[172:173], v8 offset:41216
    ds_read_b64_tr_b16 a[174:175], v8 offset:42240
    buffer_load_dwordx4 v[128:131], v30, s[48:51], s4 offen sc1
    v_mfma_f32_32x32x16_bf16 a[16:31], a[148:151], a[188:191], a[16:31]
    ds_read_b64_tr_b16 a[144:145], v6 offset:43264
    ds_read_b64_tr_b16 a[146:147], v6 offset:44288
    s_waitcnt lgkmcnt(10)
    v_mfma_f32_32x32x16_bf16 a[0:15], a[152:155], a[180:183], a[0:15]
    ds_read_b64_tr_b16 a[148:149], v8 offset:43264
    ds_read_b64_tr_b16 a[150:151], v8 offset:44288
    buffer_load_dwordx4 v[132:135], v30, s[48:51], s4 offen offset:1024 sc1
    buffer_load_dword v49, v208, s[48:51], s4 offen offset:2048 sc1
    v_mfma_f32_32x32x16_bf16 a[16:31], a[156:159], a[180:183], a[16:31]
    ds_read_b64_tr_b16 a[152:153], v6 offset:45312
    ds_read_b64_tr_b16 a[154:155], v6 offset:46336
    s_waitcnt lgkmcnt(10)
    v_mfma_f32_32x32x16_bf16 a[0:15], a[160:163], v[120:123], a[0:15]
    ds_read_b64_tr_b16 a[156:157], v8 offset:45312
    ds_read_b64_tr_b16 a[158:159], v8 offset:46336
    buffer_load_dwordx4 v11, s[36:39], s96 offen offset:1024 lds
    s_add_u32 m0, s84, 8448
    v_mfma_f32_32x32x16_bf16 a[16:31], a[164:167], v[120:123], a[16:31]
    ds_read_b64_tr_b16 a[160:161], v2 offset:47360
    ds_read_b64_tr_b16 a[162:163], v2 offset:47872
    s_waitcnt lgkmcnt(10)
    v_mfma_f32_32x32x16_bf16 a[0:15], a[168:171], v[124:127], a[0:15]
    ds_read_b64_tr_b16 a[164:165], v4 offset:47360
    ds_read_b64_tr_b16 a[166:167], v4 offset:47872
    buffer_load_dwordx4 v12, s[36:39], s96 offen lds
    v_mfma_f32_32x32x16_bf16 a[16:31], a[172:175], v[124:127], a[16:31]
    ds_read_b64_tr_b16 a[168:169], v2 offset:49408
    ds_read_b64_tr_b16 a[170:171], v2 offset:49920
    s_waitcnt lgkmcnt(10)
    v_mfma_f32_32x32x16_bf16 a[0:15], a[144:147], a[192:195], a[0:15]
    ds_read_b64_tr_b16 a[172:173], v4 offset:49408
    ds_read_b64_tr_b16 a[174:175], v4 offset:49920
    v_mfma_f32_32x32x16_bf16 a[16:31], a[148:151], a[192:195], a[16:31]
    ds_read_b64_tr_b16 a[144:145], v2 offset:51456
    ds_read_b64_tr_b16 a[146:147], v2 offset:51968
    s_waitcnt lgkmcnt(10)
    buffer_load_dwordx4 v13, s[36:39], s96 offen offset:1024 lds
    v_mfma_f32_32x32x16_bf16 a[0:15], a[152:155], a[196:199], a[0:15]
    ds_read_b64_tr_b16 a[148:149], v4 offset:51456
    ds_read_b64_tr_b16 a[150:151], v4 offset:51968
    v_mfma_f32_32x32x16_bf16 a[16:31], a[156:159], a[196:199], a[16:31]
    ds_read_b64_tr_b16 a[152:153], v2 offset:53504
    ds_read_b64_tr_b16 a[154:155], v2 offset:54016
    s_waitcnt lgkmcnt(10)
    v_mfma_f32_32x32x16_bf16 a[0:15], a[160:163], v[40:43], a[0:15]
    ds_read_b64_tr_b16 a[156:157], v4 offset:53504
    ds_read_b64_tr_b16 a[158:159], v4 offset:54016
    v_mfma_f32_32x32x16_bf16 a[16:31], a[164:167], v[40:43], a[16:31]
    ds_read_b64_tr_b16 a[160:161], v22
    s_waitcnt lgkmcnt(9)
    v_mfma_f32_32x32x16_bf16 a[0:15], a[168:171], v[44:47], a[0:15]
    ds_read_b64_tr_b16 a[164:165], v22 offset:64
    v_mfma_f32_32x32x16_bf16 a[16:31], a[172:175], v[44:47], a[16:31]
    s_barrier
    ds_read_b64_tr_b16 a[168:169], v6 offset:55552
    ds_read_b64_tr_b16 a[170:171], v6 offset:56576
    s_waitcnt lgkmcnt(8)
    s_add_u32 m0, s83, 22784
    s_add_u32 s96, s67, s99
    buffer_load_dwordx4 v10, s[36:39], s96 offen lds
    buffer_load_dwordx4 v11, s[36:39], s96 offen offset:1024 lds
    s_add_u32 m0, s83, 30976
    s_nop 0
    buffer_load_dwordx4 v14, s[40:43], s67 offen lds
    buffer_load_dwordx4 v15, s[40:43], s67 offen offset:1024 lds
    s_waitcnt vmcnt(7)
    v_max3_u32 v210, v128, v129, v130
    v_max3_u32 v211, v131, v132, v133
    v_max3_u32 v210, v210, v134, v135
    v_max3_u32 v210, v210, v211, v49
    v_cmp_eq_u32_e64 s[6:7], -1, v210
    s_nop 0
    s_cmp_lg_u64 s[6:7], 0
    s_cbranch_scc1 L_slow_26
L_back_27:
    v_mfma_f32_32x32x16_bf16 a[0:15], a[144:147], v[128:131], a[0:15]
    ds_read_b64_tr_b16 a[172:173], v8 offset:55552
    ds_read_b64_tr_b16 a[174:175], v8 offset:56576
    v_mfma_f32_32x32x16_bf16 a[16:31], a[148:151], v[128:131], a[16:31]
    ds_read_b64_tr_b16 a[144:145], v6 offset:57600
    ds_read_b64_tr_b16 a[146:147], v6 offset:58624
    s_waitcnt lgkmcnt(8)
    v_mfma_f32_32x32x16_bf16 a[0:15], a[152:155], v[132:135], a[0:15]
    ds_read_b64_tr_b16 a[148:149], v8 offset:57600
    ds_read_b64_tr_b16 a[150:151], v8 offset:58624
    v_mfma_f32_32x32x16_bf16 a[16:31], a[156:159], v[132:135], a[16:31]
    ds_read_b64_tr_b16 a[152:153], v6 offset:59648
    ds_read_b64_tr_b16 a[154:155], v6 offset:60672
    s_waitcnt lgkmcnt(10)
    v_mfma_f32_32x32x16_bf16 a[0:15], a[160:163], v[48:51], a[0:15]
    ds_read_b64_tr_b16 a[156:157], v8 offset:59648
    ds_read_b64_tr_b16 a[158:159], v8 offset:60672
    v_mfma_f32_32x32x16_bf16 a[16:31], a[164:167], v[48:51], a[16:31]
    ds_read_b64_tr_b16 a[160:161], v6 offset:61696
    ds_read_b64_tr_b16 a[162:163], v6 offset:62720
    s_waitcnt lgkmcnt(10)
    v_lshrrev_b32 v250, 5, v1
    v_mul_u32_u24 v250, 9216, v250
    v_add_u32 v248, v248, v250
    v_mfma_f32_32x32x16_bf16 a[32:47], a[168:171], a[248:251], a[32:47]
    ds_read_b64_tr_b16 a[164:165], v8 offset:61696
    ds_read_b64_tr_b16 a[166:167], v8 offset:62720
    v_accvgpr_read_b32 v52, a0
    v_accvgpr_read_b32 v53, a1
    v_cvt_pk_bf16_f32 v152, v52, v53
    v_mov_b32 v36, v32
    v_mfma_f32_32x32x16_bf16 a[48:63], a[172:175], a[248:251], a[48:63]
    ds_read_b64_tr_b16 a[168:169], v6 offset:63744
    ds_read_b64_tr_b16 a[170:171], v6 offset:64768
    s_waitcnt lgkmcnt(10)
    v_accvgpr_read_b32 v54, a2
    v_accvgpr_read_b32 v55, a3
    v_cvt_pk_bf16_f32 v153, v54, v55
    v_mfma_f32_32x32x16_bf16 a[32:47], a[144:147], a[240:243], a[32:47]
    ds_read_b64_tr_b16 a[172:173], v8 offset:63744
    ds_read_b64_tr_b16 a[174:175], v8 offset:64768
    v_accvgpr_read_b32 v52, a4
    v_accvgpr_read_b32 v53, a5
    v_cvt_pk_bf16_f32 v154, v52, v53
    v_mov_b32 v250, v32
    v_mfma_f32_32x32x16_bf16 a[48:63], a[148:151], a[240:243], a[48:63]
    ds_read_b64_tr_b16 a[144:145], v7 offset:1280
    ds_read_b64_tr_b16 a[146:147], v7 offset:2304
    s_waitcnt lgkmcnt(10)
    v_accvgpr_read_b32 v54, a6
    v_accvgpr_read_b32 v55, a7
    v_cvt_pk_bf16_f32 v155, v54, v55
    v_mfma_f32_32x32x16_bf16 a[32:47], a[152:155], a[252:255], a[32:47]
    ds_read_b64_tr_b16 a[148:149], v9 offset:1280
    ds_read_b64_tr_b16 a[150:151], v9 offset:2304
    v_accvgpr_read_b32 v52, a8
    v_accvgpr_read_b32 v53, a9
    v_cvt_pk_bf16_f32 v156, v52, v53
    v_mfma_f32_32x32x16_bf16 a[48:63], a[156:159], a[252:255], a[48:63]
    ds_read_b64_tr_b16 a[152:153], v7 offset:3328
    ds_read_b64_tr_b16 a[154:155], v7 offset:4352
    s_waitcnt lgkmcnt(10)
    v_accvgpr_read_b32 v54, a10
    v_accvgpr_read_b32 v55, a11
    v_cvt_pk_bf16_f32 v157, v54, v55
    v_mfma_f32_32x32x16_bf16 a[32:47], a[160:163], a[244:247], a[32:47]
    ds_read_b64_tr_b16 a[156:157], v9 offset:3328
    ds_read_b64_tr_b16 a[158:159], v9 offset:4352
    v_accvgpr_read_b32 v52, a12
    v_accvgpr_read_b32 v53, a13
    v_cvt_pk_bf16_f32 v158, v52, v53
    v_mfma_f32_32x32x16_bf16 a[48:63], a[164:167], a[244:247], a[48:63]
    ds_read_b64_tr_b16 a[160:161], v7 offset:5376
    ds_read_b64_tr_b16 a[162:163], v7 offset:6400
    s_waitcnt lgkmcnt(10)
    v_accvgpr_read_b32 v54, a14
    v_accvgpr_read_b32 v55, a15
    v_cvt_pk_bf16_f32 v159, v54, v55
    v_mfma_f32_32x32x16_bf16 a[32:47], a[168:171], a[184:187], a[32:47]
    ds_read_b64_tr_b16 a[164:165], v9 offset:5376
    ds_read_b64_tr_b16 a[166:167], v9 offset:6400
    v_permlane32_swap_b32 v152, v154
    v_permlane32_swap_b32 v153, v155
    v_mfma_f32_32x32x16_bf16 a[48:63], a[172:175], a[184:187], a[48:63]
    s_barrier
    ds_read_b64_tr_b16 a[168:169], v7 offset:7424
    ds_read_b64_tr_b16 a[170:171], v7 offset:8448
    s_waitcnt lgkmcnt(10)
    s_add_u32 m0, s84, 39168
    s_add_u32 s96, s68, s69
    v_mfma_f32_32x32x16_bf16 a[32:47], a[144:147], a[176:179], a[32:47]
    ds_read_b64_tr_b16 a[172:173], v9 offset:7424
    ds_read_b64_tr_b16 a[174:175], v9 offset:8448
    buffer_load_dwordx4 v10, s[36:39], s96 offen lds
    v_permlane32_swap_b32 v156, v158
    v_mfma_f32_32x32x16_bf16 a[48:63], a[148:151], a[176:179], a[48:63]
    ds_read_b64_tr_b16 a[144:145], v7 offset:9472
    ds_read_b64_tr_b16 a[146:147], v7 offset:10496
    s_waitcnt lgkmcnt(10)
    v_permlane32_swap_b32 v157, v159
    v_accvgpr_read_b32 v52, a16
    v_mfma_f32_32x32x16_bf16 a[32:47], a[152:155], a[188:191], a[32:47]
    ds_read_b64_tr_b16 a[148:149], v9 offset:9472
    ds_read_b64_tr_b16 a[150:151], v9 offset:10496
    buffer_store_dwordx4 v[152:155], v29, s[48:51], s90 offen sc1
    v_accvgpr_read_b32 v53, a17
    v_cvt_pk_bf16_f32 v160, v52, v53
    v_mfma_f32_32x32x16_bf16 a[48:63], a[156:159], a[188:191], a[48:63]
    ds_read_b64_tr_b16 a[152:153], v7 offset:11520
    ds_read_b64_tr_b16 a[154:155], v7 offset:12544
    s_waitcnt lgkmcnt(10)
    v_accvgpr_read_b32 v54, a18
    v_accvgpr_read_b32 v55, a19
    v_cvt_pk_bf16_f32 v161, v54, v55
    v_mfma_f32_32x32x16_bf16 a[32:47], a[160:163], a[180:183], a[32:47]
    ds_read_b64_tr_b16 a[156:157], v9 offset:11520
    ds_read_b64_tr_b16 a[158:159], v9 offset:12544
    buffer_load_dwordx4 v11, s[36:39], s96 offen offset:1024 lds
    s_add_u32 m0, s84, 41216
    v_accvgpr_read_b32 v52, a20
    v_mfma_f32_32x32x16_bf16 a[48:63], a[164:167], a[180:183], a[48:63]
    ds_read_b64_tr_b16 a[160:161], v7 offset:13568
    ds_read_b64_tr_b16 a[162:163], v7 offset:14592
    s_waitcnt lgkmcnt(10)
    v_accvgpr_read_b32 v53, a21
    v_cvt_pk_bf16_f32 v162, v52, v53
    v_accvgpr_read_b32 v54, a22
    v_mfma_f32_32x32x16_bf16 a[32:47], a[168:171], v[120:123], a[32:47]
    ds_read_b64_tr_b16 a[164:165], v9 offset:13568
    ds_read_b64_tr_b16 a[166:167], v9 offset:14592
    buffer_load_dwordx4 v12, s[36:39], s96 offen lds
    v_accvgpr_read_b32 v55, a23
    v_cvt_pk_bf16_f32 v163, v54, v55
    v_mfma_f32_32x32x16_bf16 a[48:63], a[172:175], v[120:123], a[48:63]
    ds_read_b64_tr_b16 a[168:169], v3 offset:15616
    ds_read_b64_tr_b16 a[170:171], v3 offset:16128
    s_waitcnt lgkmcnt(10)
    v_accvgpr_read_b32 v52, a24
    v_accvgpr_read_b32 v53, a25
    v_cvt_pk_bf16_f32 v164, v52, v53
    v_mfma_f32_32x32x16_bf16 a[32:47], a[144:147], v[124:127], a[32:47]
    ds_read_b64_tr_b16 a[172:173], v5 offset:15616
    ds_read_b64_tr_b16 a[174:175], v5 offset:16128
    buffer_load_dwordx4 v13, s[36:39], s96 offen offset:1024 lds
    v_accvgpr_read_b32 v54, a26
    v_accvgpr_read_b32 v55, a27
    v_mfma_f32_32x32x16_bf16 a[48:63], a[148:151], v[124:127], a[48:63]
    ds_read_b64_tr_b16 a[144:145], v3 offset:17664
    ds_read_b64_tr_b16 a[146:147], v3 offset:18176
    s_waitcnt lgkmcnt(10)
    v_cvt_pk_bf16_f32 v165, v54, v55
    v_accvgpr_read_b32 v52, a28
    v_accvgpr_read_b32 v53, a29
    v_mfma_f32_32x32x16_bf16 a[32:47], a[152:155], a[192:195], a[32:47]
    ds_read_b64_tr_b16 a[148:149], v5 offset:17664
    ds_read_b64_tr_b16 a[150:151], v5 offset:18176
    buffer_store_dwordx4 v[156:159], v29, s[48:51], s90 offen offset:512 sc1
    v_cvt_pk_bf16_f32 v166, v52, v53
    v_accvgpr_read_b32 v54, a30
    v_mfma_f32_32x32x16_bf16 a[48:63], a[156:159], a[192:195], a[48:63]
    ds_read_b64_tr_b16 a[152:153], v3 offset:19712
    ds_read_b64_tr_b16 a[154:155], v3 offset:20224
    s_waitcnt lgkmcnt(10)
    v_accvgpr_read_b32 v55, a31
    v_cvt_pk_bf16_f32 v167, v54, v55
    v_mfma_f32_32x32x16_bf16 a[32:47], a[160:163], a[196:199], a[32:47]
    ds_read_b64_tr_b16 a[156:157], v5 offset:19712
    ds_read_b64_tr_b16 a[158:159], v5 offset:20224
    v_permlane32_swap_b32 v160, v162
    v_permlane32_swap_b32 v161, v163
    v_mfma_f32_32x32x16_bf16 a[48:63], a[164:167], a[196:199], a[48:63]
    ds_read_b64_tr_b16 a[160:161], v3 offset:21760
    ds_read_b64_tr_b16 a[162:163], v3 offset:22272
    s_waitcnt lgkmcnt(10)
    v_permlane32_swap_b32 v164, v166
    v_mfma_f32_32x32x16_bf16 a[32:47], a[168:171], v[40:43], a[32:47]
    ds_read_b64_tr_b16 a[164:165], v5 offset:21760
    ds_read_b64_tr_b16 a[166:167], v5 offset:22272
    v_permlane32_swap_b32 v165, v167
    v_permlane32_swap_b32 v36, v250
    v_mfma_f32_32x32x16_bf16 a[48:63], a[172:175], v[40:43], a[48:63]
    ds_read_b64_tr_b16 a[168:169], v22 offset:128
    s_waitcnt lgkmcnt(9)
    v_or_b32 v36, v36, v250
    v_mov_b32 v37, v33
    v_mov_b32 v250, v33
    v_mfma_f32_32x32x16_bf16 a[32:47], a[144:147], v[44:47], a[32:47]
    ds_read_b64_tr_b16 a[172:173], v22 offset:192
    v_permlane32_swap_b32 v37, v250
    v_or_b32 v37, v37, v250
    v_mov_b32 v38, v34
    v_mov_b32 v250, v34
    v_mfma_f32_32x32x16_bf16 a[48:63], a[148:151], v[44:47], a[48:63]
    s_barrier
    ds_read_b64_tr_b16 a[144:145], v7 offset:23808
    ds_read_b64_tr_b16 a[146:147], v7 offset:24832
    s_waitcnt lgkmcnt(8)
    s_add_u32 m0, s84, 55552
    s_add_u32 s96, s68, s71
    v_mfma_f32_32x32x16_bf16 a[32:47], a[152:155], v[128:131], a[32:47]
    ds_read_b64_tr_b16 a[148:149], v9 offset:23808
    ds_read_b64_tr_b16 a[150:151], v9 offset:24832
    buffer_store_dwordx4 v[160:163], v29, s[48:51], s90 offen offset:1024 sc1
    v_permlane32_swap_b32 v38, v250
    v_or_b32 v38, v38, v250
    v_mfma_f32_32x32x16_bf16 a[48:63], a[156:159], v[128:131], a[48:63]
    ds_read_b64_tr_b16 a[152:153], v7 offset:25856
    ds_read_b64_tr_b16 a[154:155], v7 offset:26880
    s_waitcnt lgkmcnt(8)
    v_mov_b32 v39, v35
    v_mov_b32 v250, v35
    v_mfma_f32_32x32x16_bf16 a[32:47], a[160:163], v[132:135], a[32:47]
    ds_read_b64_tr_b16 a[156:157], v9 offset:25856
    ds_read_b64_tr_b16 a[158:159], v9 offset:26880
    buffer_load_dwordx4 v10, s[36:39], s96 offen lds
    v_permlane32_swap_b32 v39, v250
    v_or_b32 v39, v39, v250
    v_mfma_f32_32x32x16_bf16 a[48:63], a[164:167], v[132:135], a[48:63]
    ds_read_b64_tr_b16 a[160:161], v7 offset:27904
    ds_read_b64_tr_b16 a[162:163], v7 offset:28928
    s_waitcnt lgkmcnt(10)
    v_mfma_f32_32x32x16_bf16 a[32:47], a[168:171], v[48:51], a[32:47]
    ds_read_b64_tr_b16 a[164:165], v9 offset:27904
    ds_read_b64_tr_b16 a[166:167], v9 offset:28928
    buffer_load_dwordx4 v11, s[36:39], s96 offen offset:1024 lds
    s_add_u32 m0, s84, 57600
    v_mfma_f32_32x32x16_bf16 a[48:63], a[172:175], v[48:51], a[48:63]
    ds_read_b64_tr_b16 a[168:169], v7 offset:29952
    ds_read_b64_tr_b16 a[170:171], v7 offset:30976
    s_waitcnt lgkmcnt(10)
    v_mfma_f32_32x32x16_bf16 a[64:79], a[144:147], a[248:251], a[64:79]
    ds_read_b64_tr_b16 a[172:173], v9 offset:29952
    ds_read_b64_tr_b16 a[174:175], v9 offset:30976
    buffer_load_dwordx4 v12, s[36:39], s96 offen lds
    v_accvgpr_read_b32 v52, a32
    v_accvgpr_read_b32 v53, a33
    v_mfma_f32_32x32x16_bf16 a[80:95], a[148:151], a[248:251], a[80:95]
    ds_read_b64_tr_b16 a[144:145], v7 offset:32000
    ds_read_b64_tr_b16 a[146:147], v7 offset:33024
    s_waitcnt lgkmcnt(10)
    v_cvt_pk_bf16_f32 v152, v52, v53
    v_accvgpr_read_b32 v54, a34
    v_accvgpr_read_b32 v55, a35
    v_mfma_f32_32x32x16_bf16 a[64:79], a[152:155], a[240:243], a[64:79]
    ds_read_b64_tr_b16 a[148:149], v9 offset:32000
    ds_read_b64_tr_b16 a[150:151], v9 offset:33024
    buffer_store_dwordx4 v[164:167], v29, s[48:51], s90 offen offset:1536 sc1
    v_cvt_pk_bf16_f32 v153, v54, v55
    v_accvgpr_read_b32 v52, a36
    v_mfma_f32_32x32x16_bf16 a[80:95], a[156:159], a[240:243], a[80:95]
    ds_read_b64_tr_b16 a[152:153], v7 offset:34048
    ds_read_b64_tr_b16 a[154:155], v7 offset:35072
    s_waitcnt lgkmcnt(10)
    v_accvgpr_read_b32 v53, a37
    v_cvt_pk_bf16_f32 v154, v52, v53
    v_accvgpr_read_b32 v54, a38
    v_mfma_f32_32x32x16_bf16 a[64:79], a[160:163], a[252:255], a[64:79]
    ds_read_b64_tr_b16 a[156:157], v9 offset:34048
    ds_read_b64_tr_b16 a[158:159], v9 offset:35072
    buffer_load_dwordx4 v13, s[36:39], s96 offen offset:1024 lds
    v_accvgpr_read_b32 v55, a39
    v_cvt_pk_bf16_f32 v155, v54, v55
    v_mfma_f32_32x32x16_bf16 a[80:95], a[164:167], a[252:255], a[80:95]
    ds_read_b64_tr_b16 a[160:161], v7 offset:36096
    ds_read_b64_tr_b16 a[162:163], v7 offset:37120
    s_waitcnt lgkmcnt(10)
    v_accvgpr_read_b32 v52, a40
    v_accvgpr_read_b32 v53, a41
    v_cvt_pk_bf16_f32 v156, v52, v53
    v_mfma_f32_32x32x16_bf16 a[64:79], a[168:171], a[244:247], a[64:79]
    ds_read_b64_tr_b16 a[164:165], v9 offset:36096
    ds_read_b64_tr_b16 a[166:167], v9 offset:37120
    v_accvgpr_read_b32 v54, a42
    v_accvgpr_read_b32 v55, a43
    v_cvt_pk_bf16_f32 v157, v54, v55
    v_mfma_f32_32x32x16_bf16 a[80:95], a[172:175], a[244:247], a[80:95]
    ds_read_b64_tr_b16 a[168:169], v7 offset:38144
    ds_read_b64_tr_b16 a[170:171], v7 offset:39168
    s_waitcnt lgkmcnt(10)
    v_accvgpr_read_b32 v52, a44
    v_accvgpr_read_b32 v53, a45
    v_cvt_pk_bf16_f32 v158, v52, v53
    v_mfma_f32_32x32x16_bf16 a[64:79], a[144:147], a[184:187], a[64:79]
    ds_read_b64_tr_b16 a[172:173], v9 offset:38144
    ds_read_b64_tr_b16 a[174:175], v9 offset:39168
    v_accvgpr_read_b32 v54, a46
    v_accvgpr_read_b32 v55, a47
    v_cvt_pk_bf16_f32 v159, v54, v55
    v_mfma_f32_32x32x16_bf16 a[80:95], a[148:151], a[184:187], a[80:95]
    s_barrier
    ds_read_b64_tr_b16 a[144:145], v7 offset:40192
    ds_read_b64_tr_b16 a[146:147], v7 offset:41216
    s_waitcnt lgkmcnt(10)
    s_add_u32 m0, s84, 71936
    s_add_u32 s96, s68, s70
    v_mfma_f32_32x32x16_bf16 a[64:79], a[152:155], a[176:179], a[64:79]
    ds_read_b64_tr_b16 a[148:149], v9 offset:40192
    ds_read_b64_tr_b16 a[150:151], v9 offset:41216
    buffer_load_dwordx4 v10, s[36:39], s96 offen lds
    v_permlane32_swap_b32 v152, v154
    v_mfma_f32_32x32x16_bf16 a[80:95], a[156:159], a[176:179], a[80:95]
    ds_read_b64_tr_b16 a[152:153], v7 offset:42240
    ds_read_b64_tr_b16 a[154:155], v7 offset:43264
    s_waitcnt lgkmcnt(10)
    v_permlane32_swap_b32 v153, v155
    v_mfma_f32_32x32x16_bf16 a[64:79], a[160:163], a[188:191], a[64:79]
    ds_read_b64_tr_b16 a[156:157], v9 offset:42240
    ds_read_b64_tr_b16 a[158:159], v9 offset:43264
    buffer_load_dwordx4 v11, s[36:39], s96 offen offset:1024 lds
    s_add_u32 m0, s84, 73984
    v_permlane32_swap_b32 v156, v158
    v_mfma_f32_32x32x16_bf16 a[80:95], a[164:167], a[188:191], a[80:95]
    ds_read_b64_tr_b16 a[160:161], v7 offset:44288
    ds_read_b64_tr_b16 a[162:163], v7 offset:45312
    s_waitcnt lgkmcnt(10)
    v_permlane32_swap_b32 v157, v159
    v_accvgpr_read_b32 v52, a48
    v_mfma_f32_32x32x16_bf16 a[64:79], a[168:171], a[180:183], a[64:79]
    ds_read_b64_tr_b16 a[164:165], v9 offset:44288
    ds_read_b64_tr_b16 a[166:167], v9 offset:45312
    buffer_store_dwordx4 v[152:155], v29, s[48:51], s90 offen offset:2048 sc1
    v_accvgpr_read_b32 v53, a49
    v_cvt_pk_bf16_f32 v160, v52, v53
    v_mfma_f32_32x32x16_bf16 a[80:95], a[172:175], a[180:183], a[80:95]
    ds_read_b64_tr_b16 a[168:169], v7 offset:46336
    ds_read_b64_tr_b16 a[170:171], v7 offset:47360
    s_waitcnt lgkmcnt(10)
    v_accvgpr_read_b32 v54, a50
    v_accvgpr_read_b32 v55, a51
    v_cvt_pk_bf16_f32 v161, v54, v55
    v_mfma_f32_32x32x16_bf16 a[64:79], a[144:147], v[120:123], a[64:79]
    ds_read_b64_tr_b16 a[172:173], v9 offset:46336
    ds_read_b64_tr_b16 a[174:175], v9 offset:47360
    buffer_load_dwordx4 v12, s[36:39], s96 offen lds
    v_accvgpr_read_b32 v52, a52
    v_accvgpr_read_b32 v53, a53
    v_mfma_f32_32x32x16_bf16 a[80:95], a[148:151], v[120:123], a[80:95]
    ds_read_b64_tr_b16 a[144:145], v3 offset:48384
    ds_read_b64_tr_b16 a[146:147], v3 offset:48896
    s_waitcnt lgkmcnt(10)
    v_cvt_pk_bf16_f32 v162, v52, v53
    v_accvgpr_read_b32 v54, a54
    v_accvgpr_read_b32 v55, a55
    v_mfma_f32_32x32x16_bf16 a[64:79], a[152:155], v[124:127], a[64:79]
    ds_read_b64_tr_b16 a[148:149], v5 offset:48384
    ds_read_b64_tr_b16 a[150:151], v5 offset:48896
    buffer_load_dwordx4 v13, s[36:39], s96 offen offset:1024 lds
    v_cvt_pk_bf16_f32 v163, v54, v55
    v_accvgpr_read_b32 v52, a56
    v_mfma_f32_32x32x16_bf16 a[80:95], a[156:159], v[124:127], a[80:95]
    ds_read_b64_tr_b16 a[152:153], v3 offset:50432
    ds_read_b64_tr_b16 a[154:155], v3 offset:50944
    s_waitcnt lgkmcnt(10)
    v_accvgpr_read_b32 v53, a57
    v_cvt_pk_bf16_f32 v164, v52, v53
    v_accvgpr_read_b32 v54, a58
    v_mfma_f32_32x32x16_bf16 a[64:79], a[160:163], a[192:195], a[64:79]
    ds_read_b64_tr_b16 a[156:157], v5 offset:50432
    ds_read_b64_tr_b16 a[158:159], v5 offset:50944
    v_accvgpr_read_b32 v55, a59
    v_cvt_pk_bf16_f32 v165, v54, v55
    v_accvgpr_read_b32 v52, a60
    v_mfma_f32_32x32x16_bf16 a[80:95], a[164:167], a[192:195], a[80:95]
    ds_read_b64_tr_b16 a[160:161], v3 offset:52480
    ds_read_b64_tr_b16 a[162:163], v3 offset:52992
    s_waitcnt lgkmcnt(10)
    v_accvgpr_read_b32 v53, a61
    v_cvt_pk_bf16_f32 v166, v52, v53
    v_accvgpr_read_b32 v54, a62
    v_mfma_f32_32x32x16_bf16 a[64:79], a[168:171], a[196:199], a[64:79]
    ds_read_b64_tr_b16 a[164:165], v5 offset:52480
    ds_read_b64_tr_b16 a[166:167], v5 offset:52992
    buffer_store_dwordx4 v[156:159], v29, s[48:51], s90 offen offset:2560 sc1
    v_accvgpr_read_b32 v55, a63
    v_cvt_pk_bf16_f32 v167, v54, v55
    v_mfma_f32_32x32x16_bf16 a[80:95], a[172:175], a[196:199], a[80:95]
    ds_read_b64_tr_b16 a[168:169], v3 offset:54528
    ds_read_b64_tr_b16 a[170:171], v3 offset:55040
    s_waitcnt lgkmcnt(10)
    v_permlane32_swap_b32 v160, v162
    v_mfma_f32_32x32x16_bf16 a[64:79], a[144:147], v[40:43], a[64:79]
    ds_read_b64_tr_b16 a[172:173], v5 offset:54528
    ds_read_b64_tr_b16 a[174:175], v5 offset:55040
    v_permlane32_swap_b32 v161, v163
    v_permlane32_swap_b32 v164, v166
    v_mfma_f32_32x32x16_bf16 a[80:95], a[148:151], v[40:43], a[80:95]
    ds_read_b64_tr_b16 a[144:145], v22 offset:256
    s_waitcnt lgkmcnt(9)
    v_permlane32_swap_b32 v165, v167
    v_mfma_f32_32x32x16_bf16 a[64:79], a[152:155], v[44:47], a[64:79]
    ds_read_b64_tr_b16 a[148:149], v22 offset:320
    v_mfma_f32_32x32x16_bf16 a[80:95], a[156:159], v[44:47], a[80:95]
    s_waitcnt vmcnt(22)
    s_barrier
    ds_read_b64_tr_b16 a[152:153], v6 offset:6400
    ds_read_b64_tr_b16 a[154:155], v6 offset:7424
    s_waitcnt lgkmcnt(8)
    s_add_u32 m0, s84, 88320
    s_add_u32 s96, s68, s72
    v_mfma_f32_32x32x16_bf16 a[64:79], a[160:163], v[128:131], a[64:79]
    ds_read_b64_tr_b16 a[156:157], v8 offset:6400
    ds_read_b64_tr_b16 a[158:159], v8 offset:7424
    buffer_load_dwordx4 v10, s[36:39], s96 offen lds
    v_mfma_f32_32x32x16_bf16 a[80:95], a[164:167], v[128:131], a[80:95]
    ds_read_b64_tr_b16 a[160:161], v6 offset:8448
    ds_read_b64_tr_b16 a[162:163], v6 offset:9472
    s_waitcnt lgkmcnt(8)
    v_mfma_f32_32x32x16_bf16 a[64:79], a[168:171], v[132:135], a[64:79]
    ds_read_b64_tr_b16 a[164:165], v8 offset:8448
    ds_read_b64_tr_b16 a[166:167], v8 offset:9472
    buffer_store_dwordx4 v[160:163], v29, s[48:51], s90 offen offset:3072 sc1
    v_mfma_f32_32x32x16_bf16 a[80:95], a[172:175], v[132:135], a[80:95]
    ds_read_b64_tr_b16 a[168:169], v6 offset:10496
    ds_read_b64_tr_b16 a[170:171], v6 offset:11520
    s_waitcnt lgkmcnt(10)
    v_mfma_f32_32x32x16_bf16 a[64:79], a[144:147], v[48:51], a[64:79]
    ds_read_b64_tr_b16 a[172:173], v8 offset:10496
    ds_read_b64_tr_b16 a[174:175], v8 offset:11520
    buffer_load_dwordx4 v11, s[36:39], s96 offen offset:1024 lds
    s_add_u32 m0, s84, 90368
    v_mfma_f32_32x32x16_bf16 a[80:95], a[148:151], v[48:51], a[80:95]
    ds_read_b64_tr_b16 a[144:145], v6 offset:12544
    ds_read_b64_tr_b16 a[146:147], v6 offset:13568
    s_waitcnt lgkmcnt(10)
    v_mfma_f32_32x32x16_bf16 a[96:111], a[152:155], a[248:251], a[96:111]
    ds_read_b64_tr_b16 a[148:149], v8 offset:12544
    ds_read_b64_tr_b16 a[150:151], v8 offset:13568
    buffer_load_dwordx4 v12, s[36:39], s96 offen lds
    v_accvgpr_read_b32 v52, a64
    v_accvgpr_read_b32 v53, a65
    v_mfma_f32_32x32x16_bf16 a[112:127], a[156:159], a[248:251], a[112:127]
    ds_read_b64_tr_b16 a[152:153], v6 offset:14592
    ds_read_b64_tr_b16 a[154:155], v6 offset:15616
    s_waitcnt lgkmcnt(10)
    v_cvt_pk_bf16_f32 v152, v52, v53
    v_accvgpr_read_b32 v54, a66
    v_accvgpr_read_b32 v55, a67
    v_mfma_f32_32x32x16_bf16 a[96:111], a[160:163], a[240:243], a[96:111]
    ds_read_b64_tr_b16 a[156:157], v8 offset:14592
    ds_read_b64_tr_b16 a[158:159], v8 offset:15616
    buffer_load_dwordx4 v13, s[36:39], s96 offen offset:1024 lds
    v_cvt_pk_bf16_f32 v153, v54, v55
    v_accvgpr_read_b32 v52, a68
    v_mfma_f32_32x32x16_bf16 a[112:127], a[164:167], a[240:243], a[112:127]
    ds_read_b64_tr_b16 a[160:161], v6 offset:16640
    ds_read_b64_tr_b16 a[162:163], v6 offset:17664
    s_waitcnt lgkmcnt(10)
    v_accvgpr_read_b32 v53, a69
    v_cvt_pk_bf16_f32 v154, v52, v53
    v_accvgpr_read_b32 v54, a70
    v_mfma_f32_32x32x16_bf16 a[96:111], a[168:171], a[252:255], a[96:111]
    ds_read_b64_tr_b16 a[164:165], v8 offset:16640
    ds_read_b64_tr_b16 a[166:167], v8 offset:17664
    buffer_store_dwordx4 v[164:167], v29, s[48:51], s90 offen offset:3584 sc1
    v_accvgpr_read_b32 v55, a71
    v_cvt_pk_bf16_f32 v155, v54, v55
    v_mfma_f32_32x32x16_bf16 a[112:127], a[172:175], a[252:255], a[112:127]
    ds_read_b64_tr_b16 a[168:169], v6 offset:18688
    ds_read_b64_tr_b16 a[170:171], v6 offset:19712
    s_waitcnt lgkmcnt(10)
    v_accvgpr_read_b32 v52, a72
    v_accvgpr_read_b32 v53, a73
    v_cvt_pk_bf16_f32 v156, v52, v53
    v_mfma_f32_32x32x16_bf16 a[96:111], a[144:147], a[244:247], a[96:111]
    ds_read_b64_tr_b16 a[172:173], v8 offset:18688
    ds_read_b64_tr_b16 a[174:175], v8 offset:19712
    v_accvgpr_read_b32 v54, a74
    v_accvgpr_read_b32 v55, a75
    v_cvt_pk_bf16_f32 v157, v54, v55
    v_mfma_f32_32x32x16_bf16 a[112:127], a[148:151], a[244:247], a[112:127]
    ds_read_b64_tr_b16 a[144:145], v6 offset:20736
    ds_read_b64_tr_b16 a[146:147], v6 offset:21760
    s_waitcnt lgkmcnt(10)
    v_accvgpr_read_b32 v52, a76
    v_accvgpr_read_b32 v53, a77
    v_cvt_pk_bf16_f32 v158, v52, v53
    v_mfma_f32_32x32x16_bf16 a[96:111], a[152:155], a[184:187], a[96:111]
    ds_read_b64_tr_b16 a[148:149], v8 offset:20736
    ds_read_b64_tr_b16 a[150:151], v8 offset:21760
    v_accvgpr_read_b32 v54, a78
    v_accvgpr_read_b32 v55, a79
    v_cvt_pk_bf16_f32 v159, v54, v55
    v_mfma_f32_32x32x16_bf16 a[112:127], a[156:159], a[184:187], a[112:127]
    s_waitcnt vmcnt(24)
    s_barrier
    ds_read_b64_tr_b16 a[152:153], v6 offset:22784
    ds_read_b64_tr_b16 a[154:155], v6 offset:23808
    s_waitcnt lgkmcnt(10)
    s_add_u32 m0, s83, 104704
    s_add_u32 s96, s68, s99
    v_mfma_f32_32x32x16_bf16 a[96:111], a[160:163], a[176:179], a[96:111]
    ds_read_b64_tr_b16 a[156:157], v8 offset:22784
    ds_read_b64_tr_b16 a[158:159], v8 offset:23808
    buffer_load_dwordx4 v10, s[36:39], s96 offen lds
    v_permlane32_swap_b32 v152, v154
    v_mfma_f32_32x32x16_bf16 a[112:127], a[164:167], a[176:179], a[112:127]
    ds_read_b64_tr_b16 a[160:161], v6 offset:24832
    ds_read_b64_tr_b16 a[162:163], v6 offset:25856
    s_waitcnt lgkmcnt(10)
    v_permlane32_swap_b32 v153, v155
    v_mfma_f32_32x32x16_bf16 a[96:111], a[168:171], a[188:191], a[96:111]
    ds_read_b64_tr_b16 a[164:165], v8 offset:24832
    ds_read_b64_tr_b16 a[166:167], v8 offset:25856
    buffer_load_dwordx4 v11, s[36:39], s96 offen offset:1024 lds
    s_add_u32 m0, s83, 112896
    v_permlane32_swap_b32 v156, v158
    v_mfma_f32_32x32x16_bf16 a[112:127], a[172:175], a[188:191], a[112:127]
    ds_read_b64_tr_b16 a[168:169], v6 offset:26880
    ds_read_b64_tr_b16 a[170:171], v6 offset:27904
    s_waitcnt lgkmcnt(10)
    v_permlane32_swap_b32 v157, v159
    v_accvgpr_read_b32 v52, a80
    v_mfma_f32_32x32x16_bf16 a[96:111], a[144:147], a[180:183], a[96:111]
    ds_read_b64_tr_b16 a[172:173], v8 offset:26880
    ds_read_b64_tr_b16 a[174:175], v8 offset:27904
    buffer_store_dwordx4 v[152:155], v29, s[48:51], s91 offen sc1
    v_accvgpr_read_b32 v53, a81
    v_cvt_pk_bf16_f32 v160, v52, v53
    v_mfma_f32_32x32x16_bf16 a[112:127], a[148:151], a[180:183], a[112:127]
    ds_read_b64_tr_b16 a[144:145], v6 offset:28928
    ds_read_b64_tr_b16 a[146:147], v6 offset:29952
    s_waitcnt lgkmcnt(10)
    v_accvgpr_read_b32 v54, a82
    v_accvgpr_read_b32 v55, a83
    v_cvt_pk_bf16_f32 v161, v54, v55
    v_mfma_f32_32x32x16_bf16 a[96:111], a[152:155], v[120:123], a[96:111]
    ds_read_b64_tr_b16 a[148:149], v8 offset:28928
    ds_read_b64_tr_b16 a[150:151], v8 offset:29952
    buffer_load_dwordx4 v14, s[40:43], s68 offen lds
    v_accvgpr_read_b32 v52, a84
    v_accvgpr_read_b32 v53, a85
    v_mfma_f32_32x32x16_bf16 a[112:127], a[156:159], v[120:123], a[112:127]
    ds_read_b64_tr_b16 a[152:153], v2 offset:30976
    ds_read_b64_tr_b16 a[154:155], v2 offset:31488
    s_waitcnt lgkmcnt(10)
    v_cvt_pk_bf16_f32 v162, v52, v53
    v_accvgpr_read_b32 v54, a86
    v_accvgpr_read_b32 v55, a87
    v_mfma_f32_32x32x16_bf16 a[96:111], a[160:163], v[124:127], a[96:111]
    ds_read_b64_tr_b16 a[156:157], v4 offset:30976
    ds_read_b64_tr_b16 a[158:159], v4 offset:31488
    buffer_load_dwordx4 v15, s[40:43], s68 offen offset:1024 lds
    v_cvt_pk_bf16_f32 v163, v54, v55
    v_accvgpr_read_b32 v52, a88
    v_mfma_f32_32x32x16_bf16 a[112:127], a[164:167], v[124:127], a[112:127]
    ds_read_b64_tr_b16 a[160:161], v2 offset:33024
    ds_read_b64_tr_b16 a[162:163], v2 offset:33536
    s_waitcnt lgkmcnt(10)
    v_accvgpr_read_b32 v53, a89
    v_cvt_pk_bf16_f32 v164, v52, v53
    v_accvgpr_read_b32 v54, a90
    v_mfma_f32_32x32x16_bf16 a[96:111], a[168:171], a[192:195], a[96:111]
    ds_read_b64_tr_b16 a[164:165], v4 offset:33024
    ds_read_b64_tr_b16 a[166:167], v4 offset:33536
    v_accvgpr_read_b32 v55, a91
    v_cvt_pk_bf16_f32 v165, v54, v55
    v_accvgpr_read_b32 v52, a92
    v_mfma_f32_32x32x16_bf16 a[112:127], a[172:175], a[192:195], a[112:127]
    ds_read_b64_tr_b16 a[168:169], v2 offset:35072
    ds_read_b64_tr_b16 a[170:171], v2 offset:35584
    s_waitcnt lgkmcnt(10)
    v_accvgpr_read_b32 v53, a93
    v_cvt_pk_bf16_f32 v166, v52, v53
    v_accvgpr_read_b32 v54, a94
    v_mfma_f32_32x32x16_bf16 a[96:111], a[144:147], a[196:199], a[96:111]
    ds_read_b64_tr_b16 a[172:173], v4 offset:35072
    ds_read_b64_tr_b16 a[174:175], v4 offset:35584
    buffer_store_dwordx4 v[156:159], v29, s[48:51], s91 offen offset:512 sc1
    v_accvgpr_read_b32 v55, a95
    v_cvt_pk_bf16_f32 v167, v54, v55
    v_mfma_f32_32x32x16_bf16 a[112:127], a[148:151], a[196:199], a[112:127]
    ds_read_b64_tr_b16 a[144:145], v2 offset:37120
    ds_read_b64_tr_b16 a[146:147], v2 offset:37632
    s_waitcnt lgkmcnt(10)
    v_permlane32_swap_b32 v160, v162
    v_mfma_f32_32x32x16_bf16 a[96:111], a[152:155], v[40:43], a[96:111]
    ds_read_b64_tr_b16 a[148:149], v4 offset:37120
    ds_read_b64_tr_b16 a[150:151], v4 offset:37632
    v_permlane32_swap_b32 v161, v163
    v_permlane32_swap_b32 v164, v166
    v_mfma_f32_32x32x16_bf16 a[112:127], a[156:159], v[40:43], a[112:127]
    ds_read_b64_tr_b16 a[152:153], v22 offset:384
    s_waitcnt lgkmcnt(9)
    v_permlane32_swap_b32 v165, v167
    v_mfma_f32_32x32x16_bf16 a[96:111], a[160:163], v[44:47], a[96:111]
    ds_read_b64_tr_b16 a[156:157], v22 offset:448
    v_mfma_f32_32x32x16_bf16 a[112:127], a[164:167], v[44:47], a[112:127]
    s_waitcnt vmcnt(25)
    s_barrier
    ds_read_b64_tr_b16 a[160:161], v6 offset:39168
    ds_read_b64_tr_b16 a[162:163], v6 offset:40192
    s_waitcnt lgkmcnt(8)
    v_mfma_f32_32x32x16_bf16 a[96:111], a[168:171], v[128:131], a[96:111]
    ds_read_b64_tr_b16 a[164:165], v6 offset:41216
    ds_read_b64_tr_b16 a[166:167], v6 offset:42240
    v_mfma_f32_32x32x16_bf16 a[112:127], a[172:175], v[128:131], a[112:127]
    ds_read_b64_tr_b16 a[168:169], v6 offset:43264
    ds_read_b64_tr_b16 a[170:171], v6 offset:44288
    s_waitcnt lgkmcnt(8)
    v_mfma_f32_32x32x16_bf16 a[96:111], a[144:147], v[132:135], a[96:111]
    ds_read_b64_tr_b16 a[172:173], v6 offset:45312
    ds_read_b64_tr_b16 a[174:175], v6 offset:46336
    buffer_store_dwordx4 v[160:163], v29, s[48:51], s91 offen offset:1024 sc1
    v_mfma_f32_32x32x16_bf16 a[112:127], a[148:151], v[132:135], a[112:127]
    ds_read_b64_tr_b16 a[144:145], v6 offset:47360
    ds_read_b64_tr_b16 a[146:147], v6 offset:48384
    s_waitcnt lgkmcnt(10)
    v_mfma_f32_32x32x16_bf16 a[96:111], a[152:155], v[48:51], a[96:111]
    ds_read_b64_tr_b16 a[148:149], v6 offset:49408
    ds_read_b64_tr_b16 a[150:151], v6 offset:50432
    v_mfma_f32_32x32x16_bf16 a[112:127], a[156:159], v[48:51], a[112:127]
    ds_read_b64_tr_b16 a[152:153], v6 offset:51456
    ds_read_b64_tr_b16 a[154:155], v6 offset:52480
    s_waitcnt lgkmcnt(10)
    v_mfma_f32_32x32x16_bf16 v[168:183], a[160:163], v[104:107], 0
    ds_read_b64_tr_b16 a[156:157], v6 offset:53504
    ds_read_b64_tr_b16 a[158:159], v6 offset:54528
    s_waitcnt vmcnt(7)
    v_mfma_f32_32x32x16_bf16 v[168:183], a[164:167], v[112:115], v[168:183]
    s_barrier
    ds_read_b64_tr_b16 a[160:161], v6 offset:55552
    ds_read_b64_tr_b16 a[162:163], v6 offset:56576
    s_waitcnt lgkmcnt(10)
    v_accvgpr_read_b32 v52, a96
    v_accvgpr_read_b32 v53, a97
    s_mov_b64 exec, 1
    buffer_store_dword v254, v255, s[48:51], s95 offen offset:20 sc1
    s_mov_b64 exec, -1
    v_cvt_pk_bf16_f32 v152, v52, v53
    v_accvgpr_read_b32 v54, a98
    v_accvgpr_read_b32 v55, a99
    v_cvt_pk_bf16_f32 v153, v54, v55
    v_accvgpr_read_b32 v52, a100
    v_accvgpr_read_b32 v53, a101
    v_cvt_pk_bf16_f32 v154, v52, v53
    v_accvgpr_read_b32 v54, a102
    v_accvgpr_read_b32 v55, a103
    v_cvt_pk_bf16_f32 v155, v54, v55
    v_accvgpr_read_b32 v52, a104
    v_accvgpr_read_b32 v53, a105
    v_cvt_pk_bf16_f32 v156, v52, v53
    buffer_store_dwordx4 v[164:167], v29, s[48:51], s91 offen offset:1536 sc1
    v_accvgpr_read_b32 v54, a106
    v_accvgpr_read_b32 v55, a107
    v_cvt_pk_bf16_f32 v157, v54, v55
    v_accvgpr_read_b32 v52, a108
    v_accvgpr_read_b32 v53, a109
    v_cvt_pk_bf16_f32 v158, v52, v53
    v_accvgpr_read_b32 v54, a110
    v_accvgpr_read_b32 v55, a111
    v_cvt_pk_bf16_f32 v159, v54, v55
    v_permlane32_swap_b32 v152, v154
    v_permlane32_swap_b32 v153, v155
    v_permlane32_swap_b32 v156, v158
    v_permlane32_swap_b32 v157, v159
    v_accvgpr_read_b32 v52, a112
    buffer_store_dwordx4 v[152:155], v29, s[48:51], s91 offen offset:2048 sc1
    v_accvgpr_read_b32 v53, a113
    v_cvt_pk_bf16_f32 v160, v52, v53
    v_accvgpr_read_b32 v54, a114
    v_accvgpr_read_b32 v55, a115
    v_cvt_pk_bf16_f32 v161, v54, v55
    v_accvgpr_read_b32 v52, a116
    v_accvgpr_read_b32 v53, a117
    v_cvt_pk_bf16_f32 v162, v52, v53
    v_accvgpr_read_b32 v54, a118
    v_accvgpr_read_b32 v55, a119
    v_cvt_pk_bf16_f32 v163, v54, v55
    v_accvgpr_read_b32 v52, a120
    buffer_store_dwordx4 v[156:159], v29, s[48:51], s91 offen offset:2560 sc1
    v_accvgpr_read_b32 v53, a121
    v_cvt_pk_bf16_f32 v164, v52, v53
    v_accvgpr_read_b32 v54, a122
    v_accvgpr_read_b32 v55, a123
    v_cvt_pk_bf16_f32 v165, v54, v55
    v_accvgpr_read_b32 v52, a124
    v_accvgpr_read_b32 v53, a125
    v_cvt_pk_bf16_f32 v166, v52, v53
    v_accvgpr_read_b32 v54, a126
    v_accvgpr_read_b32 v55, a127
    v_cvt_pk_bf16_f32 v167, v54, v55
    v_permlane32_swap_b32 v160, v162
    v_permlane32_swap_b32 v161, v163
    v_permlane32_swap_b32 v164, v166
    v_permlane32_swap_b32 v165, v167
    buffer_store_dwordx4 v[160:163], v29, s[48:51], s91 offen offset:3072 sc1
    buffer_store_dwordx4 v[164:167], v29, s[48:51], s91 offen offset:3584 sc1
    v_mfma_f32_32x32x16_bf16 v[168:183], a[168:171], v[108:111], v[168:183]
    ds_read_b64_tr_b16 a[164:165], v6 offset:57600
    ds_read_b64_tr_b16 a[166:167], v6 offset:58624
    v_mfma_f32_32x32x16_bf16 v[168:183], a[172:175], v[116:119], v[168:183]
    ds_read_b64_tr_b16 a[168:169], v6 offset:59648
    ds_read_b64_tr_b16 a[170:171], v6 offset:60672
    s_waitcnt lgkmcnt(10)
    v_mfma_f32_32x32x16_bf16 v[168:183], a[144:147], v[136:139], v[168:183]
    ds_read_b64_tr_b16 a[172:173], v6 offset:61696
    ds_read_b64_tr_b16 a[174:175], v6 offset:62720
    v_mfma_f32_32x32x16_bf16 v[168:183], a[148:151], v[144:147], v[168:183]
    ds_read_b64_tr_b16 a[144:145], v6 offset:63744
    ds_read_b64_tr_b16 a[146:147], v6 offset:64768
    s_waitcnt lgkmcnt(10)
    v_mfma_f32_32x32x16_bf16 v[168:183], a[152:155], v[140:143], v[168:183]
    ds_read_b64_tr_b16 a[148:149], v7 offset:1280
    ds_read_b64_tr_b16 a[150:151], v7 offset:2304
    v_mfma_f32_32x32x16_bf16 v[168:183], a[156:159], v[148:151], v[168:183]
    ds_read_b64_tr_b16 a[152:153], v7 offset:3328
    ds_read_b64_tr_b16 a[154:155], v7 offset:4352
    s_waitcnt lgkmcnt(10)
    v_mfma_f32_32x32x16_bf16 v[168:183], a[160:163], a[216:219], v[168:183]
    ds_read_b64_tr_b16 a[156:157], v7 offset:5376
    ds_read_b64_tr_b16 a[158:159], v7 offset:6400
    v_mfma_f32_32x32x16_bf16 v[168:183], a[164:167], a[208:211], v[168:183]
    s_barrier
    ds_read_b64_tr_b16 a[160:161], v7 offset:7424
    ds_read_b64_tr_b16 a[162:163], v7 offset:8448
    s_waitcnt lgkmcnt(10)
    v_mfma_f32_32x32x16_bf16 v[168:183], a[168:171], a[220:223], v[168:183]
    ds_read_b64_tr_b16 a[164:165], v7 offset:9472
    ds_read_b64_tr_b16 a[166:167], v7 offset:10496
    v_mfma_f32_32x32x16_bf16 v[168:183], a[172:175], a[212:215], v[168:183]
    ds_read_b64_tr_b16 a[168:169], v7 offset:11520
    ds_read_b64_tr_b16 a[170:171], v7 offset:12544
    s_waitcnt lgkmcnt(10)
    v_mfma_f32_32x32x16_bf16 v[168:183], a[144:147], a[232:235], v[168:183]
    ds_read_b64_tr_b16 a[172:173], v7 offset:13568
    ds_read_b64_tr_b16 a[174:175], v7 offset:14592
    v_mfma_f32_32x32x16_bf16 v[168:183], a[148:151], a[224:227], v[168:183]
    ds_read_b64_tr_b16 a[144:145], v7 offset:15616
    ds_read_b64_tr_b16 a[146:147], v7 offset:16640
    s_waitcnt lgkmcnt(10)
    v_mfma_f32_32x32x16_bf16 v[168:183], a[152:155], a[236:239], v[168:183]
    ds_read_b64_tr_b16 a[148:149], v7 offset:17664
    ds_read_b64_tr_b16 a[150:151], v7 offset:18688
    v_mfma_f32_32x32x16_bf16 v[168:183], a[156:159], a[228:231], v[168:183]
    ds_read_b64_tr_b16 a[152:153], v7 offset:19712
    ds_read_b64_tr_b16 a[154:155], v7 offset:20736
    s_waitcnt lgkmcnt(10)
    v_mfma_f32_32x32x16_bf16 v[168:183], a[160:163], v[56:59], v[168:183]
    ds_read_b64_tr_b16 a[156:157], v7 offset:21760
    ds_read_b64_tr_b16 a[158:159], v7 offset:22784
    v_mfma_f32_32x32x16_bf16 v[168:183], a[164:167], v[64:67], v[168:183]
    s_barrier
    ds_read_b64_tr_b16 a[160:161], v7 offset:23808
    ds_read_b64_tr_b16 a[162:163], v7 offset:24832
    s_waitcnt lgkmcnt(10)
    v_mfma_f32_32x32x16_bf16 v[168:183], a[168:171], v[60:63], v[168:183]
    ds_read_b64_tr_b16 a[164:165], v7 offset:25856
    ds_read_b64_tr_b16 a[166:167], v7 offset:26880
    v_mfma_f32_32x32x16_bf16 v[168:183], a[172:175], v[68:71], v[168:183]
    ds_read_b64_tr_b16 a[168:169], v7 offset:27904
    ds_read_b64_tr_b16 a[170:171], v7 offset:28928
    s_waitcnt lgkmcnt(10)
    v_mfma_f32_32x32x16_bf16 v[168:183], a[144:147], v[72:75], v[168:183]
    ds_read_b64_tr_b16 a[172:173], v7 offset:29952
    ds_read_b64_tr_b16 a[174:175], v7 offset:30976
    v_mfma_f32_32x32x16_bf16 v[168:183], a[148:151], v[80:83], v[168:183]
    ds_read_b64_tr_b16 a[144:145], v7 offset:32000
    ds_read_b64_tr_b16 a[146:147], v7 offset:33024
    s_waitcnt lgkmcnt(10)
    v_mfma_f32_32x32x16_bf16 v[168:183], a[152:155], v[76:79], v[168:183]
    ds_read_b64_tr_b16 a[148:149], v7 offset:34048
    ds_read_b64_tr_b16 a[150:151], v7 offset:35072
    v_mfma_f32_32x32x16_bf16 v[168:183], a[156:159], v[84:87], v[168:183]
    ds_read_b64_tr_b16 a[152:153], v7 offset:36096
    ds_read_b64_tr_b16 a[154:155], v7 offset:37120
    s_waitcnt lgkmcnt(10)
    v_mfma_f32_32x32x16_bf16 v[168:183], a[160:163], a[248:251], v[168:183]
    ds_read_b64_tr_b16 a[156:157], v7 offset:38144
    ds_read_b64_tr_b16 a[158:159], v7 offset:39168
    v_mfma_f32_32x32x16_bf16 v[168:183], a[164:167], a[240:243], v[168:183]
    s_waitcnt vmcnt(8)
    s_barrier
    ds_read_b64_tr_b16 a[160:161], v7 offset:40192
    ds_read_b64_tr_b16 a[162:163], v7 offset:41216
    s_waitcnt lgkmcnt(10)
    v_mfma_f32_32x32x16_bf16 v[168:183], a[168:171], a[252:255], v[168:183]
    ds_read_b64_tr_b16 a[164:165], v7 offset:42240
    ds_read_b64_tr_b16 a[166:167], v7 offset:43264
    v_mfma_f32_32x32x16_bf16 v[168:183], a[172:175], a[244:247], v[168:183]
    ds_read_b64_tr_b16 a[168:169], v7 offset:44288
    ds_read_b64_tr_b16 a[170:171], v7 offset:45312
    s_waitcnt lgkmcnt(10)
    v_mfma_f32_32x32x16_bf16 v[168:183], a[144:147], a[184:187], v[168:183]
    ds_read_b64_tr_b16 a[172:173], v7 offset:46336
    ds_read_b64_tr_b16 a[174:175], v7 offset:47360
    v_mfma_f32_32x32x16_bf16 v[168:183], a[148:151], a[176:179], v[168:183]
    ds_read_b64_tr_b16 a[144:145], v3 offset:48384
    ds_read_b64_tr_b16 a[146:147], v3 offset:48896
    s_waitcnt lgkmcnt(10)
    v_mfma_f32_32x32x16_bf16 v[168:183], a[152:155], a[188:191], v[168:183]
    ds_read_b64_tr_b16 a[148:149], v3 offset:50432
    ds_read_b64_tr_b16 a[150:151], v3 offset:50944
    v_mfma_f32_32x32x16_bf16 v[168:183], a[156:159], a[180:183], v[168:183]
    ds_read_b64_tr_b16 a[152:153], v3 offset:52480
    ds_read_b64_tr_b16 a[154:155], v3 offset:52992
    s_waitcnt lgkmcnt(10)
    buffer_load_dwordx2 v[250:251], v246, s[48:51], 0 offen offset:20 sc1
    v_mfma_f32_32x32x16_bf16 v[168:183], a[160:163], v[120:123], v[168:183]
    ds_read_b64_tr_b16 a[156:157], v3 offset:54528
    ds_read_b64_tr_b16 a[158:159], v3 offset:55040
    s_waitcnt vmcnt(1)
    v_mfma_f32_32x32x16_bf16 v[168:183], a[164:167], v[124:127], v[168:183]
    ds_read_b64_tr_b16 a[160:161], v22 offset:512
    s_waitcnt lgkmcnt(9)
    s_mov_b64 exec, 1
    buffer_store_dword v254, v255, s[48:51], s95 offen offset:24 sc1
    s_mov_b64 exec, -1
    v_mfma_f32_32x32x16_bf16 v[168:183], a[168:171], a[192:195], v[168:183]
    v_mfma_f32_32x32x16_bf16 v[168:183], a[172:175], a[196:199], v[168:183]
    s_waitcnt lgkmcnt(5)
    v_mfma_f32_32x32x16_bf16 v[168:183], a[144:147], v[40:43], v[168:183]
    v_mfma_f32_32x32x16_bf16 v[168:183], a[148:151], v[44:47], v[168:183]
    s_waitcnt lgkmcnt(1)
    v_mfma_f32_32x32x16_bf16 v[168:183], a[152:155], v[128:131], v[168:183]
    v_mfma_f32_32x32x16_bf16 v[168:183], a[156:159], v[132:135], v[168:183]
    s_waitcnt lgkmcnt(0)
    v_mfma_f32_32x32x16_bf16 v[168:183], a[160:163], v[48:51], v[168:183]
    s_nop 11
    v_cvt_pk_bf16_f32 v168, v168, v169
    v_cvt_pk_bf16_f32 v169, v170, v171
    v_cvt_pk_bf16_f32 v170, v172, v173
    v_cvt_pk_bf16_f32 v171, v174, v175
    v_cvt_pk_bf16_f32 v172, v176, v177
    v_cvt_pk_bf16_f32 v173, v178, v179
    v_cvt_pk_bf16_f32 v174, v180, v181
    v_cvt_pk_bf16_f32 v175, v182, v183
    v_permlane32_swap_b32 v168, v170
    v_permlane32_swap_b32 v169, v171
    v_permlane32_swap_b32 v172, v174
    v_permlane32_swap_b32 v173, v175
    buffer_store_dwordx4 v[168:171], v29, s[48:51], s92 offen sc1
    buffer_store_dwordx4 v[172:175], v29, s[48:51], s92 offen offset:512 sc1
    s_barrier
    s_waitcnt vmcnt(3)
    v_cmp_ne_u32_e64 s[74:75], 1, v250
    s_nop 0
    s_cmp_lg_u64 s[74:75], 0
    s_cbranch_scc1 L_slow_28
L_back_29:
    buffer_load_dwordx4 a[0:3], v16, s[48:51], s73 offen sc1
    s_add_u32 s73, s73, 9216
    buffer_load_dwordx4 a[4:7], v16, s[48:51], s73 offen sc1
    s_add_u32 s73, s73, 9216
    buffer_load_dwordx4 a[8:11], v16, s[48:51], s73 offen sc1
    s_add_u32 s73, s73, 9216
    buffer_load_dwordx4 a[12:15], v16, s[48:51], s73 offen sc1
    s_add_u32 s73, s73, 9216
    buffer_load_dwordx4 a[16:19], v16, s[48:51], s73 offen sc1
    s_add_u32 s73, s73, 9216
    buffer_load_dwordx4 a[20:23], v16, s[48:51], s73 offen sc1
    s_add_u32 s73, s73, 9216
    buffer_load_dwordx4 a[24:27], v16, s[48:51], s73 offen sc1
    s_add_u32 s73, s73, 9216
    buffer_load_dwordx4 a[28:31], v16, s[48:51], s73 offen sc1
    s_add_u32 s73, s73, -64512
    v_cmp_ne_u32_e64 s[76:77], 1, v251
    s_nop 0
    s_cmp_lg_u64 s[76:77], 0
    s_cbranch_scc1 L_slow_30
L_back_31:
    buffer_load_dwordx4 a[64:67], v16, s[48:51], s80 offen sc1
    s_add_u32 s80, s80, 9216
    buffer_load_dwordx4 a[68:71], v16, s[48:51], s80 offen sc1
    s_add_u32 s80, s80, 9216
    buffer_load_dwordx4 a[72:75], v16, s[48:51], s80 offen sc1
    s_add_u32 s80, s80, 9216
    buffer_load_dwordx4 a[76:79], v16, s[48:51], s80 offen sc1
    s_add_u32 s80, s80, 9216
    buffer_load_dwordx4 a[80:83], v16, s[48:51], s80 offen sc1
    s_add_u32 s80, s80, 9216
    buffer_load_dwordx4 a[84:87], v16, s[48:51], s80 offen sc1
    s_add_u32 s80, s80, 9216
    buffer_load_dwordx4 a[88:91], v16, s[48:51], s80 offen sc1
    s_add_u32 s80, s80, 9216
    buffer_load_dwordx4 a[92:95], v16, s[48:51], s80 offen sc1
    s_add_u32 s80, s80, -64512
    buffer_load_dwordx4 a[96:99], v248, s[48:51], s81 offen sc1
    s_add_u32 s81, s81, 18432
    buffer_load_dwordx4 a[100:103], v248, s[48:51], s81 offen sc1
    s_add_u32 s81, s81, 18432
    buffer_load_dwordx4 a[104:107], v248, s[48:51], s81 offen sc1
    s_add_u32 s81, s81, 18432
    buffer_load_dwordx4 a[108:111], v248, s[48:51], s81 offen sc1
    s_add_u32 s81, s81, -55296
    v_mfma_f32_32x32x16_bf16 v[184:199], v[32:35], a[128:131], 0
    s_waitcnt vmcnt(19)
    v_mfma_f32_32x32x16_bf16 v[184:199], v[32:35], a[0:3], v[184:199]
    s_waitcnt vmcnt(18)
    v_mfma_f32_32x32x16_bf16 v[184:199], v[32:35], a[4:7], v[184:199]
    s_waitcnt vmcnt(17)
    v_mfma_f32_32x32x16_bf16 v[184:199], v[32:35], a[8:11], v[184:199]
    s_waitcnt vmcnt(16)
    v_mfma_f32_32x32x16_bf16 v[184:199], v[32:35], a[12:15], v[184:199]
    s_waitcnt vmcnt(15)
    v_mfma_f32_32x32x16_bf16 v[184:199], v[32:35], a[16:19], v[184:199]
    s_waitcnt vmcnt(14)
    v_mfma_f32_32x32x16_bf16 v[184:199], v[32:35], a[20:23], v[184:199]
    s_waitcnt vmcnt(13)
    v_mfma_f32_32x32x16_bf16 v[184:199], v[32:35], a[24:27], v[184:199]
    s_waitcnt vmcnt(12)
    v_mfma_f32_32x32x16_bf16 v[184:199], v[32:35], a[28:31], v[184:199]
    s_nop 11
    v_cvt_pk_bf16_f32 v192, v184, v185
    v_cvt_pk_bf16_f32 v193, v186, v187
    v_cvt_pk_bf16_f32 v194, v188, v189
    v_cvt_pk_bf16_f32 v195, v190, v191
    buffer_store_dwordx4 v[192:195], v17, s[44:47], s12 offen
    v_mfma_f32_32x32x16_bf16 v[200:215], v[32:35], a[132:135], 0
    s_waitcnt vmcnt(12)
    v_mfma_f32_32x32x16_bf16 v[200:215], v[32:35], a[64:67], v[200:215]
    s_waitcnt vmcnt(11)
    v_mfma_f32_32x32x16_bf16 v[200:215], v[32:35], a[68:71], v[200:215]
    s_waitcnt vmcnt(10)
    v_mfma_f32_32x32x16_bf16 v[200:215], v[32:35], a[72:75], v[200:215]
    s_waitcnt vmcnt(9)
    v_mfma_f32_32x32x16_bf16 v[200:215], v[32:35], a[76:79], v[200:215]
    s_waitcnt vmcnt(8)
    v_mfma_f32_32x32x16_bf16 v[200:215], v[32:35], a[80:83], v[200:215]
    s_waitcnt vmcnt(7)
    v_mfma_f32_32x32x16_bf16 v[200:215], v[32:35], a[84:87], v[200:215]
    s_waitcnt vmcnt(6)
    v_mfma_f32_32x32x16_bf16 v[200:215], v[32:35], a[88:91], v[200:215]
    s_waitcnt vmcnt(5)
    v_mfma_f32_32x32x16_bf16 v[200:215], v[32:35], a[92:95], v[200:215]
    s_nop 11
    v_cvt_pk_bf16_f32 v208, v200, v201
    v_cvt_pk_bf16_f32 v209, v202, v203
    v_cvt_pk_bf16_f32 v210, v204, v205
    v_cvt_pk_bf16_f32 v211, v206, v207
    buffer_store_dwordx4 v[208:211], v17, s[44:47], s13 offen
    v_mfma_f32_32x32x16_bf16 v[216:231], v[32:35], a[136:139], 0
    s_waitcnt vmcnt(5)
    v_mfma_f32_32x32x16_bf16 v[216:231], v[36:39], a[96:99], v[216:231]
    s_waitcnt vmcnt(4)
    v_mfma_f32_32x32x16_bf16 v[216:231], v[36:39], a[100:103], v[216:231]
    s_waitcnt vmcnt(3)
    v_mfma_f32_32x32x16_bf16 v[216:231], v[36:39], a[104:107], v[216:231]
    s_waitcnt vmcnt(2)
    v_mfma_f32_32x32x16_bf16 v[216:231], v[36:39], a[108:111], v[216:231]
    s_nop 11
    v_cmp_u_f32_e64 s[78:79], v216, v216
    s_nop 0
    s_cmp_lg_u64 s[78:79], 0
    s_cbranch_scc1 L_slow_32
L_back_33:
    v_cvt_pk_bf16_f32 v224, v216, v217
    v_cvt_pk_bf16_f32 v225, v218, v219
    v_cvt_pk_bf16_f32 v226, v220, v221
    v_cvt_pk_bf16_f32 v227, v222, v223
    buffer_store_dwordx4 v[224:227], v249, s[44:47], s8 offen
L_end:
    s_endpgm
    s_nop 15
    s_nop 3
L_slow_2:
    s_mov_b32 s18, 0
L_spin_34:
    s_sleep 4
    buffer_load_dword v179, v178, s[52:55], 0 offen sc1
    s_waitcnt vmcnt(0)
    v_cmp_ne_u32_e64 s[14:15], s100, v179
    s_nop 3
    s_cmp_eq_u64 s[14:15], 0
    s_cbranch_scc1 L_back_3
    s_add_u32 s18, s18, 1
    s_cmp_lt_u32 s18, 262144
    s_cbranch_scc1 L_spin_34
    s_branch L_back_3
    s_nop 15
    s_nop 3
L_slow_7:
    s_mov_b32 s18, 0
L_spin_35:
    s_sleep 4
    buffer_load_dword v172, v173, s[48:51], s14 offen sc1
    s_waitcnt vmcnt(0)
    v_cmp_ne_u32_e64 s[6:7], 1, v172
    s_nop 3
    s_cmp_eq_u64 s[6:7], 0
    s_cbranch_scc1 L_back_8
    s_add_u32 s18, s18, 1
    s_cmp_lt_u32 s18, 262144
    s_cbranch_scc1 L_spin_35
    s_branch L_back_8
    s_nop 15
    s_nop 3
L_slow_14:
    s_mov_b32 s18, 0
L_spin_36:
    s_sleep 4
    buffer_load_dword v250, v255, s[48:51], s101 offen offset:4 sc1
    s_waitcnt vmcnt(0)
    v_cmp_ne_u32_e64 s[10:11], 1, v250
    s_nop 3
    s_cmp_eq_u64 s[10:11], 0
    s_cbranch_scc1 L_back_15
    s_add_u32 s18, s18, 1
    s_cmp_lt_u32 s18, 262144
    s_cbranch_scc1 L_spin_36
    s_branch L_back_15
    s_nop 15
    s_nop 3
L_slow_17:
    s_mov_b32 s18, 0
L_spin_37:
    s_sleep 4
    buffer_load_dword v251, v255, s[48:51], s101 offen offset:8 sc1
    s_waitcnt vmcnt(0)
    v_cmp_ne_u32_e64 s[16:17], 1, v251
    s_nop 3
    s_cmp_eq_u64 s[16:17], 0
    s_cbranch_scc1 L_back_18
    s_add_u32 s18, s18, 1
    s_cmp_lt_u32 s18, 262144
    s_cbranch_scc1 L_spin_37
    s_branch L_back_18
    s_nop 15
    s_nop 3
L_slow_19:
    s_mov_b32 s18, 0
L_spin_38:
    s_sleep 2
    buffer_load_dwordx4 v[96:99], v91, s[48:51], s4 offen sc1
    buffer_load_dwordx2 v[100:101], v92, s[48:51], s4 offen offset:64 sc1
    s_waitcnt vmcnt(0)
    s_mov_b32 s6, 0xf0f0f0f0
    s_mov_b32 s7, 0xf0f0f0f0
    v_permlane16_swap_b32 v96, v97
    v_permlane16_swap_b32 v98, v99
    v_permlane16_swap_b32 v100, v101
    v_add_f32 v100, v100, v101
    v_add_f32 v96, v96, v97
    v_add_f32 v98, v98, v99
    v_mov_b32 v101, v100
    s_nop 0
    v_permlane32_swap_b32 v96, v98
    v_permlane32_swap_b32 v100, v101
    v_add_f32 v96, v96, v98
    v_add_f32 v100, v100, v101
    v_cndmask_b32_e64 v98, v100, v96, s[6:7]
    v_cndmask_b32_e64 v97, v96, v100, s[6:7]
    s_nop 1
    v_add_f32_dpp v97, v98, v97 row_ror:4 row_mask:0xf bank_mask:0xf
    s_nop 1
    v_add_f32_dpp v97, v97, v97 row_ror:8 row_mask:0xf bank_mask:0xf
    s_nop 15
    s_nop 3
    v_cmp_u_f32_e64 s[6:7], v97, v97
    s_nop 3
    s_cmp_eq_u64 s[6:7], 0
    s_cbranch_scc1 L_back_20
    s_add_u32 s18, s18, 1
    s_cmp_lt_u32 s18, 65536
    s_cbranch_scc1 L_spin_38
    s_branch L_back_20
    s_nop 15
    s_nop 3
L_slow_21:
    s_mov_b32 s18, 0
L_spin_39:
    s_sleep 2
    buffer_load_dwordx4 v[184:187], v94, s[48:51], s4 offen sc1
    s_waitcnt vmcnt(0)
    v_pk_max_u16 v100, v184, v185
    v_pk_max_u16 v101, v186, v187
    v_pk_max_u16 v100, v100, v101
    v_lshlrev_b32 v101, 16, v100
    v_max_u32 v100, v100, v101
    s_nop 15
    s_nop 3
    v_cmp_le_u32_e64 s[6:7], s85, v100
    s_nop 3
    s_cmp_eq_u64 s[6:7], 0
    s_cbranch_scc1 L_back_22
    s_add_u32 s18, s18, 1
    s_cmp_lt_u32 s18, 65536
    s_cbranch_scc1 L_spin_39
    s_branch L_back_22
    s_nop 15
    s_nop 3
L_slow_24:
    s_mov_b32 s18, 0
L_spin_40:
    s_sleep 4
    buffer_load_dword v252, v255, s[48:51], s101 offen offset:12 sc1
    s_waitcnt vmcnt(0)
    v_cmp_ne_u32_e64 s[22:23], 1, v252
    s_nop 3
    s_cmp_eq_u64 s[22:23], 0
    s_cbranch_scc1 L_back_25
    s_add_u32 s18, s18, 1
    s_cmp_lt_u32 s18, 262144
    s_cbranch_scc1 L_spin_40
    s_branch L_back_25
    s_nop 15
    s_nop 3
L_slow_26:
    s_mov_b32 s18, 0
L_spin_41:
    s_sleep 2
    buffer_load_dwordx4 v[128:131], v30, s[48:51], s4 offen sc1
    buffer_load_dwordx4 v[132:135], v30, s[48:51], s4 offen offset:1024 sc1
    buffer_load_dword v49, v208, s[48:51], s4 offen offset:2048 sc1
    s_waitcnt vmcnt(0)
    v_max3_u32 v210, v128, v129, v130
    v_max3_u32 v211, v131, v132, v133
    v_max3_u32 v210, v210, v134, v135
    v_max3_u32 v210, v210, v211, v49
    s_nop 15
    s_nop 3
    v_cmp_eq_u32_e64 s[6:7], -1, v210
    s_nop 3
    s_cmp_eq_u64 s[6:7], 0
    s_cbranch_scc1 L_back_27
    s_add_u32 s18, s18, 1
    s_cmp_lt_u32 s18, 65536
    s_cbranch_scc1 L_spin_41
    s_branch L_back_27
    s_nop 15
    s_nop 3
L_slow_28:
    s_mov_b32 s18, 0
L_spin_42:
    s_sleep 2
    buffer_load_dwordx2 v[250:251], v246, s[48:51], 0 offen offset:20 sc1
    s_waitcnt vmcnt(0)
    s_nop 15
    s_nop 3
    v_cmp_ne_u32_e64 s[74:75], 1, v250
    s_nop 3
    s_cmp_eq_u64 s[74:75], 0
    s_cbranch_scc1 L_back_29
    s_add_u32 s18, s18, 1
    s_cmp_lt_u32 s18, 65536
    s_cbranch_scc1 L_spin_42
    s_branch L_back_29
    s_nop 15
    s_nop 3
L_slow_30:
    s_mov_b32 s18, 0
L_spin_43:
    s_sleep 2
    buffer_load_dwordx2 v[250:251], v246, s[48:51], 0 offen offset:20 sc1
    s_waitcnt vmcnt(0)
    s_nop 15
    s_nop 3
    v_cmp_ne_u32_e64 s[76:77], 1, v251
    s_nop 3
    s_cmp_eq_u64 s[76:77], 0
    s_cbranch_scc1 L_back_31
    s_add_u32 s18, s18, 1
    s_cmp_lt_u32 s18, 65536
    s_cbranch_scc1 L_spin_43
    s_branch L_back_31
    s_nop 15
    s_nop 3
L_slow_32:
    s_mov_b32 s18, 0
L_spin_44:
    s_sleep 2
    buffer_load_dwordx4 a[96:99], v248, s[48:51], s81 offen sc1
    s_add_u32 s81, s81, 18432
    buffer_load_dwordx4 a[100:103], v248, s[48:51], s81 offen sc1
    s_add_u32 s81, s81, 18432
    buffer_load_dwordx4 a[104:107], v248, s[48:51], s81 offen sc1
    s_add_u32 s81, s81, 18432
    buffer_load_dwordx4 a[108:111], v248, s[48:51], s81 offen sc1
    s_add_u32 s81, s81, -55296
    v_mfma_f32_32x32x16_bf16 v[216:231], v[32:35], a[136:139], 0
    s_waitcnt vmcnt(3)
    v_mfma_f32_32x32x16_bf16 v[216:231], v[36:39], a[96:99], v[216:231]
    s_waitcnt vmcnt(2)
    v_mfma_f32_32x32x16_bf16 v[216:231], v[36:39], a[100:103], v[216:231]
    s_waitcnt vmcnt(1)
    v_mfma_f32_32x32x16_bf16 v[216:231], v[36:39], a[104:107], v[216:231]
    s_waitcnt vmcnt(0)
    v_mfma_f32_32x32x16_bf16 v[216:231], v[36:39], a[108:111], v[216:231]
    s_nop 15
    s_nop 3
    v_cmp_u_f32_e64 s[78:79], v216, v216
    s_nop 3
    s_cmp_eq_u64 s[78:79], 0
    s_cbranch_scc1 L_back_33
    s_add_u32 s18, s18, 1
    s_cmp_lt_u32 s18, 65536
    s_cbranch_scc1 L_spin_44
    s_branch L_back_33

.section .rodata,"a"
.p2align 6
.amdhsa_kernel parallel_sum__linear_kernel_hedgehog__dense_activation_relu__prompt_kernel
  .amdhsa_next_free_vgpr 512
  .amdhsa_next_free_sgpr 102
  .amdhsa_accum_offset 256
  .amdhsa_group_segment_fixed_size 0
  .amdhsa_kernarg_size 80
  .amdhsa_user_sgpr_count 2
  .amdhsa_user_sgpr_kernarg_segment_ptr 1
  .amdhsa_system_sgpr_workgroup_id_x 1
.end_amdhsa_kernel
```
